```python
import torch

def _softmax(x, axis=-1):
    return torch.softmax(x, dim=axis)
def _gelu(x):
    return torch.nn.functional.gelu(x, approximate="tanh")
def _silu(x):
    return torch.nn.functional.silu(x)
def _sigmoid(x):
    return torch.sigmoid(x)
def _layernorm(x, axis=-1, eps=1e-5):
    m = x.mean(dim=axis, keepdim=True)
    v = x.var(dim=axis, keepdim=True, unbiased=False)
    return (x - m) / torch.sqrt(v + eps)
def _scatter_add(tgt, idx, src, axis=0):
    return tgt.clone().index_add_(axis, idx, src)
def _segment_sum(src, seg, n):
    out = torch.zeros((n,) + src.shape[1:], dtype=src.dtype)
    return out.index_add_(0, seg, src)
def _pad(x, pw):
    flat = tuple(v for pair in reversed(pw) for v in pair)
    return torch.nn.functional.pad(x, flat)

kernel_name = 'concat_heads__sliding_block__linear_attn_block__prompt'

def setup_inputs():

    _w = (lambda a: (lambda t: t.to(torch.bfloat16) if t.is_floating_point() else t)(torch.as_tensor(a)))
    def _A_setup():
        B, S, D = 1, 2048, 640
        return {
            "x": _w((lambda *s: torch.randn(*s, dtype=torch.bfloat16) * 0.2)(B, S, D)),
            "wqkv": _w((lambda *s: torch.randn(*s, dtype=torch.bfloat16) * 0.2)(D, 3 * D)),
            "wo": _w((lambda *s: torch.randn(*s, dtype=torch.bfloat16) * 0.05)(D, D)),
        }
    _A_in = _A_setup()

    def _B_setup():
        B, S, D = 1, 2048, 640
        return {
            "x": _w((lambda *s: torch.randn(*s, dtype=torch.bfloat16) * 0.05)(B, S, D)),
            "wqkv": _w((lambda *s: torch.randn(*s, dtype=torch.bfloat16) * 1.6)(D, 3 * D)),
            "wo": _w((lambda *s: torch.randn(*s, dtype=torch.bfloat16) * 0.8)(D, D)),
        }
    _B_in = _B_setup()

    return {
        "A_x": _A_in["x"],
        "A_wqkv": _A_in["wqkv"],
        "A_wo": _A_in["wo"],
        "B_x": _B_in["x"],
        "B_wqkv": _B_in["wqkv"],
        "B_wo": _B_in["wo"],
    }

def reference(A_x, A_wqkv, A_wo, B_x, B_wqkv, B_wo):
    def _A_ref(x, wqkv, wo):
        B, S, D = x.shape
        H = 32; Dh = D // H; W = 256
        qkv = (lambda x, *d: x.permute(*d))((x @ wqkv).reshape(B, S, 3, H, Dh), 2, 0, 3, 1, 4)
        q, k, v = qkv[0], qkv[1], qkv[2]
        scores = torch.einsum("bhqd,bhkd->bhqk", q, k) * (Dh ** -0.5)
        idx = torch.arange(S)
        mask = (idx[:, None] - idx[None, :] >= 0) & (idx[:, None] - idx[None, :] < W)
        scores = torch.where(mask[None, None], scores, -1e9)
        p = _softmax(scores, axis=-1)
        o = torch.einsum("bhqk,bhkd->bhqd", p, v)
        return (lambda x, *d: x.permute(*d))(o, 0, 2, 1, 3).reshape(B, S, D) @ wo

    def _B_ref(x, wqkv, wo):
        B, S, D = x.shape
        H = 32; Dh = D // H
        qkv = (lambda x, *d: x.permute(*d))((x @ wqkv).reshape(B, S, 3, H, Dh), 2, 0, 3, 1, 4)
        q, k, v = qkv[0], qkv[1], qkv[2]
        phi = lambda t: torch.where(t > 0, t + 1, torch.exp(t)) + 1e-6
        pq, pk = phi(q), phi(k)
        kv = torch.einsum("bhsd,bhse->bhde", pk, v)
        z = torch.einsum("bhsd->bhd", pk)
        num = torch.einsum("bhqd,bhde->bhqe", pq, kv)
        den = torch.einsum("bhqd,bhd->bhq", pq, z)[..., None] + 1e-6
        o = num / den
        return (lambda x, *d: x.permute(*d))(o, 0, 2, 1, 3).reshape(B, S, D) @ wo

    a = _A_ref(A_x, A_wqkv, A_wo)
    b = _B_ref(B_x, B_wqkv, B_wo)
    return torch.concatenate([a, b], axis=-1)
```

```asm
; @launch grid=(256,1,1) block=(256,1,1) lds=163840
.amdgcn_target "amdgcn-amd-amdhsa--gfx950"
.text
.globl concat_heads__sliding_block__linear_attn_block__prompt_kernel
.p2align 8
.type concat_heads__sliding_block__linear_attn_block__prompt_kernel,@function
concat_heads__sliding_block__linear_attn_block__prompt_kernel:
    s_and_b32 s32, s2, 1
    s_mul_i32 s44, s32, 24
    s_load_dwordx4 s[64:67], s[0:1], s44
    s_cmp_ge_u32 s2, 256
    s_cbranch_scc1 L_end
    s_load_dwordx2 s[68:69], s[0:1], s44 offset:16
    s_load_dwordx4 s[72:75], s[0:1], 48
    s_load_dwordx2 s[76:77], s[0:1], 64
    v_lshrrev_b32 v26, 6, v0
    v_and_b32 v1, 63, v0
    s_and_b32 s42, s2, 7
    v_readfirstlane_b32 s35, v26
    s_lshr_b32 s43, s2, 3
    s_lshr_b32 s38, s42, 1
    s_and_b32 s38, s38, 1
    s_lshl_b32 s38, s38, 3
    s_and_b32 s33, s43, 7
    s_or_b32 s33, s33, s38
    s_lshr_b32 s38, s42, 2
    s_lshl_b32 s38, s38, 2
    s_lshr_b32 s34, s43, 3
    s_or_b32 s34, s34, s38
    v_lshrrev_b32 v26, 3, v1
    v_and_b32 v27, 7, v1
    v_xor_b32 v27, v27, v26
    v_mul_u32_u24 v120, 1280, v26
    v_lshl_add_u32 v120, v27, 4, v120
    v_add_u32 v121, 9216, v120
    v_add_u32 v122, 18432, v120
    v_add_u32 v123, 27648, v120
    s_lshl_b32 s38, s33, 7
    s_lshl_b32 s39, s35, 5
    s_add_u32 s38, s38, s39
    s_mul_i32 s57, s38, 1280
    s_and_b32 s55, s34, 3
    s_mul_i32 s55, s55, 3
    s_and_b32 s38, s33, 7
    s_add_u32 s55, s55, s38
    s_cmp_ge_u32 s55, 10
    s_cselect_b32 s38, 10, 0
    s_sub_u32 s55, s55, s38
    s_mov_b32 s56, s55
    s_mul_i32 s49, s35, 16384
    s_add_u32 s49, s49, 81920
    s_mov_b32 s10, 2621440
    s_mov_b32 s11, 0x00020000
    s_mov_b32 s14, 2457600
    s_mov_b32 s15, 0x00020000
    v_add_u32 v26, 0, v1
    v_mul_u32_u24 v27, 3277, v26
    v_lshrrev_b32 v27, 16, v27
    v_mul_u32_u24 v28, 20, v27
    v_sub_u32 v28, v26, v28
    v_lshrrev_b32 v29, 1, v28
    v_bfe_u32 v30, v27, 3, 1
    v_xor_b32 v29, v29, v30
    v_cmp_le_u32 vcc, 5, v29
    v_and_b32 v28, 1, v28
    v_mul_u32_u24 v27, 3840, v27
    v_lshl_add_u32 v27, v29, 5, v27
    v_lshl_add_u32 v27, v28, 4, v27
    v_mov_b32 v30, 1120
    v_cndmask_b32 v30, 0, v30, vcc
    v_add_u32 v27, v27, v30
    v_add_u32 v6, 1280, v27
    v_add_u32 v26, 64, v1
    v_mul_u32_u24 v27, 3277, v26
    v_lshrrev_b32 v27, 16, v27
    v_mul_u32_u24 v28, 20, v27
    v_sub_u32 v28, v26, v28
    v_lshrrev_b32 v29, 1, v28
    v_bfe_u32 v30, v27, 3, 1
    v_xor_b32 v29, v29, v30
    v_cmp_le_u32 vcc, 5, v29
    v_and_b32 v28, 1, v28
    v_mul_u32_u24 v27, 3840, v27
    v_lshl_add_u32 v27, v29, 5, v27
    v_lshl_add_u32 v27, v28, 4, v27
    v_mov_b32 v30, 1120
    v_cndmask_b32 v30, 0, v30, vcc
    v_add_u32 v27, v27, v30
    v_add_u32 v7, 256, v27
    s_mul_i32 s58, s35, 61440
    s_mul_i32 s38, s34, 160
    s_add_u32 s58, s58, s38
    s_mul_i32 s54, s35, 5120
    s_waitcnt lgkmcnt(0)
    s_mov_b32 s8, s64
    s_mov_b32 s9, s65
    s_mov_b32 s12, s66
    s_mov_b32 s13, s67
    s_lshl_b32 s36, s56, 7
    s_add_u32 s36, s36, s57
    s_add_u32 m0, s49, 0
    s_mul_i32 s37, s56, 245760
    buffer_load_dwordx4 v120, s[8:11], s36 offen offset:0 lds
    buffer_load_dwordx4 v121, s[8:11], s36 offen offset:1024 lds
    buffer_load_dwordx4 v122, s[8:11], s36 offen offset:2048 lds
    buffer_load_dwordx4 v123, s[8:11], s36 offen offset:3072 lds
    v_add_u32 v26, 128, v1
    v_mul_u32_u24 v27, 3277, v26
    v_lshrrev_b32 v27, 16, v27
    v_mul_u32_u24 v28, 20, v27
    v_sub_u32 v28, v26, v28
    v_lshrrev_b32 v29, 1, v28
    v_bfe_u32 v30, v27, 3, 1
    v_xor_b32 v29, v29, v30
    v_cmp_le_u32 vcc, 5, v29
    v_and_b32 v28, 1, v28
    v_mul_u32_u24 v27, 3840, v27
    v_lshl_add_u32 v27, v29, 5, v27
    v_lshl_add_u32 v27, v28, 4, v27
    v_mov_b32 v30, 1120
    v_cndmask_b32 v30, 0, v30, vcc
    v_add_u32 v27, v27, v30
    v_add_u32 v8, -768, v27
    v_add_u32 v26, 192, v1
    v_mul_u32_u24 v27, 3277, v26
    v_lshrrev_b32 v27, 16, v27
    v_mul_u32_u24 v28, 20, v27
    v_sub_u32 v28, v26, v28
    v_lshrrev_b32 v29, 1, v28
    v_bfe_u32 v30, v27, 3, 1
    v_xor_b32 v29, v29, v30
    v_cmp_le_u32 vcc, 5, v29
    v_and_b32 v28, 1, v28
    v_mul_u32_u24 v27, 3840, v27
    v_lshl_add_u32 v27, v29, 5, v27
    v_lshl_add_u32 v27, v28, 4, v27
    v_mov_b32 v30, 1120
    v_cndmask_b32 v30, 0, v30, vcc
    v_add_u32 v27, v27, v30
    v_add_u32 v9, -1792, v27
    v_add_u32 v26, 256, v1
    v_mul_u32_u24 v27, 3277, v26
    v_lshrrev_b32 v27, 16, v27
    v_mul_u32_u24 v28, 20, v27
    v_sub_u32 v28, v26, v28
    v_lshrrev_b32 v29, 1, v28
    v_bfe_u32 v30, v27, 3, 1
    v_xor_b32 v29, v29, v30
    v_cmp_le_u32 vcc, 5, v29
    v_and_b32 v28, 1, v28
    v_mul_u32_u24 v27, 3840, v27
    v_lshl_add_u32 v27, v29, 5, v27
    v_lshl_add_u32 v27, v28, 4, v27
    v_mov_b32 v30, 1120
    v_cndmask_b32 v30, 0, v30, vcc
    v_add_u32 v27, v27, v30
    v_add_u32 v10, 1280, v27
    s_add_u32 s37, s37, s58
    s_add_u32 s38, s54, 0
    s_mov_b32 m0, s38
    s_nop 0
    buffer_load_dwordx4 v6, s[12:15], s37 offen offset:0 lds
    buffer_load_dwordx4 v7, s[12:15], s37 offen offset:1024 lds
    buffer_load_dwordx4 v8, s[12:15], s37 offen offset:2048 lds
    buffer_load_dwordx4 v9, s[12:15], s37 offen offset:3072 lds
    s_add_u32 m0, m0, 4096
    s_nop 0
    buffer_load_dwordx4 v10, s[12:15], s37 offen lds
    s_add_u32 s56, s56, 1
    s_cmp_eq_u32 s56, 10
    s_cselect_b32 s56, 0, s56
    s_mov_b32 s24, s76
    s_mov_b32 s25, s77
    s_mov_b32 s26, 268435456
    s_mov_b32 s27, 0x00020000
    s_mov_b32 s16, s68
    s_mov_b32 s17, s69
    s_mov_b32 s18, 819200
    s_mov_b32 s19, 0x00020000
    s_mov_b32 s20, s72
    s_mov_b32 s21, s73
    s_mov_b32 s22, 5242880
    s_mov_b32 s23, 0x00020000
    s_mov_b32 s28, s74
    s_mov_b32 s29, s75
    s_mov_b32 s30, 256
    s_mov_b32 s31, 0x00020000
    v_lshrrev_b32 v2, 4, v1
    v_and_b32 v3, 15, v1
    s_lshl_b32 s91, s34, 4
    s_add_u32 s91, s91, s33
    s_and_b32 s59, s35, 1
    s_mul_i32 s59, s59, 122880
    s_mul_i32 s38, s34, 160
    s_add_u32 s59, s59, s38
    s_lshl_b32 s48, s2, 7
    s_add_u32 s48, s48, 131072
    s_mov_b32 s40, 0
    s_getpc_b64 s[44:45]
L_pc:
    s_lshr_b32 s38, s2, 3
    s_lshl_b32 s38, s38, 11
    v_lshlrev_b32 v26, 7, v3
    v_add_u32 v26, s38, v26
    v_min_u32 v26, (L_slow - L_pc), v26
    s_cmp_lg_u32 s35, 2
    s_cbranch_scc1 pf_1
    global_load_dword v125, v26, s[44:45]
pf_1:
    v_lshlrev_b32 v26, 21, v1
    v_min_u32 v26, 13893628, v26
    s_lshr_b32 s38, s2, 3
    s_xor_b32 s38, s38, 31
    s_xor_b32 s39, s35, 3
    s_or_b32 s38, s38, s39
    s_cmp_lg_u32 s38, 0
    s_cbranch_scc1 pt_2
    buffer_load_dword v126, v26, s[24:27], 0 offen
    buffer_load_dword v127, v26, s[20:23], 0 offen
    buffer_load_dword v127, off, s[16:19], 0
pt_2:
    v_lshrrev_b32 v26, 3, v3
    v_lshlrev_b32 v26, 4, v26
    v_and_b32 v27, 7, v3
    v_add_u32 v26, v26, v27
    v_lshlrev_b32 v26, 7, v26
    v_xor_b32 v27, v27, v2
    v_add_u32 v26, s49, v26
    v_lshl_add_u32 v4, v27, 4, v26
    v_xor_b32 v27, 4, v27
    v_lshl_add_u32 v5, v27, 4, v26
    v_bfe_u32 v26, v1, 2, 2
    v_and_b32 v27, 3, v1
    v_lshl_add_u32 v28, v2, 3, v26
    v_mul_u32_u24 v28, 320, v28
    v_lshl_add_u32 v28, v27, 3, v28
    v_and_b32 v29, 1, v2
    v_lshlrev_b32 v29, 5, v29
    v_add_u32 v16, v28, v29
    v_sub_u32 v17, v28, v29
    v_add_u32 v18, 61440, v16
    v_add_u32 v19, 61440, v17
    v_lshrrev_b32 v28, 1, v2
    v_lshlrev_b32 v28, 4, v28
    v_and_b32 v29, 1, v2
    v_lshl_add_u32 v28, v29, 2, v28
    v_add_u32 v28, v28, v26
    v_mul_u32_u24 v28, 160, v28
    v_lshl_add_u32 v20, v27, 3, v28
    v_add_u32 v21, 61440, v20
    v_add_u32 v22, 143360, v20
    s_lshl_b32 s36, s56, 7
    s_add_u32 s36, s36, s57
    s_add_u32 m0, s49, 4096
    s_mul_i32 s37, s56, 245760
    buffer_load_dwordx4 v120, s[8:11], s36 offen offset:0 lds
    buffer_load_dwordx4 v121, s[8:11], s36 offen offset:1024 lds
    buffer_load_dwordx4 v122, s[8:11], s36 offen offset:2048 lds
    buffer_load_dwordx4 v123, s[8:11], s36 offen offset:3072 lds
    s_add_u32 s37, s37, s58
    s_add_u32 s38, s54, 20480
    s_mov_b32 m0, s38
    s_nop 0
    buffer_load_dwordx4 v6, s[12:15], s37 offen offset:0 lds
    buffer_load_dwordx4 v7, s[12:15], s37 offen offset:1024 lds
    buffer_load_dwordx4 v8, s[12:15], s37 offen offset:2048 lds
    buffer_load_dwordx4 v9, s[12:15], s37 offen offset:3072 lds
    s_add_u32 m0, m0, 4096
    s_nop 0
    buffer_load_dwordx4 v10, s[12:15], s37 offen lds
    s_add_u32 s56, s56, 1
    s_cmp_eq_u32 s56, 10
    s_cselect_b32 s56, 0, s56
    s_or_b32 s38, s2, s35
    s_cmp_lg_u32 s38, 0
    s_cbranch_scc1 np_3
    s_mov_b32 s38, 114688
    buffer_load_dword v124, off, s[24:27], s38 sc1
    s_waitcnt vmcnt(0)
    v_add_u32 v124, 1, v124
    v_max_u32 v124, 1, v124
    buffer_store_dword v124, off, s[28:31], 0 sc1
    buffer_store_dword v124, off, s[24:27], s38 sc1
np_3:
    v_add_u32 v26, 0, v1
    v_mul_u32_u24 v27, 6554, v26
    v_lshrrev_b32 v27, 16, v27
    v_mul_u32_u24 v28, 10, v27
    v_sub_u32 v28, v26, v28
    v_and_b32 v29, 0x13, v27
    v_bfe_u32 v30, v27, 2, 1
    v_lshl_or_b32 v29, v30, 3, v29
    v_bfe_u32 v30, v27, 3, 1
    v_lshl_or_b32 v29, v30, 2, v29
    v_mul_u32_u24 v29, 3840, v29
    v_lshl_add_u32 v29, v28, 4, v29
    v_mov_b32 v11, v29
    v_add_u32 v26, 64, v1
    v_mul_u32_u24 v27, 6554, v26
    v_lshrrev_b32 v27, 16, v27
    v_mul_u32_u24 v28, 10, v27
    v_sub_u32 v28, v26, v28
    v_and_b32 v29, 0x13, v27
    v_bfe_u32 v30, v27, 2, 1
    v_lshl_or_b32 v29, v30, 3, v29
    v_bfe_u32 v30, v27, 3, 1
    v_lshl_or_b32 v29, v30, 2, v29
    v_mul_u32_u24 v29, 3840, v29
    v_lshl_add_u32 v29, v28, 4, v29
    v_subrev_u32 v12, 1024, v29
    v_add_u32 v26, 128, v1
    v_mul_u32_u24 v27, 6554, v26
    v_lshrrev_b32 v27, 16, v27
    v_mul_u32_u24 v28, 10, v27
    v_sub_u32 v28, v26, v28
    v_and_b32 v29, 0x13, v27
    v_bfe_u32 v30, v27, 2, 1
    v_lshl_or_b32 v29, v30, 3, v29
    v_bfe_u32 v30, v27, 3, 1
    v_lshl_or_b32 v29, v30, 2, v29
    v_mul_u32_u24 v29, 3840, v29
    v_lshl_add_u32 v29, v28, 4, v29
    v_subrev_u32 v13, 2048, v29
    v_add_u32 v26, 192, v1
    v_mul_u32_u24 v27, 6554, v26
    v_lshrrev_b32 v27, 16, v27
    v_mul_u32_u24 v28, 10, v27
    v_sub_u32 v28, v26, v28
    v_and_b32 v29, 0x13, v27
    v_bfe_u32 v30, v27, 2, 1
    v_lshl_or_b32 v29, v30, 3, v29
    v_bfe_u32 v30, v27, 3, 1
    v_lshl_or_b32 v29, v30, 2, v29
    v_mul_u32_u24 v29, 3840, v29
    v_lshl_add_u32 v29, v28, 4, v29
    v_subrev_u32 v14, 3072, v29
    v_add_u32 v26, 256, v1
    v_mul_u32_u24 v27, 6554, v26
    v_lshrrev_b32 v27, 16, v27
    v_mul_u32_u24 v28, 10, v27
    v_sub_u32 v28, v26, v28
    v_and_b32 v29, 0x13, v27
    v_bfe_u32 v30, v27, 2, 1
    v_lshl_or_b32 v29, v30, 3, v29
    v_bfe_u32 v30, v27, 3, 1
    v_lshl_or_b32 v29, v30, 2, v29
    v_mul_u32_u24 v29, 3840, v29
    v_lshl_add_u32 v29, v28, 4, v29
    v_mov_b32 v15, v29
    v_add_u32 v26, 0, v1
    v_mul_u32_u24 v27, 6554, v26
    v_lshrrev_b32 v27, 16, v27
    v_mul_u32_u24 v28, 10, v27
    v_sub_u32 v28, v26, v28
    v_and_b32 v29, 0x13, v27
    v_bfe_u32 v30, v27, 2, 1
    v_lshl_or_b32 v29, v30, 3, v29
    v_bfe_u32 v30, v27, 3, 1
    v_lshl_or_b32 v29, v30, 2, v29
    v_mul_u32_u24 v29, 1280, v29
    v_lshl_add_u32 v29, v28, 4, v29
    v_mov_b32 v88, v29
    v_add_u32 v26, 64, v1
    v_mul_u32_u24 v27, 6554, v26
    v_lshrrev_b32 v27, 16, v27
    v_mul_u32_u24 v28, 10, v27
    v_sub_u32 v28, v26, v28
    v_and_b32 v29, 0x13, v27
    v_bfe_u32 v30, v27, 2, 1
    v_lshl_or_b32 v29, v30, 3, v29
    v_bfe_u32 v30, v27, 3, 1
    v_lshl_or_b32 v29, v30, 2, v29
    v_mul_u32_u24 v29, 1280, v29
    v_lshl_add_u32 v29, v28, 4, v29
    v_subrev_u32 v89, 1024, v29
    v_add_u32 v26, 128, v1
    v_mul_u32_u24 v27, 6554, v26
    v_lshrrev_b32 v27, 16, v27
    v_mul_u32_u24 v28, 10, v27
    v_sub_u32 v28, v26, v28
    v_and_b32 v29, 0x13, v27
    v_bfe_u32 v30, v27, 2, 1
    v_lshl_or_b32 v29, v30, 3, v29
    v_bfe_u32 v30, v27, 3, 1
    v_lshl_or_b32 v29, v30, 2, v29
    v_mul_u32_u24 v29, 1280, v29
    v_lshl_add_u32 v29, v28, 4, v29
    v_subrev_u32 v90, 2048, v29
    v_add_u32 v26, 192, v1
    v_mul_u32_u24 v27, 6554, v26
    v_lshrrev_b32 v27, 16, v27
    v_mul_u32_u24 v28, 10, v27
    v_sub_u32 v28, v26, v28
    v_and_b32 v29, 0x13, v27
    v_bfe_u32 v30, v27, 2, 1
    v_lshl_or_b32 v29, v30, 3, v29
    v_bfe_u32 v30, v27, 3, 1
    v_lshl_or_b32 v29, v30, 2, v29
    v_mul_u32_u24 v29, 1280, v29
    v_lshl_add_u32 v29, v28, 4, v29
    v_subrev_u32 v91, 3072, v29
    v_add_u32 v26, 256, v1
    v_mul_u32_u24 v27, 6554, v26
    v_lshrrev_b32 v27, 16, v27
    v_mul_u32_u24 v28, 10, v27
    v_sub_u32 v28, v26, v28
    v_and_b32 v29, 0x13, v27
    v_bfe_u32 v30, v27, 2, 1
    v_lshl_or_b32 v29, v30, 3, v29
    v_bfe_u32 v30, v27, 3, 1
    v_lshl_or_b32 v29, v30, 2, v29
    v_mul_u32_u24 v29, 1280, v29
    v_lshl_add_u32 v29, v28, 4, v29
    v_mov_b32 v92, v29
    s_lshr_b32 s38, s33, 3
    s_lshl_b32 s38, s38, 1
    s_lshr_b32 s39, s34, 2
    s_add_u32 s38, s38, s39
    s_lshl_b32 s73, s38, 2
    s_and_b32 s38, s33, 7
    s_lshr_b32 s39, s38, 1
    s_add_u32 s73, s73, s39
    s_and_b32 s38, s33, 1
    s_lshl_b32 s38, s38, 2
    s_and_b32 s74, s34, 3
    s_add_u32 s74, s74, s38
    s_mul_i32 s46, s74, 5
    s_lshr_b32 s38, s74, 2
    s_lshl_b32 s38, s38, 1
    s_add_u32 s46, s46, s38
    s_cmp_ge_u32 s46, 20
    s_cselect_b32 s38, 20, 0
    s_sub_u32 s46, s46, s38
    s_mov_b32 s72, s46
    s_mov_b32 s75, 0
    s_and_b32 s47, s73, 3
    s_add_u32 s47, s47, 0
    s_cmp_ge_u32 s47, 10
    s_cselect_b32 s38, 10, 0
    s_sub_u32 s47, s47, s38
    s_cmp_ge_u32 s47, 5
    s_cselect_b32 s38, 5, 0
    s_sub_u32 s47, s47, s38
    s_lshl_b32 s38, s47, 0
    s_or_b32 s75, s75, s38
    s_lshl_b32 s41, s47, 2
    s_add_u32 s41, s41, s35
    s_add_u32 s41, s41, s46
    s_cmp_ge_u32 s41, 20
    s_cselect_b32 s38, 20, 0
    s_sub_u32 s41, s41, s38
    s_mul_i32 s41, s41, 40960
    s_mul_i32 s38, s74, 160
    s_add_u32 s97, s41, s38
    s_and_b32 s47, s73, 3
    s_add_u32 s47, s47, 1
    s_cmp_ge_u32 s47, 10
    s_cselect_b32 s38, 10, 0
    s_sub_u32 s47, s47, s38
    s_cmp_ge_u32 s47, 5
    s_cselect_b32 s38, 5, 0
    s_sub_u32 s47, s47, s38
    s_lshl_b32 s38, s47, 4
    s_or_b32 s75, s75, s38
    s_lshl_b32 s41, s47, 2
    s_add_u32 s41, s41, s35
    s_add_u32 s41, s41, s46
    s_cmp_ge_u32 s41, 20
    s_cselect_b32 s38, 20, 0
    s_sub_u32 s41, s41, s38
    s_mul_i32 s41, s41, 40960
    s_mul_i32 s38, s74, 160
    s_add_u32 s98, s41, s38
    s_and_b32 s47, s73, 3
    s_add_u32 s47, s47, 2
    s_cmp_ge_u32 s47, 10
    s_cselect_b32 s38, 10, 0
    s_sub_u32 s47, s47, s38
    s_cmp_ge_u32 s47, 5
    s_cselect_b32 s38, 5, 0
    s_sub_u32 s47, s47, s38
    s_lshl_b32 s38, s47, 8
    s_or_b32 s75, s75, s38
    s_lshl_b32 s41, s47, 2
    s_add_u32 s41, s41, s35
    s_add_u32 s41, s41, s46
    s_cmp_ge_u32 s41, 20
    s_cselect_b32 s38, 20, 0
    s_sub_u32 s41, s41, s38
    s_mul_i32 s41, s41, 40960
    s_mul_i32 s38, s74, 160
    s_add_u32 s99, s41, s38
    s_and_b32 s47, s73, 3
    s_add_u32 s47, s47, 3
    s_cmp_ge_u32 s47, 10
    s_cselect_b32 s38, 10, 0
    s_sub_u32 s47, s47, s38
    s_cmp_ge_u32 s47, 5
    s_cselect_b32 s38, 5, 0
    s_sub_u32 s47, s47, s38
    s_lshl_b32 s38, s47, 12
    s_or_b32 s75, s75, s38
    s_lshl_b32 s41, s47, 2
    s_add_u32 s41, s41, s35
    s_add_u32 s41, s41, s46
    s_cmp_ge_u32 s41, 20
    s_cselect_b32 s38, 20, 0
    s_sub_u32 s41, s41, s38
    s_mul_i32 s41, s41, 40960
    s_mul_i32 s38, s74, 160
    s_add_u32 s100, s41, s38
    s_and_b32 s47, s73, 3
    s_add_u32 s47, s47, 4
    s_cmp_ge_u32 s47, 10
    s_cselect_b32 s38, 10, 0
    s_sub_u32 s47, s47, s38
    s_cmp_ge_u32 s47, 5
    s_cselect_b32 s38, 5, 0
    s_sub_u32 s47, s47, s38
    s_lshl_b32 s38, s47, 16
    s_or_b32 s75, s75, s38
    s_lshl_b32 s41, s47, 2
    s_add_u32 s41, s41, s35
    s_add_u32 s41, s41, s46
    s_cmp_ge_u32 s41, 20
    s_cselect_b32 s38, 20, 0
    s_sub_u32 s41, s41, s38
    s_mul_i32 s41, s41, 40960
    s_mul_i32 s38, s74, 160
    s_add_u32 s101, s41, s38
    v_lshlrev_b32 v118, 4, v1
    v_lshrrev_b32 v116, 5, v1
    v_and_b32 v117, 31, v1
    s_lshl_b32 s38, s32, 4
    s_add_u32 s38, s38, s73
    s_lshl_b32 s38, s38, 3
    s_add_u32 s38, s38, 256
    v_and_b32 v26, 7, v1
    v_add_u32 v26, s38, v26
    v_lshlrev_b32 v119, 7, v26
    s_cmp_eq_u32 s32, 1
    s_cbranch_scc1 pb_4
    s_mul_i32 s38, s35, 20
    v_bfe_u32 v26, v1, 2, 2
    v_lshl_add_u32 v27, v116, 3, v26
    v_add_u32 v27, s38, v27
    v_lshlrev_b32 v27, 8, v27
    v_bfe_u32 v28, v1, 4, 1
    v_lshl_add_u32 v27, v28, 5, v27
    v_and_b32 v28, 1, v1
    v_lshl_add_u32 v27, v28, 4, v27
    v_bfe_u32 v28, v1, 1, 1
    v_lshl_add_u32 v27, v28, 3, v27
    v_add_u32 v27, 82432, v27
    v_xor_b32 v28, 0, v26
    v_lshl_add_u32 v112, v28, 6, v27
    v_xor_b32 v28, 1, v26
    v_lshl_add_u32 v113, v28, 6, v27
    v_xor_b32 v28, 2, v26
    v_lshl_add_u32 v114, v28, 6, v27
    v_xor_b32 v28, 3, v26
    v_lshl_add_u32 v115, v28, 6, v27
    v_add_u32 v26, s38, v117
    v_cmp_gt_u32 vcc, 20, v117
    v_mov_b32 v27, 80
    s_nop 0
    v_cndmask_b32 v26, v27, v26, vcc
    v_and_b32 v27, 15, v26
    v_xor_b32 v27, v27, v116
    v_lshlrev_b32 v26, 8, v26
    v_add_u32 v26, 102912, v26
    v_xor_b32 v28, 0, v27
    v_lshl_add_u32 v80, v28, 4, v26
    v_xor_b32 v28, 2, v27
    v_lshl_add_u32 v81, v28, 4, v26
    v_xor_b32 v28, 4, v27
    v_lshl_add_u32 v82, v28, 4, v26
    v_xor_b32 v28, 6, v27
    v_lshl_add_u32 v83, v28, 4, v26
    v_xor_b32 v28, 8, v27
    v_lshl_add_u32 v84, v28, 4, v26
    v_xor_b32 v28, 10, v27
    v_lshl_add_u32 v85, v28, 4, v26
    v_xor_b32 v28, 12, v27
    v_lshl_add_u32 v86, v28, 4, v26
    v_xor_b32 v28, 14, v27
    v_lshl_add_u32 v87, v28, 4, v26
    v_lshlrev_b32 v30, 2, v116
    v_sub_u32 v30, v30, v117
    v_cvt_f32_i32 v30, v30
    v_mov_b32 v31, 0xf1800000
    v_fmaak_f32 v96, v30, v31, 0x80000000
    v_fmaak_f32 v97, v30, v31, 0xf1800000
    v_fmaak_f32 v98, v30, v31, 0xf2000000
    v_fmaak_f32 v99, v30, v31, 0xf2400000
    v_fmaak_f32 v100, v30, v31, 0xf3000000
    v_fmaak_f32 v101, v30, v31, 0xf3100000
    v_fmaak_f32 v102, v30, v31, 0xf3200000
    v_fmaak_f32 v103, v30, v31, 0xf3300000
    v_fmaak_f32 v104, v30, v31, 0xf3800000
    v_fmaak_f32 v105, v30, v31, 0xf3880000
    v_fmaak_f32 v106, v30, v31, 0xf3900000
    v_fmaak_f32 v107, v30, v31, 0xf3980000
    v_fmaak_f32 v108, v30, v31, 0xf3c00000
    v_fmaak_f32 v109, v30, v31, 0xf3c80000
    v_fmaak_f32 v110, v30, v31, 0xf3d00000
    v_fmaak_f32 v111, v30, v31, 0xf3d80000
    v_min_f32 v96, 0, v96
    v_min_f32 v97, 0, v97
    v_min_f32 v98, 0, v98
    v_min_f32 v99, 0, v99
    v_min_f32 v100, 0, v100
    v_min_f32 v101, 0, v101
    v_min_f32 v102, 0, v102
    v_min_f32 v103, 0, v103
    v_min_f32 v104, 0, v104
    v_min_f32 v105, 0, v105
    v_min_f32 v106, 0, v106
    v_min_f32 v107, 0, v107
    v_min_f32 v108, 0, v108
    v_min_f32 v109, 0, v109
    v_min_f32 v110, 0, v110
    v_min_f32 v111, 0, v111
    s_sub_u32 s38, s91, 1
    s_max_u32 s39, s33, 1
    s_min_u32 s39, s39, 2
    s_sub_u32 s39, s39, 1
    v_and_b32 v26, 1, v1
    v_mul_lo_u32 v26, s39, v26
    v_sub_u32 v26, s38, v26
    v_max_i32 v26, 0, v26
    v_lshlrev_b32 v94, 7, v26
    v_and_b32 v26, 3, v3
    v_xor_b32 v26, s35, v26
    v_lshlrev_b32 v26, 6, v26
    v_lshl_add_u32 v26, v2, 4, v26
    v_lshl_add_u32 v26, v3, 8, v26
    v_add_u32 v23, 82432, v26
    s_lshl_b32 s38, s35, 2
    v_add_u32 v26, s38, v2
    v_xor_b32 v26, v26, v3
    v_lshlrev_b32 v26, 4, v26
    v_lshl_add_u32 v26, v3, 8, v26
    v_add_u32 v24, 102912, v26
    v_lshrrev_b32 v26, 3, v3
    v_lshlrev_b32 v26, 4, v26
    v_and_b32 v27, 7, v3
    v_add_u32 v26, v26, v27
    s_lshl_b32 s38, s35, 5
    v_add_u32 v26, s38, v26
    v_mul_u32_u24 v26, 160, v26
    v_lshl_add_u32 v26, v2, 3, v26
    v_add_u32 v93, 143360, v26
    s_branch pe_5
pb_4:
    s_add_u32 s38, s34, 512
    s_lshl_b32 s38, s38, 7
    v_mov_b32 v94, s38
    s_lshl_b32 s38, s34, 4
    s_add_u32 s38, s38, 128
    v_add_u32 v26, s38, v3
    v_lshlrev_b32 v93, 7, v26
    v_mul_u32_u24 v26, 272, v3
    v_lshl_add_u32 v26, v2, 4, v26
    v_add_u32 v24, 82432, v26
    s_lshl_b32 s38, s35, 6
    v_add_u32 v23, s38, v24
    v_add_u32 v98, 256, v0
    v_mul_u32_u24 v26, 13108, v0
    v_lshrrev_b32 v26, 16, v26
    v_mul_u32_u24 v27, 5, v26
    v_sub_u32 v27, v0, v27
    v_mul_u32_u24 v28, 205, v26
    v_lshrrev_b32 v28, 12, v28
    v_subrev_u32 v29, 80, v26
    v_cmp_le_u32 vcc, 80, v26
    s_nop 1
    v_cndmask_b32 v28, v28, v29, vcc
    v_mul_u32_u24 v28, 5, v28
    v_add_u32 v28, v28, v27
    v_and_b32 v29, 0x18, v28
    v_and_b32 v27, 3, v28
    v_lshl_add_u32 v29, v27, 1, v29
    v_bfe_u32 v27, v28, 2, 1
    v_add_u32 v29, v29, v27
    v_mul_u32_u24 v96, 208, v26
    v_lshl_add_u32 v96, v29, 3, v96
    v_mul_u32_u24 v26, 13108, v98
    v_lshrrev_b32 v26, 16, v26
    v_mul_u32_u24 v27, 5, v26
    v_sub_u32 v27, v98, v27
    v_mul_u32_u24 v28, 205, v26
    v_lshrrev_b32 v28, 12, v28
    v_subrev_u32 v29, 80, v26
    v_cmp_le_u32 vcc, 80, v26
    s_nop 1
    v_cndmask_b32 v28, v28, v29, vcc
    v_mul_u32_u24 v28, 5, v28
    v_add_u32 v28, v28, v27
    v_and_b32 v29, 0x18, v28
    v_and_b32 v27, 3, v28
    v_lshl_add_u32 v29, v27, 1, v29
    v_bfe_u32 v27, v28, 2, 1
    v_add_u32 v29, v29, v27
    v_mul_u32_u24 v97, 208, v26
    v_lshl_add_u32 v97, v29, 3, v97
    v_mul_u32_u24 v26, 208, v3
    v_lshl_add_u32 v99, v2, 4, v26
    v_add_u32 v27, 0, v3
    v_mul_u32_u24 v27, 205, v27
    v_lshrrev_b32 v27, 12, v27
    v_mul_u32_u24 v27, 208, v27
    v_lshl_add_u32 v106, v2, 4, v27
    v_add_u32 v27, 16, v3
    v_mul_u32_u24 v27, 205, v27
    v_lshrrev_b32 v27, 12, v27
    v_mul_u32_u24 v27, 208, v27
    v_lshl_add_u32 v107, v2, 4, v27
    v_add_u32 v27, 32, v3
    v_mul_u32_u24 v27, 205, v27
    v_lshrrev_b32 v27, 12, v27
    v_mul_u32_u24 v27, 208, v27
    v_lshl_add_u32 v108, v2, 4, v27
    v_add_u32 v27, 48, v3
    v_mul_u32_u24 v27, 205, v27
    v_lshrrev_b32 v27, 12, v27
    v_mul_u32_u24 v27, 208, v27
    v_lshl_add_u32 v109, v2, 4, v27
    v_add_u32 v27, 64, v3
    v_mul_u32_u24 v27, 205, v27
    v_lshrrev_b32 v27, 12, v27
    v_mul_u32_u24 v27, 208, v27
    v_lshl_add_u32 v110, v2, 4, v27
    v_lshrrev_b32 v100, 3, v3
    s_lshl_b32 s38, s35, 1
    v_add_u32 v100, s38, v100
    v_mul_u32_u24 v100, 2560, v100
    v_lshrrev_b32 v26, 1, v2
    v_lshl_add_u32 v100, v26, 8, v100
    v_and_b32 v26, 7, v3
    v_lshl_add_u32 v100, v26, 4, v100
    v_and_b32 v26, 1, v2
    v_lshl_add_u32 v100, v26, 3, v100
    v_add_u32 v100, 143360, v100
    v_add_u32 v28, 0, v0
    v_mul_u32_u24 v29, 6554, v28
    v_lshrrev_b32 v29, 20, v29
    v_mul_u32_u24 v29, 17920, v29
    v_lshl_add_u32 v101, v28, 4, v29
    v_add_u32 v28, 256, v0
    v_mul_u32_u24 v29, 6554, v28
    v_lshrrev_b32 v29, 20, v29
    v_mul_u32_u24 v29, 17920, v29
    v_lshl_add_u32 v102, v28, 4, v29
    v_add_u32 v28, 512, v0
    v_mul_u32_u24 v29, 6554, v28
    v_lshrrev_b32 v29, 20, v29
    v_mul_u32_u24 v29, 17920, v29
    v_lshl_add_u32 v103, v28, 4, v29
    v_add_u32 v28, 768, v0
    v_mul_u32_u24 v29, 6554, v28
    v_lshrrev_b32 v29, 20, v29
    v_mul_u32_u24 v29, 17920, v29
    v_lshl_add_u32 v104, v28, 4, v29
    v_add_u32 v28, 1024, v0
    v_mul_u32_u24 v29, 6554, v28
    v_lshrrev_b32 v29, 20, v29
    v_mul_u32_u24 v29, 17920, v29
    v_lshl_add_u32 v105, v28, 4, v29
    s_lshl_b32 s89, s32, 4
    s_add_u32 s89, s89, s33
    s_mul_i32 s89, s89, 163840
    s_mul_i32 s90, s34, 2560
    s_add_u32 s89, s89, s90
    s_add_u32 s89, s89, 8650752
pe_5:
    s_waitcnt vmcnt(9)
    s_barrier
    ds_read_b128 a[0:3], v4 offset:0
    ds_read_b128 a[4:7], v4 offset:1024
    ds_read_b128 a[8:11], v5 offset:0
    ds_read_b128 a[12:15], v5 offset:1024
    ds_read_b64_tr_b16 a[160:161], v16 offset:0
    ds_read_b64_tr_b16 a[162:163], v16 offset:1280
    ds_read_b64_tr_b16 a[164:165], v17 offset:32
    ds_read_b64_tr_b16 a[166:167], v17 offset:1312
    ds_read_b64_tr_b16 a[168:169], v16 offset:64
    ds_read_b64_tr_b16 a[170:171], v16 offset:1344
    ds_read_b64_tr_b16 a[172:173], v17 offset:96
    ds_read_b64_tr_b16 a[174:175], v17 offset:1376
    ds_read_b64_tr_b16 a[176:177], v16 offset:128
    ds_read_b64_tr_b16 a[178:179], v16 offset:1408
    ds_read_b64_tr_b16 a[180:181], v17 offset:160
    ds_read_b64_tr_b16 a[182:183], v17 offset:1440
    ds_read_b64_tr_b16 a[184:185], v16 offset:192
    ds_read_b64_tr_b16 a[186:187], v16 offset:1472
    ds_read_b64_tr_b16 a[188:189], v17 offset:224
    ds_read_b64_tr_b16 a[190:191], v17 offset:1504
    ds_read_b64_tr_b16 a[192:193], v16 offset:256
    ds_read_b64_tr_b16 a[194:195], v16 offset:1536
    ds_read_b64_tr_b16 a[196:197], v17 offset:288
    ds_read_b64_tr_b16 a[198:199], v17 offset:1568
    s_waitcnt lgkmcnt(0)
    v_mfma_f32_16x16x32_bf16 v[128:131], a[0:3], a[160:163], 0
    ds_read_b64_tr_b16 a[200:201], v16 offset:10240
    ds_read_b64_tr_b16 a[202:203], v16 offset:11520
    s_lshl_b32 s36, s56, 7
    s_add_u32 s36, s36, s57
    s_add_u32 m0, s49, 8192
    s_mul_i32 s37, s56, 245760
    buffer_load_dwordx4 v120, s[8:11], s36 offen offset:0 lds
    v_mfma_f32_16x16x32_bf16 v[132:135], a[4:7], a[160:163], 0
    ds_read_b64_tr_b16 a[204:205], v17 offset:10272
    ds_read_b64_tr_b16 a[206:207], v17 offset:11552
    v_mfma_f32_16x16x32_bf16 v[136:139], a[0:3], a[164:167], 0
    ds_read_b64_tr_b16 a[208:209], v16 offset:10304
    ds_read_b64_tr_b16 a[210:211], v16 offset:11584
    buffer_load_dwordx4 v121, s[8:11], s36 offen offset:1024 lds
    v_mfma_f32_16x16x32_bf16 v[140:143], a[4:7], a[164:167], 0
    ds_read_b64_tr_b16 a[212:213], v17 offset:10336
    ds_read_b64_tr_b16 a[214:215], v17 offset:11616
    v_mfma_f32_16x16x32_bf16 v[144:147], a[0:3], a[168:171], 0
    ds_read_b64_tr_b16 a[216:217], v16 offset:10368
    ds_read_b64_tr_b16 a[218:219], v16 offset:11648
    v_mfma_f32_16x16x32_bf16 v[148:151], a[4:7], a[168:171], 0
    ds_read_b64_tr_b16 a[220:221], v17 offset:10400
    ds_read_b64_tr_b16 a[222:223], v17 offset:11680
    buffer_load_dwordx4 v122, s[8:11], s36 offen offset:2048 lds
    v_mfma_f32_16x16x32_bf16 v[152:155], a[0:3], a[172:175], 0
    ds_read_b64_tr_b16 a[224:225], v16 offset:10432
    ds_read_b64_tr_b16 a[226:227], v16 offset:11712
    v_mfma_f32_16x16x32_bf16 v[156:159], a[4:7], a[172:175], 0
    ds_read_b64_tr_b16 a[228:229], v17 offset:10464
    ds_read_b64_tr_b16 a[230:231], v17 offset:11744
    buffer_load_dwordx4 v123, s[8:11], s36 offen offset:3072 lds
    v_mfma_f32_16x16x32_bf16 v[160:163], a[0:3], a[176:179], 0
    ds_read_b64_tr_b16 a[232:233], v16 offset:10496
    ds_read_b64_tr_b16 a[234:235], v16 offset:11776
    v_mfma_f32_16x16x32_bf16 v[164:167], a[4:7], a[176:179], 0
    ds_read_b64_tr_b16 a[236:237], v17 offset:10528
    ds_read_b64_tr_b16 a[238:239], v17 offset:11808
    s_add_u32 s37, s37, s58
    s_add_u32 s38, s54, 40960
    s_mov_b32 m0, s38
    s_nop 0
    buffer_load_dwordx4 v6, s[12:15], s37 offen offset:0 lds
    v_mfma_f32_16x16x32_bf16 v[168:171], a[0:3], a[180:183], 0
    v_mfma_f32_16x16x32_bf16 v[172:175], a[4:7], a[180:183], 0
    buffer_load_dwordx4 v7, s[12:15], s37 offen offset:1024 lds
    v_mfma_f32_16x16x32_bf16 v[176:179], a[0:3], a[184:187], 0
    v_mfma_f32_16x16x32_bf16 v[180:183], a[4:7], a[184:187], 0
    v_mfma_f32_16x16x32_bf16 v[184:187], a[0:3], a[188:191], 0
    buffer_load_dwordx4 v8, s[12:15], s37 offen offset:2048 lds
    v_mfma_f32_16x16x32_bf16 v[188:191], a[4:7], a[188:191], 0
    v_mfma_f32_16x16x32_bf16 v[192:195], a[0:3], a[192:195], 0
    buffer_load_dwordx4 v9, s[12:15], s37 offen offset:3072 lds
    v_mfma_f32_16x16x32_bf16 v[196:199], a[4:7], a[192:195], 0
    v_mfma_f32_16x16x32_bf16 v[200:203], a[0:3], a[196:199], 0
    s_add_u32 m0, m0, 4096
    s_nop 0
    buffer_load_dwordx4 v10, s[12:15], s37 offen lds
    s_add_u32 s56, s56, 1
    s_cmp_eq_u32 s56, 10
    s_cselect_b32 s56, 0, s56
    v_mfma_f32_16x16x32_bf16 v[204:207], a[4:7], a[196:199], 0
    s_waitcnt lgkmcnt(0)
    s_waitcnt vmcnt(9)
    s_barrier
    v_mfma_f32_16x16x32_bf16 v[128:131], a[8:11], a[200:203], v[128:131]
    ds_read_b64_tr_b16 a[160:161], v16 offset:20480
    ds_read_b64_tr_b16 a[162:163], v16 offset:21760
    s_lshl_b32 s36, s56, 7
    s_add_u32 s36, s36, s57
    s_add_u32 m0, s49, 12288
    s_mul_i32 s37, s56, 245760
    buffer_load_dwordx4 v120, s[8:11], s36 offen offset:0 lds
    v_mfma_f32_16x16x32_bf16 v[132:135], a[12:15], a[200:203], v[132:135]
    ds_read_b64_tr_b16 a[164:165], v17 offset:20512
    ds_read_b64_tr_b16 a[166:167], v17 offset:21792
    v_mfma_f32_16x16x32_bf16 v[136:139], a[8:11], a[204:207], v[136:139]
    ds_read_b128 a[16:19], v4 offset:4096
    ds_read_b128 a[20:23], v4 offset:5120
    buffer_load_dwordx4 v121, s[8:11], s36 offen offset:1024 lds
    v_mfma_f32_16x16x32_bf16 v[140:143], a[12:15], a[204:207], v[140:143]
    ds_read_b128 a[24:27], v5 offset:4096
    ds_read_b128 a[28:31], v5 offset:5120
    v_mfma_f32_16x16x32_bf16 v[144:147], a[8:11], a[208:211], v[144:147]
    ds_read_b64_tr_b16 a[168:169], v16 offset:20544
    ds_read_b64_tr_b16 a[170:171], v16 offset:21824
    v_mfma_f32_16x16x32_bf16 v[148:151], a[12:15], a[208:211], v[148:151]
    ds_read_b64_tr_b16 a[172:173], v17 offset:20576
    ds_read_b64_tr_b16 a[174:175], v17 offset:21856
    buffer_load_dwordx4 v122, s[8:11], s36 offen offset:2048 lds
    v_mfma_f32_16x16x32_bf16 v[152:155], a[8:11], a[212:215], v[152:155]
    ds_read_b64_tr_b16 a[176:177], v16 offset:20608
    ds_read_b64_tr_b16 a[178:179], v16 offset:21888
    v_mfma_f32_16x16x32_bf16 v[156:159], a[12:15], a[212:215], v[156:159]
    ds_read_b64_tr_b16 a[180:181], v17 offset:20640
    ds_read_b64_tr_b16 a[182:183], v17 offset:21920
    buffer_load_dwordx4 v123, s[8:11], s36 offen offset:3072 lds
    v_mfma_f32_16x16x32_bf16 v[160:163], a[8:11], a[216:219], v[160:163]
    ds_read_b64_tr_b16 a[184:185], v16 offset:20672
    ds_read_b64_tr_b16 a[186:187], v16 offset:21952
    v_mfma_f32_16x16x32_bf16 v[164:167], a[12:15], a[216:219], v[164:167]
    ds_read_b64_tr_b16 a[188:189], v17 offset:20704
    ds_read_b64_tr_b16 a[190:191], v17 offset:21984
    s_add_u32 s37, s37, s58
    s_add_u32 s38, s54, 61440
    s_mov_b32 m0, s38
    s_nop 0
    buffer_load_dwordx4 v6, s[12:15], s37 offen offset:0 lds
    v_mfma_f32_16x16x32_bf16 v[168:171], a[8:11], a[220:223], v[168:171]
    ds_read_b64_tr_b16 a[192:193], v16 offset:20736
    ds_read_b64_tr_b16 a[194:195], v16 offset:22016
    v_mfma_f32_16x16x32_bf16 v[172:175], a[12:15], a[220:223], v[172:175]
    ds_read_b64_tr_b16 a[196:197], v17 offset:20768
    ds_read_b64_tr_b16 a[198:199], v17 offset:22048
    buffer_load_dwordx4 v7, s[12:15], s37 offen offset:1024 lds
    v_mfma_f32_16x16x32_bf16 v[176:179], a[8:11], a[224:227], v[176:179]
    v_mfma_f32_16x16x32_bf16 v[180:183], a[12:15], a[224:227], v[180:183]
    v_mfma_f32_16x16x32_bf16 v[184:187], a[8:11], a[228:231], v[184:187]
    buffer_load_dwordx4 v8, s[12:15], s37 offen offset:2048 lds
    v_mfma_f32_16x16x32_bf16 v[188:191], a[12:15], a[228:231], v[188:191]
    v_mfma_f32_16x16x32_bf16 v[192:195], a[8:11], a[232:235], v[192:195]
    buffer_load_dwordx4 v9, s[12:15], s37 offen offset:3072 lds
    v_mfma_f32_16x16x32_bf16 v[196:199], a[12:15], a[232:235], v[196:199]
    v_mfma_f32_16x16x32_bf16 v[200:203], a[8:11], a[236:239], v[200:203]
    s_add_u32 m0, m0, 4096
    s_nop 0
    buffer_load_dwordx4 v10, s[12:15], s37 offen lds
    s_add_u32 s56, s56, 1
    s_cmp_eq_u32 s56, 10
    s_cselect_b32 s56, 0, s56
    v_mfma_f32_16x16x32_bf16 v[204:207], a[12:15], a[236:239], v[204:207]
    s_waitcnt lgkmcnt(0)
    v_mfma_f32_16x16x32_bf16 v[128:131], a[16:19], a[160:163], v[128:131]
    ds_read_b64_tr_b16 a[200:201], v16 offset:30720
    ds_read_b64_tr_b16 a[202:203], v16 offset:32000
    s_lshl_b32 s36, s56, 7
    s_add_u32 s36, s36, s57
    s_add_u32 m0, s49, 0
    s_mul_i32 s37, s56, 245760
    buffer_load_dwordx4 v120, s[8:11], s36 offen offset:0 lds
    v_mfma_f32_16x16x32_bf16 v[132:135], a[20:23], a[160:163], v[132:135]
    ds_read_b64_tr_b16 a[204:205], v17 offset:30752
    ds_read_b64_tr_b16 a[206:207], v17 offset:32032
    v_mfma_f32_16x16x32_bf16 v[136:139], a[16:19], a[164:167], v[136:139]
    ds_read_b64_tr_b16 a[208:209], v16 offset:30784
    ds_read_b64_tr_b16 a[210:211], v16 offset:32064
    buffer_load_dwordx4 v121, s[8:11], s36 offen offset:1024 lds
    v_mfma_f32_16x16x32_bf16 v[140:143], a[20:23], a[164:167], v[140:143]
    ds_read_b64_tr_b16 a[212:213], v17 offset:30816
    ds_read_b64_tr_b16 a[214:215], v17 offset:32096
    v_mfma_f32_16x16x32_bf16 v[144:147], a[16:19], a[168:171], v[144:147]
    ds_read_b64_tr_b16 a[216:217], v16 offset:30848
    ds_read_b64_tr_b16 a[218:219], v16 offset:32128
    v_mfma_f32_16x16x32_bf16 v[148:151], a[20:23], a[168:171], v[148:151]
    ds_read_b64_tr_b16 a[220:221], v17 offset:30880
    ds_read_b64_tr_b16 a[222:223], v17 offset:32160
    buffer_load_dwordx4 v122, s[8:11], s36 offen offset:2048 lds
    v_mfma_f32_16x16x32_bf16 v[152:155], a[16:19], a[172:175], v[152:155]
    ds_read_b64_tr_b16 a[224:225], v16 offset:30912
    ds_read_b64_tr_b16 a[226:227], v16 offset:32192
    v_mfma_f32_16x16x32_bf16 v[156:159], a[20:23], a[172:175], v[156:159]
    ds_read_b64_tr_b16 a[228:229], v17 offset:30944
    ds_read_b64_tr_b16 a[230:231], v17 offset:32224
    buffer_load_dwordx4 v123, s[8:11], s36 offen offset:3072 lds
    v_mfma_f32_16x16x32_bf16 v[160:163], a[16:19], a[176:179], v[160:163]
    ds_read_b64_tr_b16 a[232:233], v16 offset:30976
    ds_read_b64_tr_b16 a[234:235], v16 offset:32256
    v_mfma_f32_16x16x32_bf16 v[164:167], a[20:23], a[176:179], v[164:167]
    ds_read_b64_tr_b16 a[236:237], v17 offset:31008
    ds_read_b64_tr_b16 a[238:239], v17 offset:32288
    s_add_u32 s37, s37, s58
    s_add_u32 s38, s54, 0
    s_mov_b32 m0, s38
    s_nop 0
    buffer_load_dwordx4 v6, s[12:15], s37 offen offset:0 lds
    v_mfma_f32_16x16x32_bf16 v[168:171], a[16:19], a[180:183], v[168:171]
    v_mfma_f32_16x16x32_bf16 v[172:175], a[20:23], a[180:183], v[172:175]
    buffer_load_dwordx4 v7, s[12:15], s37 offen offset:1024 lds
    v_mfma_f32_16x16x32_bf16 v[176:179], a[16:19], a[184:187], v[176:179]
    v_mfma_f32_16x16x32_bf16 v[180:183], a[20:23], a[184:187], v[180:183]
    v_mfma_f32_16x16x32_bf16 v[184:187], a[16:19], a[188:191], v[184:187]
    buffer_load_dwordx4 v8, s[12:15], s37 offen offset:2048 lds
    v_mfma_f32_16x16x32_bf16 v[188:191], a[20:23], a[188:191], v[188:191]
    v_mfma_f32_16x16x32_bf16 v[192:195], a[16:19], a[192:195], v[192:195]
    buffer_load_dwordx4 v9, s[12:15], s37 offen offset:3072 lds
    v_mfma_f32_16x16x32_bf16 v[196:199], a[20:23], a[192:195], v[196:199]
    v_mfma_f32_16x16x32_bf16 v[200:203], a[16:19], a[196:199], v[200:203]
    s_add_u32 m0, m0, 4096
    s_nop 0
    buffer_load_dwordx4 v10, s[12:15], s37 offen lds
    s_add_u32 s56, s56, 1
    s_cmp_eq_u32 s56, 10
    s_cselect_b32 s56, 0, s56
    v_mfma_f32_16x16x32_bf16 v[204:207], a[20:23], a[196:199], v[204:207]
    s_waitcnt lgkmcnt(0)
    s_waitcnt vmcnt(18)
    s_barrier
    v_mfma_f32_16x16x32_bf16 v[128:131], a[24:27], a[200:203], v[128:131]
    ds_read_b64_tr_b16 a[160:161], v16 offset:40960
    ds_read_b64_tr_b16 a[162:163], v16 offset:42240
    v_mfma_f32_16x16x32_bf16 v[132:135], a[28:31], a[200:203], v[132:135]
    ds_read_b64_tr_b16 a[164:165], v17 offset:40992
    ds_read_b64_tr_b16 a[166:167], v17 offset:42272
    s_lshl_b32 s36, s56, 7
    s_add_u32 s36, s36, s57
    s_add_u32 m0, s49, 4096
    s_mul_i32 s37, s56, 245760
    buffer_load_dwordx4 v120, s[8:11], s36 offen offset:0 lds
    v_mfma_f32_16x16x32_bf16 v[136:139], a[24:27], a[204:207], v[136:139]
    ds_read_b128 a[32:35], v4 offset:8192
    ds_read_b128 a[36:39], v4 offset:9216
    v_mfma_f32_16x16x32_bf16 v[140:143], a[28:31], a[204:207], v[140:143]
    ds_read_b128 a[40:43], v5 offset:8192
    ds_read_b128 a[44:47], v5 offset:9216
    v_mfma_f32_16x16x32_bf16 v[144:147], a[24:27], a[208:211], v[144:147]
    ds_read_b64_tr_b16 a[168:169], v16 offset:41024
    ds_read_b64_tr_b16 a[170:171], v16 offset:42304
    v_mfma_f32_16x16x32_bf16 v[148:151], a[28:31], a[208:211], v[148:151]
    ds_read_b64_tr_b16 a[172:173], v17 offset:41056
    ds_read_b64_tr_b16 a[174:175], v17 offset:42336
    v_mfma_f32_16x16x32_bf16 v[152:155], a[24:27], a[212:215], v[152:155]
    ds_read_b64_tr_b16 a[176:177], v16 offset:41088
    ds_read_b64_tr_b16 a[178:179], v16 offset:42368
    buffer_load_dwordx4 v121, s[8:11], s36 offen offset:1024 lds
    v_mfma_f32_16x16x32_bf16 v[156:159], a[28:31], a[212:215], v[156:159]
    ds_read_b64_tr_b16 a[180:181], v17 offset:41120
    ds_read_b64_tr_b16 a[182:183], v17 offset:42400
    v_mfma_f32_16x16x32_bf16 v[160:163], a[24:27], a[216:219], v[160:163]
    ds_read_b64_tr_b16 a[184:185], v16 offset:41152
    ds_read_b64_tr_b16 a[186:187], v16 offset:42432
    v_mfma_f32_16x16x32_bf16 v[164:167], a[28:31], a[216:219], v[164:167]
    ds_read_b64_tr_b16 a[188:189], v17 offset:41184
    ds_read_b64_tr_b16 a[190:191], v17 offset:42464
    v_mfma_f32_16x16x32_bf16 v[168:171], a[24:27], a[220:223], v[168:171]
    ds_read_b64_tr_b16 a[192:193], v16 offset:41216
    ds_read_b64_tr_b16 a[194:195], v16 offset:42496
    v_mfma_f32_16x16x32_bf16 v[172:175], a[28:31], a[220:223], v[172:175]
    ds_read_b64_tr_b16 a[196:197], v17 offset:41248
    ds_read_b64_tr_b16 a[198:199], v17 offset:42528
    buffer_load_dwordx4 v122, s[8:11], s36 offen offset:2048 lds
    v_mfma_f32_16x16x32_bf16 v[176:179], a[24:27], a[224:227], v[176:179]
    v_mfma_f32_16x16x32_bf16 v[180:183], a[28:31], a[224:227], v[180:183]
    v_mfma_f32_16x16x32_bf16 v[184:187], a[24:27], a[228:231], v[184:187]
    v_mfma_f32_16x16x32_bf16 v[188:191], a[28:31], a[228:231], v[188:191]
    v_mfma_f32_16x16x32_bf16 v[192:195], a[24:27], a[232:235], v[192:195]
    buffer_load_dwordx4 v123, s[8:11], s36 offen offset:3072 lds
    s_add_u32 s37, s37, s58
    s_add_u32 s38, s54, 20480
    s_mov_b32 m0, s38
    v_mfma_f32_16x16x32_bf16 v[196:199], a[28:31], a[232:235], v[196:199]
    v_mfma_f32_16x16x32_bf16 v[200:203], a[24:27], a[236:239], v[200:203]
    v_mfma_f32_16x16x32_bf16 v[204:207], a[28:31], a[236:239], v[204:207]
    s_waitcnt lgkmcnt(0)
    v_mfma_f32_16x16x32_bf16 v[128:131], a[32:35], a[160:163], v[128:131]
    ds_read_b64_tr_b16 a[200:201], v16 offset:51200
    ds_read_b64_tr_b16 a[202:203], v16 offset:52480
    v_mfma_f32_16x16x32_bf16 v[132:135], a[36:39], a[160:163], v[132:135]
    ds_read_b64_tr_b16 a[204:205], v17 offset:51232
    ds_read_b64_tr_b16 a[206:207], v17 offset:52512
    s_nop 0
    buffer_load_dwordx4 v6, s[12:15], s37 offen offset:0 lds
    v_mfma_f32_16x16x32_bf16 v[136:139], a[32:35], a[164:167], v[136:139]
    ds_read_b64_tr_b16 a[208:209], v16 offset:51264
    ds_read_b64_tr_b16 a[210:211], v16 offset:52544
    v_mfma_f32_16x16x32_bf16 v[140:143], a[36:39], a[164:167], v[140:143]
    ds_read_b64_tr_b16 a[212:213], v17 offset:51296
    ds_read_b64_tr_b16 a[214:215], v17 offset:52576
    v_mfma_f32_16x16x32_bf16 v[144:147], a[32:35], a[168:171], v[144:147]
    ds_read_b64_tr_b16 a[216:217], v16 offset:51328
    ds_read_b64_tr_b16 a[218:219], v16 offset:52608
    v_mfma_f32_16x16x32_bf16 v[148:151], a[36:39], a[168:171], v[148:151]
    ds_read_b64_tr_b16 a[220:221], v17 offset:51360
    ds_read_b64_tr_b16 a[222:223], v17 offset:52640
    buffer_load_dwordx4 v7, s[12:15], s37 offen offset:1024 lds
    v_mfma_f32_16x16x32_bf16 v[152:155], a[32:35], a[172:175], v[152:155]
    ds_read_b64_tr_b16 a[224:225], v16 offset:51392
    ds_read_b64_tr_b16 a[226:227], v16 offset:52672
    v_mfma_f32_16x16x32_bf16 v[156:159], a[36:39], a[172:175], v[156:159]
    ds_read_b64_tr_b16 a[228:229], v17 offset:51424
    ds_read_b64_tr_b16 a[230:231], v17 offset:52704
    v_mfma_f32_16x16x32_bf16 v[160:163], a[32:35], a[176:179], v[160:163]
    ds_read_b64_tr_b16 a[232:233], v16 offset:51456
    ds_read_b64_tr_b16 a[234:235], v16 offset:52736
    v_mfma_f32_16x16x32_bf16 v[164:167], a[36:39], a[176:179], v[164:167]
    ds_read_b64_tr_b16 a[236:237], v17 offset:51488
    ds_read_b64_tr_b16 a[238:239], v17 offset:52768
    buffer_load_dwordx4 v8, s[12:15], s37 offen offset:2048 lds
    v_mfma_f32_16x16x32_bf16 v[168:171], a[32:35], a[180:183], v[168:171]
    v_mfma_f32_16x16x32_bf16 v[172:175], a[36:39], a[180:183], v[172:175]
    v_mfma_f32_16x16x32_bf16 v[176:179], a[32:35], a[184:187], v[176:179]
    v_mfma_f32_16x16x32_bf16 v[180:183], a[36:39], a[184:187], v[180:183]
    buffer_load_dwordx4 v9, s[12:15], s37 offen offset:3072 lds
    v_mfma_f32_16x16x32_bf16 v[184:187], a[32:35], a[188:191], v[184:187]
    v_mfma_f32_16x16x32_bf16 v[188:191], a[36:39], a[188:191], v[188:191]
    v_mfma_f32_16x16x32_bf16 v[192:195], a[32:35], a[192:195], v[192:195]
    v_mfma_f32_16x16x32_bf16 v[196:199], a[36:39], a[192:195], v[196:199]
    s_add_u32 m0, m0, 4096
    s_nop 0
    buffer_load_dwordx4 v10, s[12:15], s37 offen lds
    s_add_u32 s56, s56, 1
    s_cmp_eq_u32 s56, 10
    s_cselect_b32 s56, 0, s56
    v_mfma_f32_16x16x32_bf16 v[200:203], a[32:35], a[196:199], v[200:203]
    v_mfma_f32_16x16x32_bf16 v[204:207], a[36:39], a[196:199], v[204:207]
    s_waitcnt lgkmcnt(0)
    s_waitcnt vmcnt(18)
    s_barrier
    v_mfma_f32_16x16x32_bf16 v[128:131], a[40:43], a[200:203], v[128:131]
    ds_read_b64_tr_b16 a[160:161], v18 offset:0
    ds_read_b64_tr_b16 a[162:163], v18 offset:1280
    v_mfma_f32_16x16x32_bf16 v[132:135], a[44:47], a[200:203], v[132:135]
    ds_read_b64_tr_b16 a[164:165], v19 offset:32
    ds_read_b64_tr_b16 a[166:167], v19 offset:1312
    buffer_load_dword v25, off, s[28:31], 0 sc1
    v_mfma_f32_16x16x32_bf16 v[136:139], a[40:43], a[204:207], v[136:139]
    ds_read_b128 a[48:51], v4 offset:12288
    ds_read_b128 a[52:55], v4 offset:13312
    v_mfma_f32_16x16x32_bf16 v[140:143], a[44:47], a[204:207], v[140:143]
    ds_read_b128 a[56:59], v5 offset:12288
    ds_read_b128 a[60:63], v5 offset:13312
    v_mfma_f32_16x16x32_bf16 v[144:147], a[40:43], a[208:211], v[144:147]
    ds_read_b64_tr_b16 a[168:169], v18 offset:64
    ds_read_b64_tr_b16 a[170:171], v18 offset:1344
    v_mfma_f32_16x16x32_bf16 v[148:151], a[44:47], a[208:211], v[148:151]
    ds_read_b64_tr_b16 a[172:173], v19 offset:96
    ds_read_b64_tr_b16 a[174:175], v19 offset:1376
    s_lshl_b32 s36, s56, 7
    s_add_u32 s36, s36, s57
    s_add_u32 m0, s49, 8192
    s_mul_i32 s37, s56, 245760
    buffer_load_dwordx4 v120, s[8:11], s36 offen offset:0 lds
    v_mfma_f32_16x16x32_bf16 v[152:155], a[40:43], a[212:215], v[152:155]
    ds_read_b64_tr_b16 a[176:177], v18 offset:128
    ds_read_b64_tr_b16 a[178:179], v18 offset:1408
    v_mfma_f32_16x16x32_bf16 v[156:159], a[44:47], a[212:215], v[156:159]
    ds_read_b64_tr_b16 a[180:181], v19 offset:160
    ds_read_b64_tr_b16 a[182:183], v19 offset:1440
    v_mfma_f32_16x16x32_bf16 v[160:163], a[40:43], a[216:219], v[160:163]
    ds_read_b64_tr_b16 a[184:185], v18 offset:192
    ds_read_b64_tr_b16 a[186:187], v18 offset:1472
    v_mfma_f32_16x16x32_bf16 v[164:167], a[44:47], a[216:219], v[164:167]
    ds_read_b64_tr_b16 a[188:189], v19 offset:224
    ds_read_b64_tr_b16 a[190:191], v19 offset:1504
    buffer_load_dwordx4 v121, s[8:11], s36 offen offset:1024 lds
    v_mfma_f32_16x16x32_bf16 v[168:171], a[40:43], a[220:223], v[168:171]
    ds_read_b64_tr_b16 a[192:193], v18 offset:256
    ds_read_b64_tr_b16 a[194:195], v18 offset:1536
    v_mfma_f32_16x16x32_bf16 v[172:175], a[44:47], a[220:223], v[172:175]
    ds_read_b64_tr_b16 a[196:197], v19 offset:288
    ds_read_b64_tr_b16 a[198:199], v19 offset:1568
    v_mfma_f32_16x16x32_bf16 v[176:179], a[40:43], a[224:227], v[176:179]
    v_mfma_f32_16x16x32_bf16 v[180:183], a[44:47], a[224:227], v[180:183]
    buffer_load_dwordx4 v122, s[8:11], s36 offen offset:2048 lds
    v_mfma_f32_16x16x32_bf16 v[184:187], a[40:43], a[228:231], v[184:187]
    v_mfma_f32_16x16x32_bf16 v[188:191], a[44:47], a[228:231], v[188:191]
    v_mfma_f32_16x16x32_bf16 v[192:195], a[40:43], a[232:235], v[192:195]
    v_mfma_f32_16x16x32_bf16 v[196:199], a[44:47], a[232:235], v[196:199]
    buffer_load_dwordx4 v123, s[8:11], s36 offen offset:3072 lds
    s_add_u32 s37, s37, s58
    s_add_u32 s38, s54, 40960
    s_mov_b32 m0, s38
    v_mfma_f32_16x16x32_bf16 v[200:203], a[40:43], a[236:239], v[200:203]
    v_mfma_f32_16x16x32_bf16 v[204:207], a[44:47], a[236:239], v[204:207]
    s_waitcnt lgkmcnt(0)
    v_mfma_f32_16x16x32_bf16 v[128:131], a[48:51], a[160:163], v[128:131]
    ds_read_b64_tr_b16 a[200:201], v18 offset:10240
    ds_read_b64_tr_b16 a[202:203], v18 offset:11520
    v_mfma_f32_16x16x32_bf16 v[132:135], a[52:55], a[160:163], v[132:135]
    ds_read_b64_tr_b16 a[204:205], v19 offset:10272
    ds_read_b64_tr_b16 a[206:207], v19 offset:11552
    s_nop 0
    buffer_load_dwordx4 v6, s[12:15], s37 offen offset:0 lds
    v_mfma_f32_16x16x32_bf16 v[136:139], a[48:51], a[164:167], v[136:139]
    ds_read_b64_tr_b16 a[208:209], v18 offset:10304
    ds_read_b64_tr_b16 a[210:211], v18 offset:11584
    v_mfma_f32_16x16x32_bf16 v[140:143], a[52:55], a[164:167], v[140:143]
    ds_read_b64_tr_b16 a[212:213], v19 offset:10336
    ds_read_b64_tr_b16 a[214:215], v19 offset:11616
    v_mfma_f32_16x16x32_bf16 v[144:147], a[48:51], a[168:171], v[144:147]
    ds_read_b64_tr_b16 a[216:217], v18 offset:10368
    ds_read_b64_tr_b16 a[218:219], v18 offset:11648
    v_mfma_f32_16x16x32_bf16 v[148:151], a[52:55], a[168:171], v[148:151]
    ds_read_b64_tr_b16 a[220:221], v19 offset:10400
    ds_read_b64_tr_b16 a[222:223], v19 offset:11680
    buffer_load_dwordx4 v7, s[12:15], s37 offen offset:1024 lds
    v_mfma_f32_16x16x32_bf16 v[152:155], a[48:51], a[172:175], v[152:155]
    ds_read_b64_tr_b16 a[224:225], v18 offset:10432
    ds_read_b64_tr_b16 a[226:227], v18 offset:11712
    v_mfma_f32_16x16x32_bf16 v[156:159], a[52:55], a[172:175], v[156:159]
    ds_read_b64_tr_b16 a[228:229], v19 offset:10464
    ds_read_b64_tr_b16 a[230:231], v19 offset:11744
    v_mfma_f32_16x16x32_bf16 v[160:163], a[48:51], a[176:179], v[160:163]
    ds_read_b64_tr_b16 a[232:233], v18 offset:10496
    ds_read_b64_tr_b16 a[234:235], v18 offset:11776
    v_mfma_f32_16x16x32_bf16 v[164:167], a[52:55], a[176:179], v[164:167]
    ds_read_b64_tr_b16 a[236:237], v19 offset:10528
    ds_read_b64_tr_b16 a[238:239], v19 offset:11808
    buffer_load_dwordx4 v8, s[12:15], s37 offen offset:2048 lds
    v_mfma_f32_16x16x32_bf16 v[168:171], a[48:51], a[180:183], v[168:171]
    v_mfma_f32_16x16x32_bf16 v[172:175], a[52:55], a[180:183], v[172:175]
    v_mfma_f32_16x16x32_bf16 v[176:179], a[48:51], a[184:187], v[176:179]
    v_mfma_f32_16x16x32_bf16 v[180:183], a[52:55], a[184:187], v[180:183]
    buffer_load_dwordx4 v9, s[12:15], s37 offen offset:3072 lds
    v_mfma_f32_16x16x32_bf16 v[184:187], a[48:51], a[188:191], v[184:187]
    v_mfma_f32_16x16x32_bf16 v[188:191], a[52:55], a[188:191], v[188:191]
    v_mfma_f32_16x16x32_bf16 v[192:195], a[48:51], a[192:195], v[192:195]
    v_mfma_f32_16x16x32_bf16 v[196:199], a[52:55], a[192:195], v[196:199]
    s_add_u32 m0, m0, 4096
    s_nop 0
    buffer_load_dwordx4 v10, s[12:15], s37 offen lds
    s_add_u32 s56, s56, 1
    s_cmp_eq_u32 s56, 10
    s_cselect_b32 s56, 0, s56
    v_mfma_f32_16x16x32_bf16 v[200:203], a[48:51], a[196:199], v[200:203]
    v_mfma_f32_16x16x32_bf16 v[204:207], a[52:55], a[196:199], v[204:207]
    s_waitcnt lgkmcnt(0)
    s_waitcnt vmcnt(19)
    s_barrier
    v_mfma_f32_16x16x32_bf16 v[128:131], a[56:59], a[200:203], v[128:131]
    ds_read_b64_tr_b16 a[160:161], v16 offset:0
    ds_read_b64_tr_b16 a[162:163], v16 offset:1280
    v_mfma_f32_16x16x32_bf16 v[132:135], a[60:63], a[200:203], v[132:135]
    ds_read_b64_tr_b16 a[164:165], v17 offset:32
    ds_read_b64_tr_b16 a[166:167], v17 offset:1312
    s_lshl_b32 s36, s56, 7
    s_add_u32 s36, s36, s57
    s_add_u32 m0, s49, 12288
    s_mul_i32 s37, s56, 245760
    buffer_load_dwordx4 v120, s[8:11], s36 offen offset:0 lds
    v_mfma_f32_16x16x32_bf16 v[136:139], a[56:59], a[204:207], v[136:139]
    ds_read_b128 a[64:67], v4 offset:0
    ds_read_b128 a[68:71], v4 offset:1024
    v_mfma_f32_16x16x32_bf16 v[140:143], a[60:63], a[204:207], v[140:143]
    ds_read_b128 a[72:75], v5 offset:0
    ds_read_b128 a[76:79], v5 offset:1024
    v_mfma_f32_16x16x32_bf16 v[144:147], a[56:59], a[208:211], v[144:147]
    ds_read_b64_tr_b16 a[168:169], v16 offset:64
    ds_read_b64_tr_b16 a[170:171], v16 offset:1344
    v_mfma_f32_16x16x32_bf16 v[148:151], a[60:63], a[208:211], v[148:151]
    ds_read_b64_tr_b16 a[172:173], v17 offset:96
    ds_read_b64_tr_b16 a[174:175], v17 offset:1376
    v_mfma_f32_16x16x32_bf16 v[152:155], a[56:59], a[212:215], v[152:155]
    ds_read_b64_tr_b16 a[176:177], v16 offset:128
    ds_read_b64_tr_b16 a[178:179], v16 offset:1408
    buffer_load_dwordx4 v121, s[8:11], s36 offen offset:1024 lds
    v_mfma_f32_16x16x32_bf16 v[156:159], a[60:63], a[212:215], v[156:159]
    ds_read_b64_tr_b16 a[180:181], v17 offset:160
    ds_read_b64_tr_b16 a[182:183], v17 offset:1440
    v_mfma_f32_16x16x32_bf16 v[160:163], a[56:59], a[216:219], v[160:163]
    ds_read_b64_tr_b16 a[184:185], v16 offset:192
    ds_read_b64_tr_b16 a[186:187], v16 offset:1472
    v_mfma_f32_16x16x32_bf16 v[164:167], a[60:63], a[216:219], v[164:167]
    ds_read_b64_tr_b16 a[188:189], v17 offset:224
    ds_read_b64_tr_b16 a[190:191], v17 offset:1504
    v_mfma_f32_16x16x32_bf16 v[168:171], a[56:59], a[220:223], v[168:171]
    ds_read_b64_tr_b16 a[192:193], v16 offset:256
    ds_read_b64_tr_b16 a[194:195], v16 offset:1536
    v_mfma_f32_16x16x32_bf16 v[172:175], a[60:63], a[220:223], v[172:175]
    ds_read_b64_tr_b16 a[196:197], v17 offset:288
    ds_read_b64_tr_b16 a[198:199], v17 offset:1568
    buffer_load_dwordx4 v122, s[8:11], s36 offen offset:2048 lds
    v_mfma_f32_16x16x32_bf16 v[176:179], a[56:59], a[224:227], v[176:179]
    v_mfma_f32_16x16x32_bf16 v[180:183], a[60:63], a[224:227], v[180:183]
    v_mfma_f32_16x16x32_bf16 v[184:187], a[56:59], a[228:231], v[184:187]
    v_mfma_f32_16x16x32_bf16 v[188:191], a[60:63], a[228:231], v[188:191]
    v_mfma_f32_16x16x32_bf16 v[192:195], a[56:59], a[232:235], v[192:195]
    buffer_load_dwordx4 v123, s[8:11], s36 offen offset:3072 lds
    s_add_u32 s37, s37, s58
    s_add_u32 s38, s54, 61440
    s_mov_b32 m0, s38
    v_mfma_f32_16x16x32_bf16 v[196:199], a[60:63], a[232:235], v[196:199]
    v_mfma_f32_16x16x32_bf16 v[200:203], a[56:59], a[236:239], v[200:203]
    v_mfma_f32_16x16x32_bf16 v[204:207], a[60:63], a[236:239], v[204:207]
    s_waitcnt lgkmcnt(0)
    v_mfma_f32_16x16x32_bf16 v[128:131], a[64:67], a[160:163], v[128:131]
    ds_read_b64_tr_b16 a[200:201], v16 offset:10240
    ds_read_b64_tr_b16 a[202:203], v16 offset:11520
    v_mfma_f32_16x16x32_bf16 v[132:135], a[68:71], a[160:163], v[132:135]
    ds_read_b64_tr_b16 a[204:205], v17 offset:10272
    ds_read_b64_tr_b16 a[206:207], v17 offset:11552
    s_nop 0
    buffer_load_dwordx4 v6, s[12:15], s37 offen offset:0 lds
    v_mfma_f32_16x16x32_bf16 v[136:139], a[64:67], a[164:167], v[136:139]
    ds_read_b64_tr_b16 a[208:209], v16 offset:10304
    ds_read_b64_tr_b16 a[210:211], v16 offset:11584
    v_mfma_f32_16x16x32_bf16 v[140:143], a[68:71], a[164:167], v[140:143]
    ds_read_b64_tr_b16 a[212:213], v17 offset:10336
    ds_read_b64_tr_b16 a[214:215], v17 offset:11616
    v_mfma_f32_16x16x32_bf16 v[144:147], a[64:67], a[168:171], v[144:147]
    ds_read_b64_tr_b16 a[216:217], v16 offset:10368
    ds_read_b64_tr_b16 a[218:219], v16 offset:11648
    v_mfma_f32_16x16x32_bf16 v[148:151], a[68:71], a[168:171], v[148:151]
    ds_read_b64_tr_b16 a[220:221], v17 offset:10400
    ds_read_b64_tr_b16 a[222:223], v17 offset:11680
    buffer_load_dwordx4 v7, s[12:15], s37 offen offset:1024 lds
    v_mfma_f32_16x16x32_bf16 v[152:155], a[64:67], a[172:175], v[152:155]
    ds_read_b64_tr_b16 a[224:225], v16 offset:10432
    ds_read_b64_tr_b16 a[226:227], v16 offset:11712
    v_mfma_f32_16x16x32_bf16 v[156:159], a[68:71], a[172:175], v[156:159]
    ds_read_b64_tr_b16 a[228:229], v17 offset:10464
    ds_read_b64_tr_b16 a[230:231], v17 offset:11744
    v_mfma_f32_16x16x32_bf16 v[160:163], a[64:67], a[176:179], v[160:163]
    ds_read_b64_tr_b16 a[232:233], v16 offset:10496
    ds_read_b64_tr_b16 a[234:235], v16 offset:11776
    v_mfma_f32_16x16x32_bf16 v[164:167], a[68:71], a[176:179], v[164:167]
    ds_read_b64_tr_b16 a[236:237], v17 offset:10528
    ds_read_b64_tr_b16 a[238:239], v17 offset:11808
    buffer_load_dwordx4 v8, s[12:15], s37 offen offset:2048 lds
    v_mfma_f32_16x16x32_bf16 v[168:171], a[64:67], a[180:183], v[168:171]
    v_mfma_f32_16x16x32_bf16 v[172:175], a[68:71], a[180:183], v[172:175]
    v_mfma_f32_16x16x32_bf16 v[176:179], a[64:67], a[184:187], v[176:179]
    v_mfma_f32_16x16x32_bf16 v[180:183], a[68:71], a[184:187], v[180:183]
    buffer_load_dwordx4 v9, s[12:15], s37 offen offset:3072 lds
    v_mfma_f32_16x16x32_bf16 v[184:187], a[64:67], a[188:191], v[184:187]
    v_mfma_f32_16x16x32_bf16 v[188:191], a[68:71], a[188:191], v[188:191]
    v_mfma_f32_16x16x32_bf16 v[192:195], a[64:67], a[192:195], v[192:195]
    v_mfma_f32_16x16x32_bf16 v[196:199], a[68:71], a[192:195], v[196:199]
    s_add_u32 m0, m0, 4096
    s_nop 0
    buffer_load_dwordx4 v10, s[12:15], s37 offen lds
    s_add_u32 s56, s56, 1
    s_cmp_eq_u32 s56, 10
    s_cselect_b32 s56, 0, s56
    v_mfma_f32_16x16x32_bf16 v[200:203], a[64:67], a[196:199], v[200:203]
    v_mfma_f32_16x16x32_bf16 v[204:207], a[68:71], a[196:199], v[204:207]
    s_waitcnt lgkmcnt(0)
    s_waitcnt vmcnt(19)
    s_barrier
    v_mfma_f32_16x16x32_bf16 v[128:131], a[72:75], a[200:203], v[128:131]
    ds_read_b64_tr_b16 a[160:161], v16 offset:20480
    ds_read_b64_tr_b16 a[162:163], v16 offset:21760
    v_mfma_f32_16x16x32_bf16 v[132:135], a[76:79], a[200:203], v[132:135]
    ds_read_b64_tr_b16 a[164:165], v17 offset:20512
    ds_read_b64_tr_b16 a[166:167], v17 offset:21792
    s_lshl_b32 s36, s56, 7
    s_add_u32 s36, s36, s57
    s_add_u32 m0, s49, 0
    s_mul_i32 s37, s56, 245760
    buffer_load_dwordx4 v120, s[8:11], s36 offen offset:0 lds
    v_mfma_f32_16x16x32_bf16 v[136:139], a[72:75], a[204:207], v[136:139]
    ds_read_b128 a[80:83], v4 offset:4096
    ds_read_b128 a[84:87], v4 offset:5120
    v_mfma_f32_16x16x32_bf16 v[140:143], a[76:79], a[204:207], v[140:143]
    ds_read_b128 a[88:91], v5 offset:4096
    ds_read_b128 a[92:95], v5 offset:5120
    v_mfma_f32_16x16x32_bf16 v[144:147], a[72:75], a[208:211], v[144:147]
    ds_read_b64_tr_b16 a[168:169], v16 offset:20544
    ds_read_b64_tr_b16 a[170:171], v16 offset:21824
    v_mfma_f32_16x16x32_bf16 v[148:151], a[76:79], a[208:211], v[148:151]
    ds_read_b64_tr_b16 a[172:173], v17 offset:20576
    ds_read_b64_tr_b16 a[174:175], v17 offset:21856
    v_mfma_f32_16x16x32_bf16 v[152:155], a[72:75], a[212:215], v[152:155]
    ds_read_b64_tr_b16 a[176:177], v16 offset:20608
    ds_read_b64_tr_b16 a[178:179], v16 offset:21888
    buffer_load_dwordx4 v121, s[8:11], s36 offen offset:1024 lds
    v_mfma_f32_16x16x32_bf16 v[156:159], a[76:79], a[212:215], v[156:159]
    ds_read_b64_tr_b16 a[180:181], v17 offset:20640
    ds_read_b64_tr_b16 a[182:183], v17 offset:21920
    v_mfma_f32_16x16x32_bf16 v[160:163], a[72:75], a[216:219], v[160:163]
    ds_read_b64_tr_b16 a[184:185], v16 offset:20672
    ds_read_b64_tr_b16 a[186:187], v16 offset:21952
    v_mfma_f32_16x16x32_bf16 v[164:167], a[76:79], a[216:219], v[164:167]
    ds_read_b64_tr_b16 a[188:189], v17 offset:20704
    ds_read_b64_tr_b16 a[190:191], v17 offset:21984
    v_mfma_f32_16x16x32_bf16 v[168:171], a[72:75], a[220:223], v[168:171]
    ds_read_b64_tr_b16 a[192:193], v16 offset:20736
    ds_read_b64_tr_b16 a[194:195], v16 offset:22016
    v_mfma_f32_16x16x32_bf16 v[172:175], a[76:79], a[220:223], v[172:175]
    ds_read_b64_tr_b16 a[196:197], v17 offset:20768
    ds_read_b64_tr_b16 a[198:199], v17 offset:22048
    buffer_load_dwordx4 v122, s[8:11], s36 offen offset:2048 lds
    v_mfma_f32_16x16x32_bf16 v[176:179], a[72:75], a[224:227], v[176:179]
    v_mfma_f32_16x16x32_bf16 v[180:183], a[76:79], a[224:227], v[180:183]
    v_mfma_f32_16x16x32_bf16 v[184:187], a[72:75], a[228:231], v[184:187]
    v_mfma_f32_16x16x32_bf16 v[188:191], a[76:79], a[228:231], v[188:191]
    v_mfma_f32_16x16x32_bf16 v[192:195], a[72:75], a[232:235], v[192:195]
    buffer_load_dwordx4 v123, s[8:11], s36 offen offset:3072 lds
    s_add_u32 s37, s37, s58
    s_add_u32 s38, s54, 0
    s_mov_b32 m0, s38
    v_mfma_f32_16x16x32_bf16 v[196:199], a[76:79], a[232:235], v[196:199]
    v_mfma_f32_16x16x32_bf16 v[200:203], a[72:75], a[236:239], v[200:203]
    v_mfma_f32_16x16x32_bf16 v[204:207], a[76:79], a[236:239], v[204:207]
    s_waitcnt lgkmcnt(0)
    v_mfma_f32_16x16x32_bf16 v[128:131], a[80:83], a[160:163], v[128:131]
    ds_read_b64_tr_b16 a[200:201], v16 offset:30720
    ds_read_b64_tr_b16 a[202:203], v16 offset:32000
    v_mfma_f32_16x16x32_bf16 v[132:135], a[84:87], a[160:163], v[132:135]
    ds_read_b64_tr_b16 a[204:205], v17 offset:30752
    ds_read_b64_tr_b16 a[206:207], v17 offset:32032
    s_nop 0
    buffer_load_dwordx4 v6, s[12:15], s37 offen offset:0 lds
    v_mfma_f32_16x16x32_bf16 v[136:139], a[80:83], a[164:167], v[136:139]
    ds_read_b64_tr_b16 a[208:209], v16 offset:30784
    ds_read_b64_tr_b16 a[210:211], v16 offset:32064
    v_mfma_f32_16x16x32_bf16 v[140:143], a[84:87], a[164:167], v[140:143]
    ds_read_b64_tr_b16 a[212:213], v17 offset:30816
    ds_read_b64_tr_b16 a[214:215], v17 offset:32096
    v_mfma_f32_16x16x32_bf16 v[144:147], a[80:83], a[168:171], v[144:147]
    ds_read_b64_tr_b16 a[216:217], v16 offset:30848
    ds_read_b64_tr_b16 a[218:219], v16 offset:32128
    v_mfma_f32_16x16x32_bf16 v[148:151], a[84:87], a[168:171], v[148:151]
    ds_read_b64_tr_b16 a[220:221], v17 offset:30880
    ds_read_b64_tr_b16 a[222:223], v17 offset:32160
    buffer_load_dwordx4 v7, s[12:15], s37 offen offset:1024 lds
    v_mfma_f32_16x16x32_bf16 v[152:155], a[80:83], a[172:175], v[152:155]
    ds_read_b64_tr_b16 a[224:225], v16 offset:30912
    ds_read_b64_tr_b16 a[226:227], v16 offset:32192
    v_mfma_f32_16x16x32_bf16 v[156:159], a[84:87], a[172:175], v[156:159]
    ds_read_b64_tr_b16 a[228:229], v17 offset:30944
    ds_read_b64_tr_b16 a[230:231], v17 offset:32224
    v_mfma_f32_16x16x32_bf16 v[160:163], a[80:83], a[176:179], v[160:163]
    ds_read_b64_tr_b16 a[232:233], v16 offset:30976
    ds_read_b64_tr_b16 a[234:235], v16 offset:32256
    v_mfma_f32_16x16x32_bf16 v[164:167], a[84:87], a[176:179], v[164:167]
    ds_read_b64_tr_b16 a[236:237], v17 offset:31008
    ds_read_b64_tr_b16 a[238:239], v17 offset:32288
    buffer_load_dwordx4 v8, s[12:15], s37 offen offset:2048 lds
    v_mfma_f32_16x16x32_bf16 v[168:171], a[80:83], a[180:183], v[168:171]
    v_mfma_f32_16x16x32_bf16 v[172:175], a[84:87], a[180:183], v[172:175]
    v_mfma_f32_16x16x32_bf16 v[176:179], a[80:83], a[184:187], v[176:179]
    v_mfma_f32_16x16x32_bf16 v[180:183], a[84:87], a[184:187], v[180:183]
    buffer_load_dwordx4 v9, s[12:15], s37 offen offset:3072 lds
    v_mfma_f32_16x16x32_bf16 v[184:187], a[80:83], a[188:191], v[184:187]
    v_mfma_f32_16x16x32_bf16 v[188:191], a[84:87], a[188:191], v[188:191]
    v_mfma_f32_16x16x32_bf16 v[192:195], a[80:83], a[192:195], v[192:195]
    v_mfma_f32_16x16x32_bf16 v[196:199], a[84:87], a[192:195], v[196:199]
    s_add_u32 m0, m0, 4096
    s_nop 0
    buffer_load_dwordx4 v10, s[12:15], s37 offen lds
    s_add_u32 s56, s56, 1
    s_cmp_eq_u32 s56, 10
    s_cselect_b32 s56, 0, s56
    v_mfma_f32_16x16x32_bf16 v[200:203], a[80:83], a[196:199], v[200:203]
    v_mfma_f32_16x16x32_bf16 v[204:207], a[84:87], a[196:199], v[204:207]
    s_waitcnt lgkmcnt(0)
    s_waitcnt vmcnt(18)
    s_barrier
    s_mov_b32 s60, 0
nn_6:
    v_readfirstlane_b32 s40, v25
    s_nop 3
    s_cmp_lg_u32 s40, 0
    s_cbranch_scc1 nok_7
    s_add_u32 s60, s60, 1
    s_cmp_lt_u32 s60, 20000
    s_cbranch_scc0 nok_7
    s_sleep 1
    buffer_load_dword v25, off, s[28:31], 0 sc1
    s_waitcnt vmcnt(0)
    s_branch nn_6
nok_7:
    s_xor_b32 s38, s32, 1
    s_or_b32 s38, s38, s33
    s_cmp_lg_u32 s38, 0
    s_cbranch_scc1 za_8
    v_mov_b32 v30, 0
    v_mov_b32 v31, 0
    v_mov_b32 v32, 0
    v_mov_b32 v33, 0
    v_lshlrev_b32 v26, 4, v0
    s_lshl_b32 s38, s34, 13
    s_add_u32 s38, s38, 6291456
    buffer_store_dwordx4 v[30:33], v26, s[24:27], s38 offen sc1
    s_add_u32 s38, s38, 4096
    buffer_store_dwordx4 v[30:33], v26, s[24:27], s38 offen sc1
za_8:
    v_mfma_f32_16x16x32_bf16 v[128:131], a[88:91], a[200:203], v[128:131]
    ds_read_b64_tr_b16 a[160:161], v16 offset:40960
    ds_read_b64_tr_b16 a[162:163], v16 offset:42240
    v_mfma_f32_16x16x32_bf16 v[132:135], a[92:95], a[200:203], v[132:135]
    ds_read_b64_tr_b16 a[164:165], v17 offset:40992
    ds_read_b64_tr_b16 a[166:167], v17 offset:42272
    s_lshl_b32 s36, s56, 7
    s_add_u32 s36, s36, s57
    s_add_u32 m0, s49, 4096
    s_mul_i32 s37, s56, 245760
    buffer_load_dwordx4 v120, s[8:11], s36 offen offset:0 lds
    v_mfma_f32_16x16x32_bf16 v[136:139], a[88:91], a[204:207], v[136:139]
    ds_read_b128 a[96:99], v4 offset:8192
    ds_read_b128 a[100:103], v4 offset:9216
    v_mfma_f32_16x16x32_bf16 v[140:143], a[92:95], a[204:207], v[140:143]
    ds_read_b128 a[104:107], v5 offset:8192
    ds_read_b128 a[108:111], v5 offset:9216
    v_mfma_f32_16x16x32_bf16 v[144:147], a[88:91], a[208:211], v[144:147]
    ds_read_b64_tr_b16 a[168:169], v16 offset:41024
    ds_read_b64_tr_b16 a[170:171], v16 offset:42304
    v_mfma_f32_16x16x32_bf16 v[148:151], a[92:95], a[208:211], v[148:151]
    ds_read_b64_tr_b16 a[172:173], v17 offset:41056
    ds_read_b64_tr_b16 a[174:175], v17 offset:42336
    v_mfma_f32_16x16x32_bf16 v[152:155], a[88:91], a[212:215], v[152:155]
    ds_read_b64_tr_b16 a[176:177], v16 offset:41088
    ds_read_b64_tr_b16 a[178:179], v16 offset:42368
    buffer_load_dwordx4 v121, s[8:11], s36 offen offset:1024 lds
    v_mfma_f32_16x16x32_bf16 v[156:159], a[92:95], a[212:215], v[156:159]
    ds_read_b64_tr_b16 a[180:181], v17 offset:41120
    ds_read_b64_tr_b16 a[182:183], v17 offset:42400
    v_mfma_f32_16x16x32_bf16 v[160:163], a[88:91], a[216:219], v[160:163]
    ds_read_b64_tr_b16 a[184:185], v16 offset:41152
    ds_read_b64_tr_b16 a[186:187], v16 offset:42432
    v_mfma_f32_16x16x32_bf16 v[164:167], a[92:95], a[216:219], v[164:167]
    ds_read_b64_tr_b16 a[188:189], v17 offset:41184
    ds_read_b64_tr_b16 a[190:191], v17 offset:42464
    v_mfma_f32_16x16x32_bf16 v[168:171], a[88:91], a[220:223], v[168:171]
    ds_read_b64_tr_b16 a[192:193], v16 offset:41216
    ds_read_b64_tr_b16 a[194:195], v16 offset:42496
    v_mfma_f32_16x16x32_bf16 v[172:175], a[92:95], a[220:223], v[172:175]
    ds_read_b64_tr_b16 a[196:197], v17 offset:41248
    ds_read_b64_tr_b16 a[198:199], v17 offset:42528
    buffer_load_dwordx4 v122, s[8:11], s36 offen offset:2048 lds
    v_mfma_f32_16x16x32_bf16 v[176:179], a[88:91], a[224:227], v[176:179]
    v_mfma_f32_16x16x32_bf16 v[180:183], a[92:95], a[224:227], v[180:183]
    v_mfma_f32_16x16x32_bf16 v[184:187], a[88:91], a[228:231], v[184:187]
    v_mfma_f32_16x16x32_bf16 v[188:191], a[92:95], a[228:231], v[188:191]
    v_mfma_f32_16x16x32_bf16 v[192:195], a[88:91], a[232:235], v[192:195]
    buffer_load_dwordx4 v123, s[8:11], s36 offen offset:3072 lds
    s_add_u32 s37, s37, s58
    s_add_u32 s38, s54, 20480
    s_mov_b32 m0, s38
    v_mfma_f32_16x16x32_bf16 v[196:199], a[92:95], a[232:235], v[196:199]
    v_mfma_f32_16x16x32_bf16 v[200:203], a[88:91], a[236:239], v[200:203]
    v_mfma_f32_16x16x32_bf16 v[204:207], a[92:95], a[236:239], v[204:207]
    s_waitcnt lgkmcnt(0)
    v_mfma_f32_16x16x32_bf16 v[128:131], a[96:99], a[160:163], v[128:131]
    ds_read_b64_tr_b16 a[200:201], v16 offset:51200
    ds_read_b64_tr_b16 a[202:203], v16 offset:52480
    v_mfma_f32_16x16x32_bf16 v[132:135], a[100:103], a[160:163], v[132:135]
    ds_read_b64_tr_b16 a[204:205], v17 offset:51232
    ds_read_b64_tr_b16 a[206:207], v17 offset:52512
    s_nop 0
    buffer_load_dwordx4 v6, s[12:15], s37 offen offset:0 lds
    v_mfma_f32_16x16x32_bf16 v[136:139], a[96:99], a[164:167], v[136:139]
    ds_read_b64_tr_b16 a[208:209], v16 offset:51264
    ds_read_b64_tr_b16 a[210:211], v16 offset:52544
    v_mfma_f32_16x16x32_bf16 v[140:143], a[100:103], a[164:167], v[140:143]
    ds_read_b64_tr_b16 a[212:213], v17 offset:51296
    ds_read_b64_tr_b16 a[214:215], v17 offset:52576
    v_mfma_f32_16x16x32_bf16 v[144:147], a[96:99], a[168:171], v[144:147]
    ds_read_b64_tr_b16 a[216:217], v16 offset:51328
    ds_read_b64_tr_b16 a[218:219], v16 offset:52608
    v_mfma_f32_16x16x32_bf16 v[148:151], a[100:103], a[168:171], v[148:151]
    ds_read_b64_tr_b16 a[220:221], v17 offset:51360
    ds_read_b64_tr_b16 a[222:223], v17 offset:52640
    buffer_load_dwordx4 v7, s[12:15], s37 offen offset:1024 lds
    v_mfma_f32_16x16x32_bf16 v[152:155], a[96:99], a[172:175], v[152:155]
    ds_read_b64_tr_b16 a[224:225], v16 offset:51392
    ds_read_b64_tr_b16 a[226:227], v16 offset:52672
    v_mfma_f32_16x16x32_bf16 v[156:159], a[100:103], a[172:175], v[156:159]
    ds_read_b64_tr_b16 a[228:229], v17 offset:51424
    ds_read_b64_tr_b16 a[230:231], v17 offset:52704
    v_mfma_f32_16x16x32_bf16 v[160:163], a[96:99], a[176:179], v[160:163]
    ds_read_b64_tr_b16 a[232:233], v16 offset:51456
    ds_read_b64_tr_b16 a[234:235], v16 offset:52736
    v_mfma_f32_16x16x32_bf16 v[164:167], a[100:103], a[176:179], v[164:167]
    ds_read_b64_tr_b16 a[236:237], v17 offset:51488
    ds_read_b64_tr_b16 a[238:239], v17 offset:52768
    buffer_load_dwordx4 v8, s[12:15], s37 offen offset:2048 lds
    v_mfma_f32_16x16x32_bf16 v[168:171], a[96:99], a[180:183], v[168:171]
    v_mfma_f32_16x16x32_bf16 v[172:175], a[100:103], a[180:183], v[172:175]
    v_mfma_f32_16x16x32_bf16 v[176:179], a[96:99], a[184:187], v[176:179]
    v_mfma_f32_16x16x32_bf16 v[180:183], a[100:103], a[184:187], v[180:183]
    buffer_load_dwordx4 v9, s[12:15], s37 offen offset:3072 lds
    v_mfma_f32_16x16x32_bf16 v[184:187], a[96:99], a[188:191], v[184:187]
    v_mfma_f32_16x16x32_bf16 v[188:191], a[100:103], a[188:191], v[188:191]
    v_mfma_f32_16x16x32_bf16 v[192:195], a[96:99], a[192:195], v[192:195]
    v_mfma_f32_16x16x32_bf16 v[196:199], a[100:103], a[192:195], v[196:199]
    s_add_u32 m0, m0, 4096
    s_nop 0
    buffer_load_dwordx4 v10, s[12:15], s37 offen lds
    s_add_u32 s56, s56, 1
    s_cmp_eq_u32 s56, 10
    s_cselect_b32 s56, 0, s56
    v_mfma_f32_16x16x32_bf16 v[200:203], a[96:99], a[196:199], v[200:203]
    v_mfma_f32_16x16x32_bf16 v[204:207], a[100:103], a[196:199], v[204:207]
    s_waitcnt lgkmcnt(0)
    s_waitcnt vmcnt(18)
    s_barrier
    v_mfma_f32_16x16x32_bf16 v[128:131], a[104:107], a[200:203], v[128:131]
    ds_read_b64_tr_b16 a[160:161], v18 offset:0
    ds_read_b64_tr_b16 a[162:163], v18 offset:1280
    v_mfma_f32_16x16x32_bf16 v[132:135], a[108:111], a[200:203], v[132:135]
    ds_read_b64_tr_b16 a[164:165], v19 offset:32
    ds_read_b64_tr_b16 a[166:167], v19 offset:1312
    v_mfma_f32_16x16x32_bf16 v[136:139], a[104:107], a[204:207], v[136:139]
    ds_read_b128 a[112:115], v4 offset:12288
    ds_read_b128 a[116:119], v4 offset:13312
    v_mfma_f32_16x16x32_bf16 v[140:143], a[108:111], a[204:207], v[140:143]
    ds_read_b128 a[120:123], v5 offset:12288
    ds_read_b128 a[124:127], v5 offset:13312
    v_mfma_f32_16x16x32_bf16 v[144:147], a[104:107], a[208:211], v[144:147]
    ds_read_b64_tr_b16 a[168:169], v18 offset:64
    ds_read_b64_tr_b16 a[170:171], v18 offset:1344
    v_mfma_f32_16x16x32_bf16 v[148:151], a[108:111], a[208:211], v[148:151]
    ds_read_b64_tr_b16 a[172:173], v19 offset:96
    ds_read_b64_tr_b16 a[174:175], v19 offset:1376
    v_mfma_f32_16x16x32_bf16 v[152:155], a[104:107], a[212:215], v[152:155]
    ds_read_b64_tr_b16 a[176:177], v18 offset:128
    ds_read_b64_tr_b16 a[178:179], v18 offset:1408
    s_lshr_b32 s41, s35, 1
    s_add_u32 s41, s41, s55
    s_add_u32 s41, s41, 0
    s_cmp_ge_u32 s41, 10
    s_cselect_b32 s38, 10, 0
    s_sub_u32 s41, s41, s38
    s_mul_i32 s41, s41, 245760
    s_add_u32 s41, s41, s59
    s_add_u32 s38, s54, 40960
    v_mfma_f32_16x16x32_bf16 v[156:159], a[108:111], a[212:215], v[156:159]
    ds_read_b64_tr_b16 a[180:181], v19 offset:160
    ds_read_b64_tr_b16 a[182:183], v19 offset:1440
    v_mfma_f32_16x16x32_bf16 v[160:163], a[104:107], a[216:219], v[160:163]
    ds_read_b64_tr_b16 a[184:185], v18 offset:192
    ds_read_b64_tr_b16 a[186:187], v18 offset:1472
    v_mfma_f32_16x16x32_bf16 v[164:167], a[108:111], a[216:219], v[164:167]
    ds_read_b64_tr_b16 a[188:189], v19 offset:224
    ds_read_b64_tr_b16 a[190:191], v19 offset:1504
    v_mfma_f32_16x16x32_bf16 v[168:171], a[104:107], a[220:223], v[168:171]
    ds_read_b64_tr_b16 a[192:193], v18 offset:256
    ds_read_b64_tr_b16 a[194:195], v18 offset:1536
    v_mfma_f32_16x16x32_bf16 v[172:175], a[108:111], a[220:223], v[172:175]
    ds_read_b64_tr_b16 a[196:197], v19 offset:288
    ds_read_b64_tr_b16 a[198:199], v19 offset:1568
    v_mfma_f32_16x16x32_bf16 v[176:179], a[104:107], a[224:227], v[176:179]
    v_mfma_f32_16x16x32_bf16 v[180:183], a[108:111], a[224:227], v[180:183]
    v_mfma_f32_16x16x32_bf16 v[184:187], a[104:107], a[228:231], v[184:187]
    v_mfma_f32_16x16x32_bf16 v[188:191], a[108:111], a[228:231], v[188:191]
    v_mfma_f32_16x16x32_bf16 v[192:195], a[104:107], a[232:235], v[192:195]
    v_mfma_f32_16x16x32_bf16 v[196:199], a[108:111], a[232:235], v[196:199]
    v_mfma_f32_16x16x32_bf16 v[200:203], a[104:107], a[236:239], v[200:203]
    v_mfma_f32_16x16x32_bf16 v[204:207], a[108:111], a[236:239], v[204:207]
    s_waitcnt lgkmcnt(0)
    v_mfma_f32_16x16x32_bf16 v[128:131], a[112:115], a[160:163], v[128:131]
    ds_read_b64_tr_b16 a[200:201], v18 offset:10240
    ds_read_b64_tr_b16 a[202:203], v18 offset:11520
    v_mfma_f32_16x16x32_bf16 v[132:135], a[116:119], a[160:163], v[132:135]
    ds_read_b64_tr_b16 a[204:205], v19 offset:10272
    ds_read_b64_tr_b16 a[206:207], v19 offset:11552
    s_mov_b32 m0, s38
    s_nop 0
    buffer_load_dwordx4 v11, s[12:15], s41 offen offset:0 lds
    v_mfma_f32_16x16x32_bf16 v[136:139], a[112:115], a[164:167], v[136:139]
    ds_read_b64_tr_b16 a[208:209], v18 offset:10304
    ds_read_b64_tr_b16 a[210:211], v18 offset:11584
    v_mfma_f32_16x16x32_bf16 v[140:143], a[116:119], a[164:167], v[140:143]
    ds_read_b64_tr_b16 a[212:213], v19 offset:10336
    ds_read_b64_tr_b16 a[214:215], v19 offset:11616
    v_mfma_f32_16x16x32_bf16 v[144:147], a[112:115], a[168:171], v[144:147]
    ds_read_b64_tr_b16 a[216:217], v18 offset:10368
    ds_read_b64_tr_b16 a[218:219], v18 offset:11648
    v_mfma_f32_16x16x32_bf16 v[148:151], a[116:119], a[168:171], v[148:151]
    ds_read_b64_tr_b16 a[220:221], v19 offset:10400
    ds_read_b64_tr_b16 a[222:223], v19 offset:11680
    buffer_load_dwordx4 v12, s[12:15], s41 offen offset:1024 lds
    v_mfma_f32_16x16x32_bf16 v[152:155], a[112:115], a[172:175], v[152:155]
    ds_read_b64_tr_b16 a[224:225], v18 offset:10432
    ds_read_b64_tr_b16 a[226:227], v18 offset:11712
    v_mfma_f32_16x16x32_bf16 v[156:159], a[116:119], a[172:175], v[156:159]
    ds_read_b64_tr_b16 a[228:229], v19 offset:10464
    ds_read_b64_tr_b16 a[230:231], v19 offset:11744
    v_mfma_f32_16x16x32_bf16 v[160:163], a[112:115], a[176:179], v[160:163]
    ds_read_b64_tr_b16 a[232:233], v18 offset:10496
    ds_read_b64_tr_b16 a[234:235], v18 offset:11776
    v_mfma_f32_16x16x32_bf16 v[164:167], a[116:119], a[176:179], v[164:167]
    ds_read_b64_tr_b16 a[236:237], v19 offset:10528
    ds_read_b64_tr_b16 a[238:239], v19 offset:11808
    buffer_load_dwordx4 v13, s[12:15], s41 offen offset:2048 lds
    v_mfma_f32_16x16x32_bf16 v[168:171], a[112:115], a[180:183], v[168:171]
    v_mfma_f32_16x16x32_bf16 v[172:175], a[116:119], a[180:183], v[172:175]
    v_mfma_f32_16x16x32_bf16 v[176:179], a[112:115], a[184:187], v[176:179]
    v_mfma_f32_16x16x32_bf16 v[180:183], a[116:119], a[184:187], v[180:183]
    buffer_load_dwordx4 v14, s[12:15], s41 offen offset:3072 lds
    v_mfma_f32_16x16x32_bf16 v[184:187], a[112:115], a[188:191], v[184:187]
    v_mfma_f32_16x16x32_bf16 v[188:191], a[116:119], a[188:191], v[188:191]
    v_mfma_f32_16x16x32_bf16 v[192:195], a[112:115], a[192:195], v[192:195]
    v_mfma_f32_16x16x32_bf16 v[196:199], a[116:119], a[192:195], v[196:199]
    s_add_u32 m0, m0, 4096
    s_nop 0
    buffer_load_dwordx4 v15, s[12:15], s41 offen lds
    v_mfma_f32_16x16x32_bf16 v[200:203], a[112:115], a[196:199], v[200:203]
    v_mfma_f32_16x16x32_bf16 v[204:207], a[116:119], a[196:199], v[204:207]
    s_waitcnt lgkmcnt(0)
    s_waitcnt vmcnt(14)
    s_barrier
    v_mfma_f32_16x16x32_bf16 v[128:131], a[120:123], a[200:203], v[128:131]
    ds_read_b64_tr_b16 a[160:161], v16 offset:0
    ds_read_b64_tr_b16 a[162:163], v16 offset:1280
    v_mfma_f32_16x16x32_bf16 v[132:135], a[124:127], a[200:203], v[132:135]
    ds_read_b64_tr_b16 a[164:165], v17 offset:32
    ds_read_b64_tr_b16 a[166:167], v17 offset:1312
    s_lshr_b32 s41, s35, 1
    s_add_u32 s41, s41, s55
    s_add_u32 s41, s41, 2
    s_cmp_ge_u32 s41, 10
    s_cselect_b32 s38, 10, 0
    s_sub_u32 s41, s41, s38
    s_mul_i32 s41, s41, 245760
    s_add_u32 s41, s41, s59
    s_add_u32 s38, s54, 61440
    s_mov_b32 m0, s38
    s_nop 0
    buffer_load_dwordx4 v11, s[12:15], s41 offen offset:0 lds
    v_mfma_f32_16x16x32_bf16 v[136:139], a[120:123], a[204:207], v[136:139]
    ds_read_b128 a[128:131], v4 offset:0
    ds_read_b128 a[132:135], v4 offset:1024
    v_mfma_f32_16x16x32_bf16 v[140:143], a[124:127], a[204:207], v[140:143]
    ds_read_b128 a[136:139], v5 offset:0
    ds_read_b128 a[140:143], v5 offset:1024
    v_mfma_f32_16x16x32_bf16 v[144:147], a[120:123], a[208:211], v[144:147]
    ds_read_b64_tr_b16 a[168:169], v16 offset:64
    ds_read_b64_tr_b16 a[170:171], v16 offset:1344
    v_mfma_f32_16x16x32_bf16 v[148:151], a[124:127], a[208:211], v[148:151]
    ds_read_b64_tr_b16 a[172:173], v17 offset:96
    ds_read_b64_tr_b16 a[174:175], v17 offset:1376
    buffer_load_dwordx4 v12, s[12:15], s41 offen offset:1024 lds
    v_mfma_f32_16x16x32_bf16 v[152:155], a[120:123], a[212:215], v[152:155]
    ds_read_b64_tr_b16 a[176:177], v16 offset:128
    ds_read_b64_tr_b16 a[178:179], v16 offset:1408
    v_mfma_f32_16x16x32_bf16 v[156:159], a[124:127], a[212:215], v[156:159]
    ds_read_b64_tr_b16 a[180:181], v17 offset:160
    ds_read_b64_tr_b16 a[182:183], v17 offset:1440
    v_mfma_f32_16x16x32_bf16 v[160:163], a[120:123], a[216:219], v[160:163]
    ds_read_b64_tr_b16 a[184:185], v16 offset:192
    ds_read_b64_tr_b16 a[186:187], v16 offset:1472
    v_mfma_f32_16x16x32_bf16 v[164:167], a[124:127], a[216:219], v[164:167]
    ds_read_b64_tr_b16 a[188:189], v17 offset:224
    ds_read_b64_tr_b16 a[190:191], v17 offset:1504
    buffer_load_dwordx4 v13, s[12:15], s41 offen offset:2048 lds
    v_mfma_f32_16x16x32_bf16 v[168:171], a[120:123], a[220:223], v[168:171]
    ds_read_b64_tr_b16 a[192:193], v16 offset:256
    ds_read_b64_tr_b16 a[194:195], v16 offset:1536
    v_mfma_f32_16x16x32_bf16 v[172:175], a[124:127], a[220:223], v[172:175]
    ds_read_b64_tr_b16 a[196:197], v17 offset:288
    ds_read_b64_tr_b16 a[198:199], v17 offset:1568
    v_mfma_f32_16x16x32_bf16 v[176:179], a[120:123], a[224:227], v[176:179]
    v_mfma_f32_16x16x32_bf16 v[180:183], a[124:127], a[224:227], v[180:183]
    buffer_load_dwordx4 v14, s[12:15], s41 offen offset:3072 lds
    v_mfma_f32_16x16x32_bf16 v[184:187], a[120:123], a[228:231], v[184:187]
    v_mfma_f32_16x16x32_bf16 v[188:191], a[124:127], a[228:231], v[188:191]
    v_mfma_f32_16x16x32_bf16 v[192:195], a[120:123], a[232:235], v[192:195]
    v_mfma_f32_16x16x32_bf16 v[196:199], a[124:127], a[232:235], v[196:199]
    s_add_u32 m0, m0, 4096
    s_nop 0
    buffer_load_dwordx4 v15, s[12:15], s41 offen lds
    v_mfma_f32_16x16x32_bf16 v[200:203], a[120:123], a[236:239], v[200:203]
    v_mfma_f32_16x16x32_bf16 v[204:207], a[124:127], a[236:239], v[204:207]
    s_waitcnt lgkmcnt(0)
    v_mfma_f32_16x16x32_bf16 v[128:131], a[128:131], a[160:163], v[128:131]
    ds_read_b64_tr_b16 a[200:201], v16 offset:10240
    ds_read_b64_tr_b16 a[202:203], v16 offset:11520
    v_mfma_f32_16x16x32_bf16 v[132:135], a[132:135], a[160:163], v[132:135]
    ds_read_b64_tr_b16 a[204:205], v17 offset:10272
    ds_read_b64_tr_b16 a[206:207], v17 offset:11552
    s_lshr_b32 s41, s35, 1
    s_add_u32 s41, s41, s55
    s_add_u32 s41, s41, 4
    s_cmp_ge_u32 s41, 10
    s_cselect_b32 s38, 10, 0
    s_sub_u32 s41, s41, s38
    s_mul_i32 s41, s41, 245760
    s_add_u32 s41, s41, s59
    s_add_u32 s38, s54, 143360
    s_mov_b32 m0, s38
    s_nop 0
    buffer_load_dwordx4 v11, s[12:15], s41 offen offset:0 lds
    v_mfma_f32_16x16x32_bf16 v[136:139], a[128:131], a[164:167], v[136:139]
    ds_read_b64_tr_b16 a[208:209], v16 offset:10304
    ds_read_b64_tr_b16 a[210:211], v16 offset:11584
    v_mfma_f32_16x16x32_bf16 v[140:143], a[132:135], a[164:167], v[140:143]
    ds_read_b64_tr_b16 a[212:213], v17 offset:10336
    ds_read_b64_tr_b16 a[214:215], v17 offset:11616
    v_mfma_f32_16x16x32_bf16 v[144:147], a[128:131], a[168:171], v[144:147]
    ds_read_b64_tr_b16 a[216:217], v16 offset:10368
    ds_read_b64_tr_b16 a[218:219], v16 offset:11648
    v_mfma_f32_16x16x32_bf16 v[148:151], a[132:135], a[168:171], v[148:151]
    ds_read_b64_tr_b16 a[220:221], v17 offset:10400
    ds_read_b64_tr_b16 a[222:223], v17 offset:11680
    buffer_load_dwordx4 v12, s[12:15], s41 offen offset:1024 lds
    v_mfma_f32_16x16x32_bf16 v[152:155], a[128:131], a[172:175], v[152:155]
    ds_read_b64_tr_b16 a[224:225], v16 offset:10432
    ds_read_b64_tr_b16 a[226:227], v16 offset:11712
    v_mfma_f32_16x16x32_bf16 v[156:159], a[132:135], a[172:175], v[156:159]
    ds_read_b64_tr_b16 a[228:229], v17 offset:10464
    ds_read_b64_tr_b16 a[230:231], v17 offset:11744
    v_mfma_f32_16x16x32_bf16 v[160:163], a[128:131], a[176:179], v[160:163]
    ds_read_b64_tr_b16 a[232:233], v16 offset:10496
    ds_read_b64_tr_b16 a[234:235], v16 offset:11776
    v_mfma_f32_16x16x32_bf16 v[164:167], a[132:135], a[176:179], v[164:167]
    ds_read_b64_tr_b16 a[236:237], v17 offset:10528
    ds_read_b64_tr_b16 a[238:239], v17 offset:11808
    buffer_load_dwordx4 v13, s[12:15], s41 offen offset:2048 lds
    v_mfma_f32_16x16x32_bf16 v[168:171], a[128:131], a[180:183], v[168:171]
    v_mfma_f32_16x16x32_bf16 v[172:175], a[132:135], a[180:183], v[172:175]
    v_mfma_f32_16x16x32_bf16 v[176:179], a[128:131], a[184:187], v[176:179]
    v_mfma_f32_16x16x32_bf16 v[180:183], a[132:135], a[184:187], v[180:183]
    buffer_load_dwordx4 v14, s[12:15], s41 offen offset:3072 lds
    v_mfma_f32_16x16x32_bf16 v[184:187], a[128:131], a[188:191], v[184:187]
    v_mfma_f32_16x16x32_bf16 v[188:191], a[132:135], a[188:191], v[188:191]
    v_mfma_f32_16x16x32_bf16 v[192:195], a[128:131], a[192:195], v[192:195]
    v_mfma_f32_16x16x32_bf16 v[196:199], a[132:135], a[192:195], v[196:199]
    s_add_u32 m0, m0, 4096
    s_nop 0
    buffer_load_dwordx4 v15, s[12:15], s41 offen lds
    v_mfma_f32_16x16x32_bf16 v[200:203], a[128:131], a[196:199], v[200:203]
    v_mfma_f32_16x16x32_bf16 v[204:207], a[132:135], a[196:199], v[204:207]
    s_waitcnt lgkmcnt(0)
    s_waitcnt vmcnt(15)
    s_barrier
    s_xor_b32 s38, s32, 1
    s_or_b32 s38, s38, s33
    s_cmp_lg_u32 s38, 0
    s_cbranch_scc1 zf_9
    s_cmp_lg_u32 s35, 0
    s_cbranch_scc1 fl_10
    s_add_u32 s38, s34, 512
    s_lshl_b32 s38, s38, 7
    v_mov_b32 v124, s40
    buffer_store_dword v124, off, s[24:27], s38 sc1
fl_10:
zf_9:
    v_mfma_f32_16x16x32_bf16 v[128:131], a[136:139], a[200:203], v[128:131]
    ds_read_b64_tr_b16 a[160:161], v16 offset:20480
    ds_read_b64_tr_b16 a[162:163], v16 offset:21760
    v_mfma_f32_16x16x32_bf16 v[132:135], a[140:143], a[200:203], v[132:135]
    ds_read_b64_tr_b16 a[164:165], v17 offset:20512
    ds_read_b64_tr_b16 a[166:167], v17 offset:21792
    v_mfma_f32_16x16x32_bf16 v[136:139], a[136:139], a[204:207], v[136:139]
    ds_read_b128 a[144:147], v4 offset:4096
    ds_read_b128 a[148:151], v4 offset:5120
    v_mfma_f32_16x16x32_bf16 v[140:143], a[140:143], a[204:207], v[140:143]
    ds_read_b128 a[152:155], v5 offset:4096
    ds_read_b128 a[156:159], v5 offset:5120
    v_mfma_f32_16x16x32_bf16 v[144:147], a[136:139], a[208:211], v[144:147]
    ds_read_b64_tr_b16 a[168:169], v16 offset:20544
    ds_read_b64_tr_b16 a[170:171], v16 offset:21824
    v_mfma_f32_16x16x32_bf16 v[148:151], a[140:143], a[208:211], v[148:151]
    ds_read_b64_tr_b16 a[172:173], v17 offset:20576
    ds_read_b64_tr_b16 a[174:175], v17 offset:21856
    v_mfma_f32_16x16x32_bf16 v[152:155], a[136:139], a[212:215], v[152:155]
    ds_read_b64_tr_b16 a[176:177], v16 offset:20608
    ds_read_b64_tr_b16 a[178:179], v16 offset:21888
    s_lshr_b32 s41, s35, 1
    s_add_u32 s41, s41, s55
    s_add_u32 s41, s41, 6
    s_cmp_ge_u32 s41, 10
    s_cselect_b32 s38, 10, 0
    s_sub_u32 s41, s41, s38
    s_mul_i32 s41, s41, 245760
    s_add_u32 s41, s41, s59
    s_add_u32 s38, s54, 0
    v_mfma_f32_16x16x32_bf16 v[156:159], a[140:143], a[212:215], v[156:159]
    ds_read_b64_tr_b16 a[180:181], v17 offset:20640
    ds_read_b64_tr_b16 a[182:183], v17 offset:21920
    v_mfma_f32_16x16x32_bf16 v[160:163], a[136:139], a[216:219], v[160:163]
    ds_read_b64_tr_b16 a[184:185], v16 offset:20672
    ds_read_b64_tr_b16 a[186:187], v16 offset:21952
    v_mfma_f32_16x16x32_bf16 v[164:167], a[140:143], a[216:219], v[164:167]
    ds_read_b64_tr_b16 a[188:189], v17 offset:20704
    ds_read_b64_tr_b16 a[190:191], v17 offset:21984
    v_mfma_f32_16x16x32_bf16 v[168:171], a[136:139], a[220:223], v[168:171]
    ds_read_b64_tr_b16 a[192:193], v16 offset:20736
    ds_read_b64_tr_b16 a[194:195], v16 offset:22016
    v_mfma_f32_16x16x32_bf16 v[172:175], a[140:143], a[220:223], v[172:175]
    ds_read_b64_tr_b16 a[196:197], v17 offset:20768
    ds_read_b64_tr_b16 a[198:199], v17 offset:22048
    v_mfma_f32_16x16x32_bf16 v[176:179], a[136:139], a[224:227], v[176:179]
    v_mfma_f32_16x16x32_bf16 v[180:183], a[140:143], a[224:227], v[180:183]
    v_mfma_f32_16x16x32_bf16 v[184:187], a[136:139], a[228:231], v[184:187]
    v_mfma_f32_16x16x32_bf16 v[188:191], a[140:143], a[228:231], v[188:191]
    v_mfma_f32_16x16x32_bf16 v[192:195], a[136:139], a[232:235], v[192:195]
    v_mfma_f32_16x16x32_bf16 v[196:199], a[140:143], a[232:235], v[196:199]
    v_mfma_f32_16x16x32_bf16 v[200:203], a[136:139], a[236:239], v[200:203]
    v_mfma_f32_16x16x32_bf16 v[204:207], a[140:143], a[236:239], v[204:207]
    s_waitcnt lgkmcnt(0)
    v_mfma_f32_16x16x32_bf16 v[128:131], a[144:147], a[160:163], v[128:131]
    ds_read_b64_tr_b16 a[200:201], v16 offset:30720
    ds_read_b64_tr_b16 a[202:203], v16 offset:32000
    v_mfma_f32_16x16x32_bf16 v[132:135], a[148:151], a[160:163], v[132:135]
    ds_read_b64_tr_b16 a[204:205], v17 offset:30752
    ds_read_b64_tr_b16 a[206:207], v17 offset:32032
    s_mov_b32 m0, s38
    s_nop 0
    buffer_load_dwordx4 v11, s[12:15], s41 offen offset:0 lds
    v_mfma_f32_16x16x32_bf16 v[136:139], a[144:147], a[164:167], v[136:139]
    ds_read_b64_tr_b16 a[208:209], v16 offset:30784
    ds_read_b64_tr_b16 a[210:211], v16 offset:32064
    v_mfma_f32_16x16x32_bf16 v[140:143], a[148:151], a[164:167], v[140:143]
    ds_read_b64_tr_b16 a[212:213], v17 offset:30816
    ds_read_b64_tr_b16 a[214:215], v17 offset:32096
    v_mfma_f32_16x16x32_bf16 v[144:147], a[144:147], a[168:171], v[144:147]
    ds_read_b64_tr_b16 a[216:217], v16 offset:30848
    ds_read_b64_tr_b16 a[218:219], v16 offset:32128
    v_mfma_f32_16x16x32_bf16 v[148:151], a[148:151], a[168:171], v[148:151]
    ds_read_b64_tr_b16 a[220:221], v17 offset:30880
    ds_read_b64_tr_b16 a[222:223], v17 offset:32160
    buffer_load_dwordx4 v12, s[12:15], s41 offen offset:1024 lds
    v_mfma_f32_16x16x32_bf16 v[152:155], a[144:147], a[172:175], v[152:155]
    ds_read_b64_tr_b16 a[224:225], v16 offset:30912
    ds_read_b64_tr_b16 a[226:227], v16 offset:32192
    v_mfma_f32_16x16x32_bf16 v[156:159], a[148:151], a[172:175], v[156:159]
    ds_read_b64_tr_b16 a[228:229], v17 offset:30944
    ds_read_b64_tr_b16 a[230:231], v17 offset:32224
    v_mfma_f32_16x16x32_bf16 v[160:163], a[144:147], a[176:179], v[160:163]
    ds_read_b64_tr_b16 a[232:233], v16 offset:30976
    ds_read_b64_tr_b16 a[234:235], v16 offset:32256
    v_mfma_f32_16x16x32_bf16 v[164:167], a[148:151], a[176:179], v[164:167]
    ds_read_b64_tr_b16 a[236:237], v17 offset:31008
    ds_read_b64_tr_b16 a[238:239], v17 offset:32288
    buffer_load_dwordx4 v13, s[12:15], s41 offen offset:2048 lds
    v_mfma_f32_16x16x32_bf16 v[168:171], a[144:147], a[180:183], v[168:171]
    v_mfma_f32_16x16x32_bf16 v[172:175], a[148:151], a[180:183], v[172:175]
    v_mfma_f32_16x16x32_bf16 v[176:179], a[144:147], a[184:187], v[176:179]
    v_mfma_f32_16x16x32_bf16 v[180:183], a[148:151], a[184:187], v[180:183]
    buffer_load_dwordx4 v14, s[12:15], s41 offen offset:3072 lds
    v_mfma_f32_16x16x32_bf16 v[184:187], a[144:147], a[188:191], v[184:187]
    v_mfma_f32_16x16x32_bf16 v[188:191], a[148:151], a[188:191], v[188:191]
    v_mfma_f32_16x16x32_bf16 v[192:195], a[144:147], a[192:195], v[192:195]
    v_mfma_f32_16x16x32_bf16 v[196:199], a[148:151], a[192:195], v[196:199]
    s_add_u32 m0, m0, 4096
    s_nop 0
    buffer_load_dwordx4 v15, s[12:15], s41 offen lds
    v_mfma_f32_16x16x32_bf16 v[200:203], a[144:147], a[196:199], v[200:203]
    v_mfma_f32_16x16x32_bf16 v[204:207], a[148:151], a[196:199], v[204:207]
    s_waitcnt lgkmcnt(0)
    s_waitcnt vmcnt(15)
    s_barrier
    v_mfma_f32_16x16x32_bf16 v[128:131], a[152:155], a[200:203], v[128:131]
    s_lshr_b32 s41, s35, 1
    s_add_u32 s41, s41, s55
    s_add_u32 s41, s41, 8
    s_cmp_ge_u32 s41, 10
    s_cselect_b32 s38, 10, 0
    s_sub_u32 s41, s41, s38
    s_mul_i32 s41, s41, 245760
    s_add_u32 s41, s41, s59
    s_add_u32 s38, s54, 20480
    s_mov_b32 m0, s38
    s_nop 0
    buffer_load_dwordx4 v11, s[12:15], s41 offen offset:0 lds
    v_mfma_f32_16x16x32_bf16 v[132:135], a[156:159], a[200:203], v[132:135]
    v_mfma_f32_16x16x32_bf16 v[136:139], a[152:155], a[204:207], v[136:139]
    v_mfma_f32_16x16x32_bf16 v[140:143], a[156:159], a[204:207], v[140:143]
    buffer_load_dwordx4 v12, s[12:15], s41 offen offset:1024 lds
    v_mfma_f32_16x16x32_bf16 v[144:147], a[152:155], a[208:211], v[144:147]
    v_mfma_f32_16x16x32_bf16 v[148:151], a[156:159], a[208:211], v[148:151]
    v_mfma_f32_16x16x32_bf16 v[152:155], a[152:155], a[212:215], v[152:155]
    buffer_load_dwordx4 v13, s[12:15], s41 offen offset:2048 lds
    v_mfma_f32_16x16x32_bf16 v[156:159], a[156:159], a[212:215], v[156:159]
    v_mfma_f32_16x16x32_bf16 v[160:163], a[152:155], a[216:219], v[160:163]
    v_mfma_f32_16x16x32_bf16 v[164:167], a[156:159], a[216:219], v[164:167]
    buffer_load_dwordx4 v14, s[12:15], s41 offen offset:3072 lds
    v_mfma_f32_16x16x32_bf16 v[168:171], a[152:155], a[220:223], v[168:171]
    v_mfma_f32_16x16x32_bf16 v[172:175], a[156:159], a[220:223], v[172:175]
    v_mfma_f32_16x16x32_bf16 v[176:179], a[152:155], a[224:227], v[176:179]
    s_add_u32 m0, m0, 4096
    s_nop 0
    buffer_load_dwordx4 v15, s[12:15], s41 offen lds
    v_mfma_f32_16x16x32_bf16 v[180:183], a[156:159], a[224:227], v[180:183]
    v_mfma_f32_16x16x32_bf16 v[184:187], a[152:155], a[228:231], v[184:187]
    v_mfma_f32_16x16x32_bf16 v[188:191], a[156:159], a[228:231], v[188:191]
    s_and_b32 s38, s73, 3
    s_mul_i32 s38, s38, 160
    s_mul_i32 s39, s35, 40
    s_add_u32 s38, s38, s39
    v_min_u32 v26, 39, v1
    v_add_u32 v27, s38, v26
    v_mul_u32_u24 v27, 1280, v27
    s_mul_i32 s38, s74, 160
    s_and_b32 s38, s38, 0xffffff80
    buffer_load_dword v125, v27, s[16:19], s38 offen
    v_mfma_f32_16x16x32_bf16 v[192:195], a[152:155], a[232:235], v[192:195]
    v_mfma_f32_16x16x32_bf16 v[196:199], a[156:159], a[232:235], v[196:199]
    v_mfma_f32_16x16x32_bf16 v[200:203], a[152:155], a[236:239], v[200:203]
    buffer_load_dword v125, v27, s[16:19], s38 offen offset:128
    v_mfma_f32_16x16x32_bf16 v[204:207], a[156:159], a[236:239], v[204:207]
    s_waitcnt lgkmcnt(0)
    s_cmp_eq_u32 s32, 1
    s_cbranch_scc1 L_B
L_A:
    s_nop 4
    ds_read_b64_tr_b16 a[160:161], v20 offset:40960
    ds_read_b64_tr_b16 a[162:163], v20 offset:42240
    ds_read_b64_tr_b16 a[164:165], v20 offset:40992
    ds_read_b64_tr_b16 a[166:167], v20 offset:42272
    ds_read_b64_tr_b16 a[168:169], v20 offset:41024
    ds_read_b64_tr_b16 a[170:171], v20 offset:42304
    ds_read_b64_tr_b16 a[172:173], v20 offset:41056
    ds_read_b64_tr_b16 a[174:175], v20 offset:42336
    ds_read_b64_tr_b16 a[176:177], v20 offset:41088
    ds_read_b64_tr_b16 a[178:179], v20 offset:42368
    s_waitcnt lgkmcnt(8)
    v_mfma_f32_16x16x32_bf16 v[208:211], a[160:163], a[0:3], 0
    ds_read_b64_tr_b16 a[180:181], v20 offset:46080
    v_cvt_pk_bf16_f32 v40, v128, v129
    v_cvt_pk_bf16_f32 v41, v130, v131
    v_cvt_pk_bf16_f32 v42, v132, v133
    v_cvt_pk_bf16_f32 v43, v134, v135
    v_mfma_f32_16x16x32_bf16 v[212:215], a[160:163], a[4:7], 0
    ds_read_b64_tr_b16 a[182:183], v20 offset:47360
    ds_write_b128 v23, v[40:43] offset:0
    v_cvt_pk_bf16_f32 v44, v136, v137
    v_cvt_pk_bf16_f32 v45, v138, v139
    v_cvt_pk_bf16_f32 v46, v140, v141
    s_waitcnt lgkmcnt(9)
    v_mfma_f32_16x16x32_bf16 v[216:219], a[164:167], a[0:3], 0
    ds_read_b64_tr_b16 a[184:185], v20 offset:46112
    v_cvt_pk_bf16_f32 v47, v142, v143
    ds_write_b128 v23, v[44:47] offset:4096
    v_cvt_pk_bf16_f32 v48, v144, v145
    v_cvt_pk_bf16_f32 v49, v146, v147
    v_mfma_f32_16x16x32_bf16 v[220:223], a[164:167], a[4:7], 0
    ds_read_b64_tr_b16 a[186:187], v20 offset:47392
    v_cvt_pk_bf16_f32 v50, v148, v149
    v_cvt_pk_bf16_f32 v51, v150, v151
    ds_write_b128 v23, v[48:51] offset:8192
    s_waitcnt lgkmcnt(11)
    v_mfma_f32_16x16x32_bf16 v[224:227], a[168:171], a[0:3], 0
    ds_read_b64_tr_b16 a[188:189], v20 offset:46144
    v_cvt_pk_bf16_f32 v52, v152, v153
    v_cvt_pk_bf16_f32 v53, v154, v155
    v_cvt_pk_bf16_f32 v54, v156, v157
    v_mfma_f32_16x16x32_bf16 v[228:231], a[168:171], a[4:7], 0
    ds_read_b64_tr_b16 a[190:191], v20 offset:47424
    v_cvt_pk_bf16_f32 v55, v158, v159
    ds_write_b128 v23, v[52:55] offset:12288
    v_cvt_pk_bf16_f32 v40, v160, v161
    s_waitcnt lgkmcnt(12)
    v_mfma_f32_16x16x32_bf16 v[232:235], a[172:175], a[0:3], 0
    ds_read_b64_tr_b16 a[192:193], v20 offset:46176
    v_cvt_pk_bf16_f32 v41, v162, v163
    v_cvt_pk_bf16_f32 v42, v164, v165
    v_cvt_pk_bf16_f32 v43, v166, v167
    v_mfma_f32_16x16x32_bf16 v[236:239], a[172:175], a[4:7], 0
    ds_read_b64_tr_b16 a[194:195], v20 offset:47456
    ds_write_b128 v23, v[40:43] offset:16384
    v_cvt_pk_bf16_f32 v44, v168, v169
    v_cvt_pk_bf16_f32 v45, v170, v171
    s_waitcnt lgkmcnt(13)
    v_mfma_f32_16x16x32_bf16 v[240:243], a[176:179], a[0:3], 0
    ds_read_b64_tr_b16 a[196:197], v20 offset:46208
    v_cvt_pk_bf16_f32 v46, v172, v173
    v_cvt_pk_bf16_f32 v47, v174, v175
    ds_write_b128 v24, v[44:47] offset:0
    v_mfma_f32_16x16x32_bf16 v[244:247], a[176:179], a[4:7], 0
    ds_read_b64_tr_b16 a[198:199], v20 offset:47488
    v_cvt_pk_bf16_f32 v48, v176, v177
    v_cvt_pk_bf16_f32 v49, v178, v179
    v_cvt_pk_bf16_f32 v50, v180, v181
    s_waitcnt lgkmcnt(14)
    v_mfma_f32_16x16x32_bf16 v[208:211], a[180:183], a[8:11], v[208:211]
    ds_read_b64_tr_b16 a[160:161], v20 offset:51200
    v_cvt_pk_bf16_f32 v51, v182, v183
    ds_write_b128 v24, v[48:51] offset:4096
    v_cvt_pk_bf16_f32 v52, v184, v185
    v_cvt_pk_bf16_f32 v53, v186, v187
    v_mfma_f32_16x16x32_bf16 v[212:215], a[180:183], a[12:15], v[212:215]
    ds_read_b64_tr_b16 a[162:163], v20 offset:52480
    v_cvt_pk_bf16_f32 v54, v188, v189
    v_cvt_pk_bf16_f32 v55, v190, v191
    ds_write_b128 v24, v[52:55] offset:8192
    v_cvt_pk_bf16_f32 v40, v192, v193
    s_waitcnt lgkmcnt(14)
    v_mfma_f32_16x16x32_bf16 v[216:219], a[184:187], a[8:11], v[216:219]
    ds_read_b64_tr_b16 a[164:165], v20 offset:51232
    v_cvt_pk_bf16_f32 v41, v194, v195
    v_cvt_pk_bf16_f32 v42, v196, v197
    v_cvt_pk_bf16_f32 v43, v198, v199
    ds_write_b128 v24, v[40:43] offset:12288
    v_mfma_f32_16x16x32_bf16 v[220:223], a[184:187], a[12:15], v[220:223]
    ds_read_b64_tr_b16 a[166:167], v20 offset:52512
    v_cvt_pk_bf16_f32 v44, v200, v201
    v_cvt_pk_bf16_f32 v45, v202, v203
    v_cvt_pk_bf16_f32 v46, v204, v205
    s_waitcnt lgkmcnt(14)
    v_mfma_f32_16x16x32_bf16 v[224:227], a[188:191], a[8:11], v[224:227]
    ds_read_b64_tr_b16 a[168:169], v20 offset:51264
    v_cvt_pk_bf16_f32 v47, v206, v207
    ds_write_b128 v24, v[44:47] offset:16384
    v_lshlrev_b32 v34, 2, v1
    v_mfma_f32_16x16x32_bf16 v[228:231], a[188:191], a[12:15], v[228:231]
    ds_read_b64_tr_b16 a[170:171], v20 offset:52544
    v_mov_b32 v35, 0x3f803f80
    v_add_u32 v34, 123392, v34
    ds_write_b32 v34, v35
    s_waitcnt lgkmcnt(15)
    v_mfma_f32_16x16x32_bf16 v[232:235], a[192:195], a[8:11], v[232:235]
    ds_read_b64_tr_b16 a[172:173], v20 offset:51296
    v_lshlrev_b32 v127, 4, v0
    v_add_u32 v26, 82432, v127
    s_mul_i32 s84, s91, 40960
    v_mfma_f32_16x16x32_bf16 v[236:239], a[192:195], a[12:15], v[236:239]
    ds_read_b64_tr_b16 a[174:175], v20 offset:52576
    s_add_u32 s84, s84, 1048576
    s_mul_i32 s39, s35, 10240
    s_add_u32 s39, s39, s84
    s_waitcnt lgkmcnt(13)
    v_mfma_f32_16x16x32_bf16 v[240:243], a[196:199], a[8:11], v[240:243]
    ds_read_b64_tr_b16 a[176:177], v20 offset:51328
    s_sub_u32 s86, s39, 40960
    s_cmp_ge_u32 s33, 1
    s_cselect_b32 s86, s86, 0x40000000
    v_mfma_f32_16x16x32_bf16 v[244:247], a[196:199], a[12:15], v[244:247]
    ds_read_b64_tr_b16 a[178:179], v20 offset:52608
    s_sub_u32 s87, s39, 81920
    s_cmp_ge_u32 s33, 2
    s_cselect_b32 s87, s87, 0x40000000
    s_waitcnt vmcnt(12) lgkmcnt(0)
    s_barrier
    s_waitcnt lgkmcnt(12)
    v_mfma_f32_16x16x32_bf16 v[208:211], a[160:163], a[16:19], v[208:211]
    ds_read_b64_tr_b16 a[180:181], v20 offset:56320
    ds_read_b128 v[40:43], v26 offset:0
    ds_read_b128 v[44:47], v26 offset:4096
    v_mfma_f32_16x16x32_bf16 v[212:215], a[160:163], a[20:23], v[212:215]
    ds_read_b64_tr_b16 a[182:183], v20 offset:57600
    ds_read_b128 v[48:51], v26 offset:8192
    s_waitcnt lgkmcnt(13)
    v_mfma_f32_16x16x32_bf16 v[216:219], a[164:167], a[16:19], v[216:219]
    ds_read_b64_tr_b16 a[184:185], v20 offset:56352
    ds_read_b128 v[52:55], v26 offset:12288
    v_mfma_f32_16x16x32_bf16 v[220:223], a[164:167], a[20:23], v[220:223]
    ds_read_b64_tr_b16 a[186:187], v20 offset:57632
    ds_read_b128 v[56:59], v26 offset:16384
    s_waitcnt lgkmcnt(14)
    v_mfma_f32_16x16x32_bf16 v[224:227], a[168:171], a[16:19], v[224:227]
    ds_read_b64_tr_b16 a[188:189], v20 offset:56384
    ds_read_b128 v[60:63], v26 offset:20480
    v_mfma_f32_16x16x32_bf16 v[228:231], a[168:171], a[20:23], v[228:231]
    ds_read_b64_tr_b16 a[190:191], v20 offset:57664
    ds_read_b128 v[64:67], v26 offset:24576
    s_waitcnt lgkmcnt(15)
    v_mfma_f32_16x16x32_bf16 v[232:235], a[172:175], a[16:19], v[232:235]
    ds_read_b64_tr_b16 a[192:193], v20 offset:56416
    ds_read_b128 v[68:71], v26 offset:28672
    v_mfma_f32_16x16x32_bf16 v[236:239], a[172:175], a[20:23], v[236:239]
    ds_read_b64_tr_b16 a[194:195], v20 offset:57696
    ds_read_b128 v[72:75], v26 offset:32768
    s_waitcnt lgkmcnt(15)
    v_mfma_f32_16x16x32_bf16 v[240:243], a[176:179], a[16:19], v[240:243]
    ds_read_b64_tr_b16 a[196:197], v20 offset:56448
    ds_read_b128 v[76:79], v26 offset:36864
    v_mfma_f32_16x16x32_bf16 v[244:247], a[176:179], a[20:23], v[244:247]
    ds_read_b64_tr_b16 a[198:199], v20 offset:57728
    s_waitcnt lgkmcnt(15)
    v_mfma_f32_16x16x32_bf16 v[208:211], a[180:183], a[24:27], v[208:211]
    ds_read_b64_tr_b16 a[160:161], v21 offset:0
    s_waitcnt lgkmcnt(1)
    s_mov_b32 s88, s84
    v_mfma_f32_16x16x32_bf16 v[212:215], a[180:183], a[28:31], v[212:215]
    ds_read_b64_tr_b16 a[162:163], v21 offset:1280
    buffer_store_dwordx4 v[40:43], v127, s[24:27], s88 offen sc1
    s_waitcnt lgkmcnt(14)
    v_mfma_f32_16x16x32_bf16 v[216:219], a[184:187], a[24:27], v[216:219]
    ds_read_b64_tr_b16 a[164:165], v21 offset:32
    s_add_u32 s88, s88, 4096
    v_mfma_f32_16x16x32_bf16 v[220:223], a[184:187], a[28:31], v[220:223]
    ds_read_b64_tr_b16 a[166:167], v21 offset:1312
    buffer_store_dwordx4 v[44:47], v127, s[24:27], s88 offen sc1
    s_waitcnt lgkmcnt(12)
    v_mfma_f32_16x16x32_bf16 v[224:227], a[188:191], a[24:27], v[224:227]
    ds_read_b64_tr_b16 a[168:169], v21 offset:64
    s_add_u32 s88, s88, 4096
    v_mfma_f32_16x16x32_bf16 v[228:231], a[188:191], a[28:31], v[228:231]
    ds_read_b64_tr_b16 a[170:171], v21 offset:1344
    buffer_store_dwordx4 v[48:51], v127, s[24:27], s88 offen sc1
    s_waitcnt lgkmcnt(10)
    v_mfma_f32_16x16x32_bf16 v[232:235], a[192:195], a[24:27], v[232:235]
    ds_read_b64_tr_b16 a[172:173], v21 offset:96
    s_add_u32 s88, s88, 4096
    v_mfma_f32_16x16x32_bf16 v[236:239], a[192:195], a[28:31], v[236:239]
    ds_read_b64_tr_b16 a[174:175], v21 offset:1376
    buffer_store_dwordx4 v[52:55], v127, s[24:27], s88 offen sc1
    s_waitcnt lgkmcnt(8)
    v_mfma_f32_16x16x32_bf16 v[240:243], a[196:199], a[24:27], v[240:243]
    ds_read_b64_tr_b16 a[176:177], v21 offset:128
    s_add_u32 s88, s88, 4096
    v_mfma_f32_16x16x32_bf16 v[244:247], a[196:199], a[28:31], v[244:247]
    ds_read_b64_tr_b16 a[178:179], v21 offset:1408
    buffer_store_dwordx4 v[56:59], v127, s[24:27], s88 offen sc1
    s_waitcnt lgkmcnt(8)
    v_mfma_f32_16x16x32_bf16 v[208:211], a[160:163], a[32:35], v[208:211]
    ds_read_b64_tr_b16 a[180:181], v21 offset:5120
    s_add_u32 s88, s88, 4096
    v_mfma_f32_16x16x32_bf16 v[212:215], a[160:163], a[36:39], v[212:215]
    ds_read_b64_tr_b16 a[182:183], v21 offset:6400
    buffer_store_dwordx4 v[60:63], v127, s[24:27], s88 offen sc1
    s_waitcnt lgkmcnt(8)
    v_mfma_f32_16x16x32_bf16 v[216:219], a[164:167], a[32:35], v[216:219]
    ds_read_b64_tr_b16 a[184:185], v21 offset:5152
    s_add_u32 s88, s88, 4096
    v_mfma_f32_16x16x32_bf16 v[220:223], a[164:167], a[36:39], v[220:223]
    ds_read_b64_tr_b16 a[186:187], v21 offset:6432
    buffer_store_dwordx4 v[64:67], v127, s[24:27], s88 offen sc1
    s_waitcnt lgkmcnt(8)
    v_mfma_f32_16x16x32_bf16 v[224:227], a[168:171], a[32:35], v[224:227]
    ds_read_b64_tr_b16 a[188:189], v21 offset:5184
    s_add_u32 s88, s88, 4096
    v_mfma_f32_16x16x32_bf16 v[228:231], a[168:171], a[36:39], v[228:231]
    ds_read_b64_tr_b16 a[190:191], v21 offset:6464
    buffer_store_dwordx4 v[68:71], v127, s[24:27], s88 offen sc1
    s_waitcnt lgkmcnt(8)
    v_mfma_f32_16x16x32_bf16 v[232:235], a[172:175], a[32:35], v[232:235]
    ds_read_b64_tr_b16 a[192:193], v21 offset:5216
    s_add_u32 s88, s88, 4096
    v_mfma_f32_16x16x32_bf16 v[236:239], a[172:175], a[36:39], v[236:239]
    ds_read_b64_tr_b16 a[194:195], v21 offset:6496
    buffer_store_dwordx4 v[72:75], v127, s[24:27], s88 offen sc1
    s_waitcnt lgkmcnt(8)
    v_mfma_f32_16x16x32_bf16 v[240:243], a[176:179], a[32:35], v[240:243]
    ds_read_b64_tr_b16 a[196:197], v21 offset:5248
    s_add_u32 s88, s88, 4096
    v_mfma_f32_16x16x32_bf16 v[244:247], a[176:179], a[36:39], v[244:247]
    ds_read_b64_tr_b16 a[198:199], v21 offset:6528
    buffer_store_dwordx4 v[76:79], v127, s[24:27], s88 offen sc1
    s_waitcnt lgkmcnt(8)
    v_mfma_f32_16x16x32_bf16 v[208:211], a[180:183], a[40:43], v[208:211]
    ds_read_b64_tr_b16 a[160:161], v21 offset:10240
    s_mov_b32 s78, 0x3ea52b5c
    v_mfma_f32_16x16x32_bf16 v[212:215], a[180:183], a[44:47], v[212:215]
    ds_read_b64_tr_b16 a[162:163], v21 offset:11520
    s_waitcnt lgkmcnt(8)
    v_mfma_f32_16x16x32_bf16 v[216:219], a[184:187], a[40:43], v[216:219]
    ds_read_b64_tr_b16 a[164:165], v21 offset:10272
    v_mfma_f32_16x16x32_bf16 v[220:223], a[184:187], a[44:47], v[220:223]
    ds_read_b64_tr_b16 a[166:167], v21 offset:11552
    s_waitcnt lgkmcnt(8)
    v_mfma_f32_16x16x32_bf16 v[224:227], a[188:191], a[40:43], v[224:227]
    ds_read_b64_tr_b16 a[168:169], v21 offset:10304
    v_mfma_f32_16x16x32_bf16 v[228:231], a[188:191], a[44:47], v[228:231]
    ds_read_b64_tr_b16 a[170:171], v21 offset:11584
    s_waitcnt lgkmcnt(8)
    v_mfma_f32_16x16x32_bf16 v[232:235], a[192:195], a[40:43], v[232:235]
    ds_read_b64_tr_b16 a[172:173], v21 offset:10336
    v_mfma_f32_16x16x32_bf16 v[236:239], a[192:195], a[44:47], v[236:239]
    ds_read_b64_tr_b16 a[174:175], v21 offset:11616
    s_waitcnt lgkmcnt(8)
    v_mfma_f32_16x16x32_bf16 v[240:243], a[196:199], a[40:43], v[240:243]
    ds_read_b64_tr_b16 a[176:177], v21 offset:10368
    v_mfma_f32_16x16x32_bf16 v[244:247], a[196:199], a[44:47], v[244:247]
    ds_read_b64_tr_b16 a[178:179], v21 offset:11648
    s_waitcnt lgkmcnt(8)
    v_mfma_f32_16x16x32_bf16 v[208:211], a[160:163], a[48:51], v[208:211]
    ds_read_b64_tr_b16 a[180:181], v21 offset:15360
    v_mfma_f32_16x16x32_bf16 v[212:215], a[160:163], a[52:55], v[212:215]
    ds_read_b64_tr_b16 a[182:183], v21 offset:16640
    s_waitcnt lgkmcnt(8)
    v_mfma_f32_16x16x32_bf16 v[216:219], a[164:167], a[48:51], v[216:219]
    ds_read_b64_tr_b16 a[184:185], v21 offset:15392
    v_mfma_f32_16x16x32_bf16 v[220:223], a[164:167], a[52:55], v[220:223]
    ds_read_b64_tr_b16 a[186:187], v21 offset:16672
    s_waitcnt lgkmcnt(8)
    v_mfma_f32_16x16x32_bf16 v[224:227], a[168:171], a[48:51], v[224:227]
    ds_read_b64_tr_b16 a[188:189], v21 offset:15424
    v_mfma_f32_16x16x32_bf16 v[228:231], a[168:171], a[52:55], v[228:231]
    ds_read_b64_tr_b16 a[190:191], v21 offset:16704
    s_waitcnt lgkmcnt(8)
    v_mfma_f32_16x16x32_bf16 v[232:235], a[172:175], a[48:51], v[232:235]
    ds_read_b64_tr_b16 a[192:193], v21 offset:15456
    v_mfma_f32_16x16x32_bf16 v[236:239], a[172:175], a[52:55], v[236:239]
    ds_read_b64_tr_b16 a[194:195], v21 offset:16736
    s_waitcnt lgkmcnt(8)
    v_mfma_f32_16x16x32_bf16 v[240:243], a[176:179], a[48:51], v[240:243]
    ds_read_b64_tr_b16 a[196:197], v21 offset:15488
    v_mfma_f32_16x16x32_bf16 v[244:247], a[176:179], a[52:55], v[244:247]
    ds_read_b64_tr_b16 a[198:199], v21 offset:16768
    s_waitcnt lgkmcnt(8)
    v_mfma_f32_16x16x32_bf16 v[208:211], a[180:183], a[56:59], v[208:211]
    ds_read_b64_tr_b16 a[160:161], v22 offset:0
    v_mfma_f32_16x16x32_bf16 v[212:215], a[180:183], a[60:63], v[212:215]
    ds_read_b64_tr_b16 a[162:163], v22 offset:1280
    s_waitcnt lgkmcnt(8)
    v_mfma_f32_16x16x32_bf16 v[216:219], a[184:187], a[56:59], v[216:219]
    ds_read_b64_tr_b16 a[164:165], v22 offset:32
    v_mfma_f32_16x16x32_bf16 v[220:223], a[184:187], a[60:63], v[220:223]
    ds_read_b64_tr_b16 a[166:167], v22 offset:1312
    s_waitcnt lgkmcnt(8)
    v_mfma_f32_16x16x32_bf16 v[224:227], a[188:191], a[56:59], v[224:227]
    ds_read_b64_tr_b16 a[168:169], v22 offset:64
    v_mfma_f32_16x16x32_bf16 v[228:231], a[188:191], a[60:63], v[228:231]
    ds_read_b64_tr_b16 a[170:171], v22 offset:1344
    s_waitcnt lgkmcnt(8)
    v_mfma_f32_16x16x32_bf16 v[232:235], a[192:195], a[56:59], v[232:235]
    ds_read_b64_tr_b16 a[172:173], v22 offset:96
    v_mfma_f32_16x16x32_bf16 v[236:239], a[192:195], a[60:63], v[236:239]
    ds_read_b64_tr_b16 a[174:175], v22 offset:1376
    s_waitcnt lgkmcnt(8)
    v_mfma_f32_16x16x32_bf16 v[240:243], a[196:199], a[56:59], v[240:243]
    ds_read_b64_tr_b16 a[176:177], v22 offset:128
    v_mfma_f32_16x16x32_bf16 v[244:247], a[196:199], a[60:63], v[244:247]
    ds_read_b64_tr_b16 a[178:179], v22 offset:1408
    s_waitcnt lgkmcnt(8)
    v_mfma_f32_16x16x32_bf16 v[208:211], a[160:163], a[64:67], v[208:211]
    ds_read_b64_tr_b16 a[180:181], v22 offset:5120
    v_mfma_f32_16x16x32_bf16 v[212:215], a[160:163], a[68:71], v[212:215]
    ds_read_b64_tr_b16 a[182:183], v22 offset:6400
    s_waitcnt lgkmcnt(8)
    v_mfma_f32_16x16x32_bf16 v[216:219], a[164:167], a[64:67], v[216:219]
    ds_read_b64_tr_b16 a[184:185], v22 offset:5152
    v_mfma_f32_16x16x32_bf16 v[220:223], a[164:167], a[68:71], v[220:223]
    ds_read_b64_tr_b16 a[186:187], v22 offset:6432
    s_waitcnt lgkmcnt(8)
    v_mfma_f32_16x16x32_bf16 v[224:227], a[168:171], a[64:67], v[224:227]
    ds_read_b64_tr_b16 a[188:189], v22 offset:5184
    v_mfma_f32_16x16x32_bf16 v[228:231], a[168:171], a[68:71], v[228:231]
    ds_read_b64_tr_b16 a[190:191], v22 offset:6464
    s_waitcnt lgkmcnt(8)
    v_mfma_f32_16x16x32_bf16 v[232:235], a[172:175], a[64:67], v[232:235]
    ds_read_b64_tr_b16 a[192:193], v22 offset:5216
    v_mfma_f32_16x16x32_bf16 v[236:239], a[172:175], a[68:71], v[236:239]
    ds_read_b64_tr_b16 a[194:195], v22 offset:6496
    s_waitcnt lgkmcnt(8)
    v_mfma_f32_16x16x32_bf16 v[240:243], a[176:179], a[64:67], v[240:243]
    ds_read_b64_tr_b16 a[196:197], v22 offset:5248
    v_mfma_f32_16x16x32_bf16 v[244:247], a[176:179], a[68:71], v[244:247]
    ds_read_b64_tr_b16 a[198:199], v22 offset:6528
    s_waitcnt lgkmcnt(8)
    v_mfma_f32_16x16x32_bf16 v[208:211], a[180:183], a[72:75], v[208:211]
    ds_read_b64_tr_b16 a[160:161], v22 offset:10240
    v_mfma_f32_16x16x32_bf16 v[212:215], a[180:183], a[76:79], v[212:215]
    ds_read_b64_tr_b16 a[162:163], v22 offset:11520
    s_waitcnt lgkmcnt(8)
    v_mfma_f32_16x16x32_bf16 v[216:219], a[184:187], a[72:75], v[216:219]
    ds_read_b64_tr_b16 a[164:165], v22 offset:10272
    v_mfma_f32_16x16x32_bf16 v[220:223], a[184:187], a[76:79], v[220:223]
    ds_read_b64_tr_b16 a[166:167], v22 offset:11552
    s_waitcnt lgkmcnt(8)
    v_mfma_f32_16x16x32_bf16 v[224:227], a[188:191], a[72:75], v[224:227]
    ds_read_b64_tr_b16 a[168:169], v22 offset:10304
    v_mfma_f32_16x16x32_bf16 v[228:231], a[188:191], a[76:79], v[228:231]
    ds_read_b64_tr_b16 a[170:171], v22 offset:11584
    s_waitcnt lgkmcnt(8)
    v_mfma_f32_16x16x32_bf16 v[232:235], a[192:195], a[72:75], v[232:235]
    ds_read_b64_tr_b16 a[172:173], v22 offset:10336
    v_mfma_f32_16x16x32_bf16 v[236:239], a[192:195], a[76:79], v[236:239]
    ds_read_b64_tr_b16 a[174:175], v22 offset:11616
    s_waitcnt lgkmcnt(8)
    v_mfma_f32_16x16x32_bf16 v[240:243], a[196:199], a[72:75], v[240:243]
    ds_read_b64_tr_b16 a[176:177], v22 offset:10368
    v_mfma_f32_16x16x32_bf16 v[244:247], a[196:199], a[76:79], v[244:247]
    ds_read_b64_tr_b16 a[178:179], v22 offset:11648
    s_waitcnt vmcnt(12)
    s_barrier
    s_waitcnt lgkmcnt(8)
    v_mfma_f32_16x16x32_bf16 v[208:211], a[160:163], a[80:83], v[208:211]
    ds_read_b64_tr_b16 a[180:181], v22 offset:15360
    v_mfma_f32_16x16x32_bf16 v[212:215], a[160:163], a[84:87], v[212:215]
    ds_read_b64_tr_b16 a[182:183], v22 offset:16640
    s_waitcnt lgkmcnt(8)
    v_mfma_f32_16x16x32_bf16 v[216:219], a[164:167], a[80:83], v[216:219]
    ds_read_b64_tr_b16 a[184:185], v22 offset:15392
    v_mfma_f32_16x16x32_bf16 v[220:223], a[164:167], a[84:87], v[220:223]
    ds_read_b64_tr_b16 a[186:187], v22 offset:16672
    s_waitcnt lgkmcnt(8)
    v_mfma_f32_16x16x32_bf16 v[224:227], a[168:171], a[80:83], v[224:227]
    ds_read_b64_tr_b16 a[188:189], v22 offset:15424
    v_mfma_f32_16x16x32_bf16 v[228:231], a[168:171], a[84:87], v[228:231]
    ds_read_b64_tr_b16 a[190:191], v22 offset:16704
    s_waitcnt lgkmcnt(8)
    v_mfma_f32_16x16x32_bf16 v[232:235], a[172:175], a[80:83], v[232:235]
    ds_read_b64_tr_b16 a[192:193], v22 offset:15456
    v_mfma_f32_16x16x32_bf16 v[236:239], a[172:175], a[84:87], v[236:239]
    ds_read_b64_tr_b16 a[194:195], v22 offset:16736
    s_waitcnt lgkmcnt(8)
    v_mfma_f32_16x16x32_bf16 v[240:243], a[176:179], a[80:83], v[240:243]
    ds_read_b64_tr_b16 a[196:197], v22 offset:15488
    v_mfma_f32_16x16x32_bf16 v[244:247], a[176:179], a[84:87], v[244:247]
    ds_read_b64_tr_b16 a[198:199], v22 offset:16768
    s_waitcnt lgkmcnt(8)
    v_mfma_f32_16x16x32_bf16 v[208:211], a[180:183], a[88:91], v[208:211]
    ds_read_b64_tr_b16 a[160:161], v20 offset:0
    v_mfma_f32_16x16x32_bf16 v[212:215], a[180:183], a[92:95], v[212:215]
    ds_read_b64_tr_b16 a[162:163], v20 offset:1280
    s_waitcnt lgkmcnt(8)
    v_mfma_f32_16x16x32_bf16 v[216:219], a[184:187], a[88:91], v[216:219]
    ds_read_b64_tr_b16 a[164:165], v20 offset:32
    v_mfma_f32_16x16x32_bf16 v[220:223], a[184:187], a[92:95], v[220:223]
    ds_read_b64_tr_b16 a[166:167], v20 offset:1312
    s_waitcnt lgkmcnt(8)
    v_mfma_f32_16x16x32_bf16 v[224:227], a[188:191], a[88:91], v[224:227]
    ds_read_b64_tr_b16 a[168:169], v20 offset:64
    v_mfma_f32_16x16x32_bf16 v[228:231], a[188:191], a[92:95], v[228:231]
    ds_read_b64_tr_b16 a[170:171], v20 offset:1344
    s_waitcnt lgkmcnt(8)
    v_mfma_f32_16x16x32_bf16 v[232:235], a[192:195], a[88:91], v[232:235]
    ds_read_b64_tr_b16 a[172:173], v20 offset:96
    v_mfma_f32_16x16x32_bf16 v[236:239], a[192:195], a[92:95], v[236:239]
    ds_read_b64_tr_b16 a[174:175], v20 offset:1376
    s_waitcnt lgkmcnt(8)
    v_mfma_f32_16x16x32_bf16 v[240:243], a[196:199], a[88:91], v[240:243]
    ds_read_b64_tr_b16 a[176:177], v20 offset:128
    v_mfma_f32_16x16x32_bf16 v[244:247], a[196:199], a[92:95], v[244:247]
    ds_read_b64_tr_b16 a[178:179], v20 offset:1408
    s_waitcnt lgkmcnt(8)
    v_mfma_f32_16x16x32_bf16 v[208:211], a[160:163], a[96:99], v[208:211]
    ds_read_b64_tr_b16 a[180:181], v20 offset:5120
    v_mfma_f32_16x16x32_bf16 v[212:215], a[160:163], a[100:103], v[212:215]
    ds_read_b64_tr_b16 a[182:183], v20 offset:6400
    s_waitcnt lgkmcnt(8)
    v_mfma_f32_16x16x32_bf16 v[216:219], a[164:167], a[96:99], v[216:219]
    ds_read_b64_tr_b16 a[184:185], v20 offset:5152
    v_mfma_f32_16x16x32_bf16 v[220:223], a[164:167], a[100:103], v[220:223]
    ds_read_b64_tr_b16 a[186:187], v20 offset:6432
    s_waitcnt lgkmcnt(8)
    v_mfma_f32_16x16x32_bf16 v[224:227], a[168:171], a[96:99], v[224:227]
    ds_read_b64_tr_b16 a[188:189], v20 offset:5184
    v_mfma_f32_16x16x32_bf16 v[228:231], a[168:171], a[100:103], v[228:231]
    ds_read_b64_tr_b16 a[190:191], v20 offset:6464
    s_waitcnt lgkmcnt(8)
    v_mfma_f32_16x16x32_bf16 v[232:235], a[172:175], a[96:99], v[232:235]
    ds_read_b64_tr_b16 a[192:193], v20 offset:5216
    v_mfma_f32_16x16x32_bf16 v[236:239], a[172:175], a[100:103], v[236:239]
    ds_read_b64_tr_b16 a[194:195], v20 offset:6496
    s_waitcnt lgkmcnt(8)
    v_mfma_f32_16x16x32_bf16 v[240:243], a[176:179], a[96:99], v[240:243]
    ds_read_b64_tr_b16 a[196:197], v20 offset:5248
    v_mfma_f32_16x16x32_bf16 v[244:247], a[176:179], a[100:103], v[244:247]
    ds_read_b64_tr_b16 a[198:199], v20 offset:6528
    s_waitcnt vmcnt(0)
    s_barrier
    s_cmp_lg_u32 s35, 0
    s_cbranch_scc1 fl_11
    s_lshl_b32 s38, s32, 7
    s_add_u32 s38, s38, s91
    s_lshl_b32 s38, s38, 7
    v_mov_b32 v124, s40
    buffer_store_dword v124, off, s[24:27], s38 sc1
fl_11:
    s_waitcnt lgkmcnt(8)
    v_mfma_f32_16x16x32_bf16 v[208:211], a[180:183], a[104:107], v[208:211]
    ds_read_b64_tr_b16 a[160:161], v20 offset:10240
    v_mfma_f32_16x16x32_bf16 v[212:215], a[180:183], a[108:111], v[212:215]
    ds_read_b64_tr_b16 a[162:163], v20 offset:11520
    s_waitcnt lgkmcnt(8)
    v_mfma_f32_16x16x32_bf16 v[216:219], a[184:187], a[104:107], v[216:219]
    ds_read_b64_tr_b16 a[164:165], v20 offset:10272
    v_mfma_f32_16x16x32_bf16 v[220:223], a[184:187], a[108:111], v[220:223]
    ds_read_b64_tr_b16 a[166:167], v20 offset:11552
    s_waitcnt lgkmcnt(8)
    v_mfma_f32_16x16x32_bf16 v[224:227], a[188:191], a[104:107], v[224:227]
    ds_read_b64_tr_b16 a[168:169], v20 offset:10304
    v_mfma_f32_16x16x32_bf16 v[228:231], a[188:191], a[108:111], v[228:231]
    ds_read_b64_tr_b16 a[170:171], v20 offset:11584
    s_waitcnt lgkmcnt(8)
    v_mfma_f32_16x16x32_bf16 v[232:235], a[192:195], a[104:107], v[232:235]
    ds_read_b64_tr_b16 a[172:173], v20 offset:10336
    v_mfma_f32_16x16x32_bf16 v[236:239], a[192:195], a[108:111], v[236:239]
    ds_read_b64_tr_b16 a[174:175], v20 offset:11616
    s_waitcnt lgkmcnt(8)
    v_mfma_f32_16x16x32_bf16 v[240:243], a[196:199], a[104:107], v[240:243]
    ds_read_b64_tr_b16 a[176:177], v20 offset:10368
    v_mfma_f32_16x16x32_bf16 v[244:247], a[196:199], a[108:111], v[244:247]
    ds_read_b64_tr_b16 a[178:179], v20 offset:11648
    s_waitcnt lgkmcnt(8)
    v_mfma_f32_16x16x32_bf16 v[208:211], a[160:163], a[112:115], v[208:211]
    ds_read_b64_tr_b16 a[180:181], v20 offset:15360
    v_mfma_f32_16x16x32_bf16 v[212:215], a[160:163], a[116:119], v[212:215]
    ds_read_b64_tr_b16 a[182:183], v20 offset:16640
    s_waitcnt lgkmcnt(8)
    v_mfma_f32_16x16x32_bf16 v[216:219], a[164:167], a[112:115], v[216:219]
    ds_read_b64_tr_b16 a[184:185], v20 offset:15392
    v_mfma_f32_16x16x32_bf16 v[220:223], a[164:167], a[116:119], v[220:223]
    ds_read_b64_tr_b16 a[186:187], v20 offset:16672
    s_waitcnt lgkmcnt(8)
    v_mfma_f32_16x16x32_bf16 v[224:227], a[168:171], a[112:115], v[224:227]
    ds_read_b64_tr_b16 a[188:189], v20 offset:15424
    v_mfma_f32_16x16x32_bf16 v[228:231], a[168:171], a[116:119], v[228:231]
    ds_read_b64_tr_b16 a[190:191], v20 offset:16704
    s_waitcnt lgkmcnt(8)
    v_mfma_f32_16x16x32_bf16 v[232:235], a[172:175], a[112:115], v[232:235]
    ds_read_b64_tr_b16 a[192:193], v20 offset:15456
    v_mfma_f32_16x16x32_bf16 v[236:239], a[172:175], a[116:119], v[236:239]
    ds_read_b64_tr_b16 a[194:195], v20 offset:16736
    s_waitcnt lgkmcnt(8)
    v_mfma_f32_16x16x32_bf16 v[240:243], a[176:179], a[112:115], v[240:243]
    ds_read_b64_tr_b16 a[196:197], v20 offset:15488
    v_mfma_f32_16x16x32_bf16 v[244:247], a[176:179], a[116:119], v[244:247]
    ds_read_b64_tr_b16 a[198:199], v20 offset:16768
    s_waitcnt lgkmcnt(8)
    v_mfma_f32_16x16x32_bf16 v[208:211], a[180:183], a[120:123], v[208:211]
    ds_read_b64_tr_b16 a[160:161], v20 offset:20480
    v_mfma_f32_16x16x32_bf16 v[212:215], a[180:183], a[124:127], v[212:215]
    ds_read_b64_tr_b16 a[162:163], v20 offset:21760
    s_waitcnt lgkmcnt(8)
    v_mfma_f32_16x16x32_bf16 v[216:219], a[184:187], a[120:123], v[216:219]
    ds_read_b64_tr_b16 a[164:165], v20 offset:20512
    v_mfma_f32_16x16x32_bf16 v[220:223], a[184:187], a[124:127], v[220:223]
    ds_read_b64_tr_b16 a[166:167], v20 offset:21792
    s_waitcnt lgkmcnt(8)
    v_mfma_f32_16x16x32_bf16 v[224:227], a[188:191], a[120:123], v[224:227]
    ds_read_b64_tr_b16 a[168:169], v20 offset:20544
    v_mfma_f32_16x16x32_bf16 v[228:231], a[188:191], a[124:127], v[228:231]
    ds_read_b64_tr_b16 a[170:171], v20 offset:21824
    s_waitcnt lgkmcnt(8)
    v_mfma_f32_16x16x32_bf16 v[232:235], a[192:195], a[120:123], v[232:235]
    ds_read_b64_tr_b16 a[172:173], v20 offset:20576
    v_mfma_f32_16x16x32_bf16 v[236:239], a[192:195], a[124:127], v[236:239]
    ds_read_b64_tr_b16 a[174:175], v20 offset:21856
    s_waitcnt lgkmcnt(8)
    v_mfma_f32_16x16x32_bf16 v[240:243], a[196:199], a[120:123], v[240:243]
    ds_read_b64_tr_b16 a[176:177], v20 offset:20608
    v_mfma_f32_16x16x32_bf16 v[244:247], a[196:199], a[124:127], v[244:247]
    ds_read_b64_tr_b16 a[178:179], v20 offset:21888
    s_waitcnt lgkmcnt(8)
    v_mfma_f32_16x16x32_bf16 v[208:211], a[160:163], a[128:131], v[208:211]
    ds_read_b64_tr_b16 a[180:181], v20 offset:25600
    v_mfma_f32_16x16x32_bf16 v[212:215], a[160:163], a[132:135], v[212:215]
    ds_read_b64_tr_b16 a[182:183], v20 offset:26880
    s_waitcnt lgkmcnt(8)
    v_mfma_f32_16x16x32_bf16 v[216:219], a[164:167], a[128:131], v[216:219]
    ds_read_b64_tr_b16 a[184:185], v20 offset:25632
    v_mfma_f32_16x16x32_bf16 v[220:223], a[164:167], a[132:135], v[220:223]
    ds_read_b64_tr_b16 a[186:187], v20 offset:26912
    s_waitcnt lgkmcnt(8)
    v_mfma_f32_16x16x32_bf16 v[224:227], a[168:171], a[128:131], v[224:227]
    ds_read_b64_tr_b16 a[188:189], v20 offset:25664
    v_mfma_f32_16x16x32_bf16 v[228:231], a[168:171], a[132:135], v[228:231]
    ds_read_b64_tr_b16 a[190:191], v20 offset:26944
    s_waitcnt lgkmcnt(8)
    v_mfma_f32_16x16x32_bf16 v[232:235], a[172:175], a[128:131], v[232:235]
    ds_read_b64_tr_b16 a[192:193], v20 offset:25696
    v_mfma_f32_16x16x32_bf16 v[236:239], a[172:175], a[132:135], v[236:239]
    ds_read_b64_tr_b16 a[194:195], v20 offset:26976
    s_waitcnt lgkmcnt(8)
    v_mfma_f32_16x16x32_bf16 v[240:243], a[176:179], a[128:131], v[240:243]
    ds_read_b64_tr_b16 a[196:197], v20 offset:25728
    v_mfma_f32_16x16x32_bf16 v[244:247], a[176:179], a[132:135], v[244:247]
    ds_read_b64_tr_b16 a[198:199], v20 offset:27008
    s_waitcnt lgkmcnt(8)
    v_mfma_f32_16x16x32_bf16 v[208:211], a[180:183], a[136:139], v[208:211]
    ds_read_b64_tr_b16 a[160:161], v20 offset:30720
    v_mfma_f32_16x16x32_bf16 v[212:215], a[180:183], a[140:143], v[212:215]
    ds_read_b64_tr_b16 a[162:163], v20 offset:32000
    s_waitcnt lgkmcnt(8)
    v_mfma_f32_16x16x32_bf16 v[216:219], a[184:187], a[136:139], v[216:219]
    ds_read_b64_tr_b16 a[164:165], v20 offset:30752
    v_mfma_f32_16x16x32_bf16 v[220:223], a[184:187], a[140:143], v[220:223]
    ds_read_b64_tr_b16 a[166:167], v20 offset:32032
    s_waitcnt lgkmcnt(8)
    v_mfma_f32_16x16x32_bf16 v[224:227], a[188:191], a[136:139], v[224:227]
    ds_read_b64_tr_b16 a[168:169], v20 offset:30784
    v_mfma_f32_16x16x32_bf16 v[228:231], a[188:191], a[140:143], v[228:231]
    ds_read_b64_tr_b16 a[170:171], v20 offset:32064
    s_waitcnt lgkmcnt(8)
    v_mfma_f32_16x16x32_bf16 v[232:235], a[192:195], a[136:139], v[232:235]
    ds_read_b64_tr_b16 a[172:173], v20 offset:30816
    v_mfma_f32_16x16x32_bf16 v[236:239], a[192:195], a[140:143], v[236:239]
    ds_read_b64_tr_b16 a[174:175], v20 offset:32096
    s_waitcnt lgkmcnt(8)
    v_mfma_f32_16x16x32_bf16 v[240:243], a[196:199], a[136:139], v[240:243]
    ds_read_b64_tr_b16 a[176:177], v20 offset:30848
    v_mfma_f32_16x16x32_bf16 v[244:247], a[196:199], a[140:143], v[244:247]
    ds_read_b64_tr_b16 a[178:179], v20 offset:32128
    s_waitcnt lgkmcnt(8)
    v_mfma_f32_16x16x32_bf16 v[208:211], a[160:163], a[144:147], v[208:211]
    ds_read_b64_tr_b16 a[180:181], v20 offset:35840
    s_cmp_lg_u32 s35, 0
    s_cbranch_scc1 pp_12
    buffer_load_dword v121, v94, s[24:27], 0 offen sc1
pp_12:
    v_mfma_f32_16x16x32_bf16 v[212:215], a[160:163], a[148:151], v[212:215]
    ds_read_b64_tr_b16 a[182:183], v20 offset:37120
    s_waitcnt lgkmcnt(8)
    v_mfma_f32_16x16x32_bf16 v[216:219], a[164:167], a[144:147], v[216:219]
    ds_read_b64_tr_b16 a[184:185], v20 offset:35872
    v_mfma_f32_16x16x32_bf16 v[220:223], a[164:167], a[148:151], v[220:223]
    ds_read_b64_tr_b16 a[186:187], v20 offset:37152
    s_waitcnt lgkmcnt(8)
    v_mfma_f32_16x16x32_bf16 v[224:227], a[168:171], a[144:147], v[224:227]
    ds_read_b64_tr_b16 a[188:189], v20 offset:35904
    v_mfma_f32_16x16x32_bf16 v[228:231], a[168:171], a[148:151], v[228:231]
    ds_read_b64_tr_b16 a[190:191], v20 offset:37184
    s_waitcnt lgkmcnt(8)
    v_mfma_f32_16x16x32_bf16 v[232:235], a[172:175], a[144:147], v[232:235]
    ds_read_b64_tr_b16 a[192:193], v20 offset:35936
    v_mfma_f32_16x16x32_bf16 v[236:239], a[172:175], a[148:151], v[236:239]
    ds_read_b64_tr_b16 a[194:195], v20 offset:37216
    s_waitcnt lgkmcnt(8)
    v_mfma_f32_16x16x32_bf16 v[240:243], a[176:179], a[144:147], v[240:243]
    ds_read_b64_tr_b16 a[196:197], v20 offset:35968
    v_mfma_f32_16x16x32_bf16 v[244:247], a[176:179], a[148:151], v[244:247]
    ds_read_b64_tr_b16 a[198:199], v20 offset:37248
    s_waitcnt lgkmcnt(8)
    v_mfma_f32_16x16x32_bf16 v[208:211], a[180:183], a[152:155], v[208:211]
    v_mfma_f32_16x16x32_bf16 v[212:215], a[180:183], a[156:159], v[212:215]
    s_waitcnt lgkmcnt(6)
    v_mfma_f32_16x16x32_bf16 v[216:219], a[184:187], a[152:155], v[216:219]
    v_mfma_f32_16x16x32_bf16 v[220:223], a[184:187], a[156:159], v[220:223]
    s_waitcnt lgkmcnt(4)
    v_mfma_f32_16x16x32_bf16 v[224:227], a[188:191], a[152:155], v[224:227]
    v_mfma_f32_16x16x32_bf16 v[228:231], a[188:191], a[156:159], v[228:231]
    s_waitcnt lgkmcnt(2)
    v_mfma_f32_16x16x32_bf16 v[232:235], a[192:195], a[152:155], v[232:235]
    v_mfma_f32_16x16x32_bf16 v[236:239], a[192:195], a[156:159], v[236:239]
    s_waitcnt lgkmcnt(0)
    v_mfma_f32_16x16x32_bf16 v[240:243], a[196:199], a[152:155], v[240:243]
    v_mfma_f32_16x16x32_bf16 v[244:247], a[196:199], a[156:159], v[244:247]
    s_nop 7
    v_pk_mul_f32 v[208:209], v[208:209], s[78:79] op_sel_hi:[1,0]
    v_pk_mul_f32 v[210:211], v[210:211], s[78:79] op_sel_hi:[1,0]
    v_cvt_pk_bf16_f32 v26, v208, v209
    v_cvt_pk_bf16_f32 v27, v210, v211
    ds_write_b64 v93, v[26:27] offset:0
    v_pk_mul_f32 v[212:213], v[212:213], s[78:79] op_sel_hi:[1,0]
    v_pk_mul_f32 v[214:215], v[214:215], s[78:79] op_sel_hi:[1,0]
    v_cvt_pk_bf16_f32 v28, v212, v213
    v_cvt_pk_bf16_f32 v29, v214, v215
    ds_write_b64 v93, v[28:29] offset:1280
    v_pk_mul_f32 v[216:217], v[216:217], s[78:79] op_sel_hi:[1,0]
    v_pk_mul_f32 v[218:219], v[218:219], s[78:79] op_sel_hi:[1,0]
    v_cvt_pk_bf16_f32 v30, v216, v217
    v_cvt_pk_bf16_f32 v31, v218, v219
    ds_write_b64 v93, v[30:31] offset:32
    v_pk_mul_f32 v[220:221], v[220:221], s[78:79] op_sel_hi:[1,0]
    v_pk_mul_f32 v[222:223], v[222:223], s[78:79] op_sel_hi:[1,0]
    v_cvt_pk_bf16_f32 v32, v220, v221
    v_cvt_pk_bf16_f32 v33, v222, v223
    ds_write_b64 v93, v[32:33] offset:1312
    v_pk_mul_f32 v[224:225], v[224:225], s[78:79] op_sel_hi:[1,0]
    v_pk_mul_f32 v[226:227], v[226:227], s[78:79] op_sel_hi:[1,0]
    v_cvt_pk_bf16_f32 v26, v224, v225
    v_cvt_pk_bf16_f32 v27, v226, v227
    ds_write_b64 v93, v[26:27] offset:64
    v_pk_mul_f32 v[228:229], v[228:229], s[78:79] op_sel_hi:[1,0]
    v_pk_mul_f32 v[230:231], v[230:231], s[78:79] op_sel_hi:[1,0]
    v_cvt_pk_bf16_f32 v28, v228, v229
    v_cvt_pk_bf16_f32 v29, v230, v231
    ds_write_b64 v93, v[28:29] offset:1344
    v_pk_mul_f32 v[232:233], v[232:233], s[78:79] op_sel_hi:[1,0]
    v_pk_mul_f32 v[234:235], v[234:235], s[78:79] op_sel_hi:[1,0]
    v_cvt_pk_bf16_f32 v30, v232, v233
    v_cvt_pk_bf16_f32 v31, v234, v235
    ds_write_b64 v93, v[30:31] offset:96
    v_pk_mul_f32 v[236:237], v[236:237], s[78:79] op_sel_hi:[1,0]
    v_pk_mul_f32 v[238:239], v[238:239], s[78:79] op_sel_hi:[1,0]
    v_cvt_pk_bf16_f32 v32, v236, v237
    v_cvt_pk_bf16_f32 v33, v238, v239
    ds_write_b64 v93, v[32:33] offset:1376
    v_pk_mul_f32 v[240:241], v[240:241], s[78:79] op_sel_hi:[1,0]
    v_pk_mul_f32 v[242:243], v[242:243], s[78:79] op_sel_hi:[1,0]
    v_cvt_pk_bf16_f32 v26, v240, v241
    v_cvt_pk_bf16_f32 v27, v242, v243
    ds_write_b64 v93, v[26:27] offset:128
    v_pk_mul_f32 v[244:245], v[244:245], s[78:79] op_sel_hi:[1,0]
    v_pk_mul_f32 v[246:247], v[246:247], s[78:79] op_sel_hi:[1,0]
    v_cvt_pk_bf16_f32 v28, v244, v245
    v_cvt_pk_bf16_f32 v29, v246, v247
    ds_write_b64 v93, v[28:29] offset:1408
    v_accvgpr_write_b32 a106, 0
    v_accvgpr_write_b32 a107, 0
    v_accvgpr_write_b32 a114, 0
    v_accvgpr_write_b32 a115, 0
    v_accvgpr_write_b32 a122, 0
    v_accvgpr_write_b32 a123, 0
    s_cmp_ge_u32 s35, 2
    s_cbranch_scc1 on_13
    s_add_u32 s38, s35, 1
    s_cmp_ge_u32 s33, s38
    s_cselect_b32 s39, 0x3f803f80, 0
    s_mul_i32 s38, s35, 41216
    s_sub_u32 s38, 82176, s38
    v_lshlrev_b32 v36, 2, v1
    v_add_u32 v36, s38, v36
    v_mov_b32 v37, s39
    ds_write_b32 v36, v37
on_13:
    s_cmp_eq_u32 s33, 0
    s_cbranch_scc1 nb_14
    s_cmp_lg_u32 s35, 0
    s_cbranch_scc1 pollsk_17
    s_mov_b32 s60, 0
    s_waitcnt vmcnt(0)
    v_cmp_ne_u32 vcc, s40, v121
    s_nop 1
    s_cmp_eq_u64 vcc, 0
    s_cbranch_scc1 pollsk_17
    buffer_load_dword v121, v94, s[24:27], 0 offen sc1
    s_sleep 3
    buffer_load_dword v122, v94, s[24:27], 0 offen sc1
    s_sleep 3
    buffer_load_dword v123, v94, s[24:27], 0 offen sc1
poll_15:
    s_waitcnt vmcnt(2)
    v_cmp_ne_u32 vcc, s40, v121
    s_nop 1
    s_cmp_eq_u64 vcc, 0
    s_cbranch_scc1 polld_16
    buffer_load_dword v121, v94, s[24:27], 0 offen sc1
    s_waitcnt vmcnt(2)
    v_cmp_ne_u32 vcc, s40, v122
    s_nop 1
    s_cmp_eq_u64 vcc, 0
    s_cbranch_scc1 polld_16
    buffer_load_dword v122, v94, s[24:27], 0 offen sc1
    s_waitcnt vmcnt(2)
    v_cmp_ne_u32 vcc, s40, v123
    s_nop 1
    s_cmp_eq_u64 vcc, 0
    s_cbranch_scc1 polld_16
    buffer_load_dword v123, v94, s[24:27], 0 offen sc1
    s_add_u32 s60, s60, 1
    s_cmp_lt_u32 s60, 20000
    s_cbranch_scc1 poll_15
polld_16:
pollsk_17:
nb_14:
    s_waitcnt lgkmcnt(0)
    s_barrier
    s_mul_i32 s38, s35, 10240
    s_add_u32 s38, s38, 41216
    s_mov_b32 m0, s38
    s_add_u32 s39, s86, 0
    buffer_load_dwordx4 v118, s[24:27], s39 offen offset:0 sc1 lds
    buffer_load_dwordx4 v118, s[24:27], s39 offen offset:1024 sc1 lds
    buffer_load_dwordx4 v118, s[24:27], s39 offen offset:2048 sc1 lds
    buffer_load_dwordx4 v118, s[24:27], s39 offen offset:3072 sc1 lds
    v_mul_u32_u24 v26, 160, v117
    s_mul_i32 s88, s35, 40
    s_add_u32 s88, s88, 143360
    v_add_u32 v27, s88, v26
    v_lshl_add_u32 v26, v116, 4, v27
    ds_read_b64 v[160:161], v26 offset:15360
    ds_read_b64 v[162:163], v26 offset:15368
    ds_read_b64 v[164:165], v27 offset:15392
    ds_read_b64 v[152:153], v26 offset:10240
    ds_read_b64 v[154:155], v26 offset:10248
    ds_read_b64 v[156:157], v27 offset:10272
    ds_read_b64 v[144:145], v26 offset:5120
    ds_read_b64 v[146:147], v26 offset:5128
    ds_read_b64 v[148:149], v27 offset:5152
    ds_read_b64 v[136:137], v26 offset:0
    ds_read_b64 v[138:139], v26 offset:8
    ds_read_b64 v[140:141], v27 offset:32
    ds_read_b64_tr_b16 a[100:101], v115 offset:0
    ds_read_b64_tr_b16 a[102:103], v115 offset:1024
    ds_read_b64_tr_b16 a[104:105], v115 offset:4096
    ds_read_b64_tr_b16 a[108:109], v114 offset:0
    ds_read_b64_tr_b16 a[110:111], v114 offset:1024
    ds_read_b64_tr_b16 a[112:113], v114 offset:4096
    ds_read_b128 a[124:127], v86 offset:0
    ds_read_b128 a[128:131], v87 offset:0
    s_mov_b32 s55, s72
    v_cmp_eq_u32 vcc, 0, v116
    v_mov_b32 v142, 0
    v_mov_b32 v143, 0
    v_mov_b32 v150, 0
    v_mov_b32 v151, 0
    v_mov_b32 v158, 0
    v_mov_b32 v159, 0
    v_mov_b32 v166, 0
    v_mov_b32 v167, 0
    s_waitcnt lgkmcnt(5)
    v_cndmask_b32 v140, 0, v140, vcc
    v_cndmask_b32 v141, 0, v141, vcc
    v_cndmask_b32 v148, 0, v148, vcc
    v_cndmask_b32 v149, 0, v149, vcc
    v_cndmask_b32 v156, 0, v156, vcc
    v_cndmask_b32 v157, 0, v157, vcc
    v_cndmask_b32 v164, 0, v164, vcc
    v_cndmask_b32 v165, 0, v165, vcc
    s_nop 1
    v_mfma_f32_32x32x16_bf16 v[40:55], a[100:103], v[160:163], v[96:111]
    v_mfma_f32_32x32x16_bf16 v[40:55], a[104:107], v[164:167], v[40:55]
    s_nop 7
    s_waitcnt lgkmcnt(2)
    v_mfma_f32_32x32x16_bf16 v[56:71], a[108:111], v[152:155], v[96:111]
    ds_read_b128 a[132:135], v84 offset:0
    ds_read_b128 a[136:139], v85 offset:0
    s_mul_i32 s38, s35, 10240
    v_exp_f32 v40, v40
    v_exp_f32 v41, v41
    v_exp_f32 v42, v42
    v_mfma_f32_32x32x16_bf16 v[56:71], a[112:115], v[156:159], v[56:71]
    s_add_u32 s38, s38, 45312
    s_mov_b32 m0, s38
    s_add_u32 s39, s86, 4096
    v_exp_f32 v43, v43
    v_exp_f32 v44, v44
    v_exp_f32 v45, v45
    v_cvt_pk_bf16_f32 v72, v40, v41
    buffer_load_dwordx4 v118, s[24:27], s39 offen offset:0 sc1 lds
    buffer_load_dwordx4 v118, s[24:27], s39 offen offset:1024 sc1 lds
    buffer_load_dwordx4 v118, s[24:27], s39 offen offset:2048 sc1 lds
    v_exp_f32 v46, v46
    v_exp_f32 v47, v47
    v_exp_f32 v48, v48
    v_cvt_pk_bf16_f32 v73, v42, v43
    v_cvt_pk_bf16_f32 v74, v44, v45
    buffer_load_dwordx4 v118, s[24:27], s39 offen offset:3072 sc1 lds
    v_exp_f32 v49, v49
    v_exp_f32 v50, v50
    v_exp_f32 v51, v51
    v_cvt_pk_bf16_f32 v75, v46, v47
    v_exp_f32 v52, v52
    v_exp_f32 v53, v53
    v_exp_f32 v54, v54
    v_exp_f32 v55, v55
    v_cvt_pk_bf16_f32 v76, v48, v49
    v_cvt_pk_bf16_f32 v77, v50, v51
    v_cvt_pk_bf16_f32 v78, v52, v53
    v_cvt_pk_bf16_f32 v79, v54, v55
    v_mfma_f32_32x32x16_bf16 v[40:55], a[108:111], v[160:163], 0
    ds_read_b64_tr_b16 a[116:117], v113 offset:0
    ds_read_b64_tr_b16 a[118:119], v113 offset:1024
    ds_read_b64_tr_b16 a[120:121], v113 offset:4096
    v_exp_f32 v56, v56
    v_exp_f32 v57, v57
    v_exp_f32 v58, v58
    v_mfma_f32_32x32x16_bf16 v[40:55], a[112:115], v[164:167], v[40:55]
    s_mul_i32 s38, s35, 10240
    s_add_u32 s38, s38, 49408
    s_mov_b32 m0, s38
    v_exp_f32 v59, v59
    v_exp_f32 v60, v60
    v_exp_f32 v61, v61
    v_cvt_pk_bf16_f32 v128, v56, v57
    s_waitcnt lgkmcnt(5)
    v_mfma_f32_32x32x16_bf16 v[216:231], a[124:127], v[72:75], 0
    s_add_u32 s39, s86, 8192
    buffer_load_dwordx4 v118, s[24:27], s39 offen offset:0 sc1 lds
    buffer_load_dwordx4 v118, s[24:27], s39 offen offset:1024 sc1 lds
    v_exp_f32 v62, v62
    v_exp_f32 v63, v63
    v_exp_f32 v64, v64
    v_cvt_pk_bf16_f32 v129, v58, v59
    v_cvt_pk_bf16_f32 v130, v60, v61
    v_mfma_f32_32x32x16_bf16 v[216:231], a[128:131], v[76:79], v[216:231]
    v_exp_f32 v65, v65
    v_exp_f32 v66, v66
    v_exp_f32 v67, v67
    v_cvt_pk_bf16_f32 v131, v62, v63
    v_exp_f32 v68, v68
    v_exp_f32 v69, v69
    v_exp_f32 v70, v70
    v_exp_f32 v71, v71
    v_cvt_pk_bf16_f32 v132, v64, v65
    v_cvt_pk_bf16_f32 v133, v66, v67
    v_cvt_pk_bf16_f32 v134, v68, v69
    v_cvt_pk_bf16_f32 v135, v70, v71
    s_waitcnt lgkmcnt(0)
    v_mfma_f32_32x32x16_bf16 v[56:71], a[116:119], v[144:147], v[96:111]
    ds_read_b128 a[140:143], v82 offset:0
    ds_read_b128 a[144:147], v83 offset:0
    s_mul_i32 s38, s35, 10240
    v_exp_f32 v40, v40
    v_exp_f32 v41, v41
    v_exp_f32 v42, v42
    v_mfma_f32_32x32x16_bf16 v[56:71], a[120:123], v[148:151], v[56:71]
    s_add_u32 s38, s38, 0
    s_mov_b32 m0, s38
    s_add_u32 s39, s87, 0
    v_exp_f32 v43, v43
    v_exp_f32 v44, v44
    v_exp_f32 v45, v45
    v_cvt_pk_bf16_f32 v72, v40, v41
    s_waitcnt lgkmcnt(5)
    v_mfma_f32_32x32x16_bf16 v[200:215], a[132:135], v[128:131], 0
    buffer_load_dwordx4 v118, s[24:27], s39 offen offset:0 sc1 lds
    buffer_load_dwordx4 v118, s[24:27], s39 offen offset:1024 sc1 lds
    buffer_load_dwordx4 v118, s[24:27], s39 offen offset:2048 sc1 lds
    v_exp_f32 v46, v46
    v_exp_f32 v47, v47
    v_exp_f32 v48, v48
    v_cvt_pk_bf16_f32 v73, v42, v43
    v_cvt_pk_bf16_f32 v74, v44, v45
    v_mfma_f32_32x32x16_bf16 v[200:215], a[136:139], v[132:135], v[200:215]
    buffer_load_dwordx4 v118, s[24:27], s39 offen offset:3072 sc1 lds
    v_exp_f32 v49, v49
    v_exp_f32 v50, v50
    v_exp_f32 v51, v51
    v_cvt_pk_bf16_f32 v75, v46, v47
    v_exp_f32 v52, v52
    v_exp_f32 v53, v53
    v_exp_f32 v54, v54
    v_exp_f32 v55, v55
    v_cvt_pk_bf16_f32 v76, v48, v49
    v_cvt_pk_bf16_f32 v77, v50, v51
    v_cvt_pk_bf16_f32 v78, v52, v53
    v_cvt_pk_bf16_f32 v79, v54, v55
    v_mfma_f32_32x32x16_bf16 v[40:55], a[116:119], v[152:155], 0
    s_mul_i32 s38, s35, 10240
    s_add_u32 s38, s38, 4096
    v_exp_f32 v56, v56
    v_exp_f32 v57, v57
    v_exp_f32 v58, v58
    v_mfma_f32_32x32x16_bf16 v[40:55], a[120:123], v[156:159], v[40:55]
    s_mov_b32 m0, s38
    s_add_u32 s39, s87, 4096
    v_exp_f32 v59, v59
    v_exp_f32 v60, v60
    v_exp_f32 v61, v61
    v_cvt_pk_bf16_f32 v128, v56, v57
    v_mfma_f32_32x32x16_bf16 v[216:231], a[132:135], v[72:75], v[216:231]
    buffer_load_dwordx4 v118, s[24:27], s39 offen offset:0 sc1 lds
    buffer_load_dwordx4 v118, s[24:27], s39 offen offset:1024 sc1 lds
    v_exp_f32 v62, v62
    v_exp_f32 v63, v63
    v_exp_f32 v64, v64
    v_cvt_pk_bf16_f32 v129, v58, v59
    v_cvt_pk_bf16_f32 v130, v60, v61
    v_mfma_f32_32x32x16_bf16 v[216:231], a[136:139], v[76:79], v[216:231]
    buffer_load_dwordx4 v118, s[24:27], s39 offen offset:2048 sc1 lds
    buffer_load_dwordx4 v118, s[24:27], s39 offen offset:3072 sc1 lds
    v_exp_f32 v65, v65
    v_exp_f32 v66, v66
    v_exp_f32 v67, v67
    v_cvt_pk_bf16_f32 v131, v62, v63
    v_exp_f32 v68, v68
    v_exp_f32 v69, v69
    v_exp_f32 v70, v70
    v_exp_f32 v71, v71
    v_cvt_pk_bf16_f32 v132, v64, v65
    v_cvt_pk_bf16_f32 v133, v66, v67
    v_cvt_pk_bf16_f32 v134, v68, v69
    v_cvt_pk_bf16_f32 v135, v70, v71
    v_mfma_f32_32x32x16_bf16 v[56:71], a[116:119], v[160:163], 0
    ds_read_b64_tr_b16 a[100:101], v112 offset:0
    ds_read_b64_tr_b16 a[102:103], v112 offset:1024
    ds_read_b64_tr_b16 a[104:105], v112 offset:4096
    v_exp_f32 v40, v40
    v_exp_f32 v41, v41
    v_exp_f32 v42, v42
    v_mfma_f32_32x32x16_bf16 v[56:71], a[120:123], v[164:167], v[56:71]
    s_mul_i32 s38, s35, 10240
    s_add_u32 s38, s38, 8192
    s_mov_b32 m0, s38
    v_exp_f32 v43, v43
    v_exp_f32 v44, v44
    v_exp_f32 v45, v45
    v_cvt_pk_bf16_f32 v72, v40, v41
    s_waitcnt lgkmcnt(3)
    v_mfma_f32_32x32x16_bf16 v[184:199], a[140:143], v[128:131], 0
    s_add_u32 s39, s87, 8192
    buffer_load_dwordx4 v118, s[24:27], s39 offen offset:0 sc1 lds
    buffer_load_dwordx4 v118, s[24:27], s39 offen offset:1024 sc1 lds
    v_exp_f32 v46, v46
    v_exp_f32 v47, v47
    v_exp_f32 v48, v48
    v_cvt_pk_bf16_f32 v73, v42, v43
    v_cvt_pk_bf16_f32 v74, v44, v45
    v_mfma_f32_32x32x16_bf16 v[184:199], a[144:147], v[132:135], v[184:199]
    v_exp_f32 v49, v49
    v_exp_f32 v50, v50
    v_exp_f32 v51, v51
    v_cvt_pk_bf16_f32 v75, v46, v47
    v_exp_f32 v52, v52
    v_exp_f32 v53, v53
    v_exp_f32 v54, v54
    v_exp_f32 v55, v55
    v_cvt_pk_bf16_f32 v76, v48, v49
    v_cvt_pk_bf16_f32 v77, v50, v51
    v_cvt_pk_bf16_f32 v78, v52, v53
    v_cvt_pk_bf16_f32 v79, v54, v55
    s_waitcnt lgkmcnt(0)
    v_mfma_f32_32x32x16_bf16 v[40:55], a[100:103], v[136:139], v[96:111]
    ds_read_b128 a[124:127], v80 offset:0
    ds_read_b128 a[128:131], v81 offset:0
    v_add_u32 v28, 0, v0
    v_mul_u32_u24 v29, 6554, v28
    v_exp_f32 v56, v56
    v_exp_f32 v57, v57
    v_exp_f32 v58, v58
    v_mfma_f32_32x32x16_bf16 v[40:55], a[104:107], v[140:143], v[40:55]
    v_lshrrev_b32 v29, 20, v29
    v_mul_u32_u24 v29, 17920, v29
    v_lshl_add_u32 v232, v28, 4, v29
    v_add_u32 v28, 256, v0
    v_exp_f32 v59, v59
    v_exp_f32 v60, v60
    v_exp_f32 v61, v61
    v_cvt_pk_bf16_f32 v128, v56, v57
    v_mfma_f32_32x32x16_bf16 v[200:215], a[140:143], v[72:75], v[200:215]
    v_mul_u32_u24 v29, 6554, v28
    v_lshrrev_b32 v29, 20, v29
    v_mul_u32_u24 v29, 17920, v29
    v_lshl_add_u32 v233, v28, 4, v29
    v_exp_f32 v62, v62
    v_exp_f32 v63, v63
    v_exp_f32 v64, v64
    v_cvt_pk_bf16_f32 v129, v58, v59
    v_cvt_pk_bf16_f32 v130, v60, v61
    v_mfma_f32_32x32x16_bf16 v[200:215], a[144:147], v[76:79], v[200:215]
    v_add_u32 v28, 512, v0
    v_exp_f32 v65, v65
    v_exp_f32 v66, v66
    v_exp_f32 v67, v67
    v_cvt_pk_bf16_f32 v131, v62, v63
    v_exp_f32 v68, v68
    v_exp_f32 v69, v69
    v_exp_f32 v70, v70
    v_exp_f32 v71, v71
    v_cvt_pk_bf16_f32 v132, v64, v65
    v_cvt_pk_bf16_f32 v133, v66, v67
    v_cvt_pk_bf16_f32 v134, v68, v69
    v_cvt_pk_bf16_f32 v135, v70, v71
    v_mfma_f32_32x32x16_bf16 v[56:71], a[100:103], v[144:147], 0
    v_mul_u32_u24 v29, 6554, v28
    v_lshrrev_b32 v29, 20, v29
    v_mul_u32_u24 v29, 17920, v29
    v_exp_f32 v40, v40
    v_exp_f32 v41, v41
    v_exp_f32 v42, v42
    v_mfma_f32_32x32x16_bf16 v[56:71], a[104:107], v[148:151], v[56:71]
    v_lshl_add_u32 v234, v28, 4, v29
    v_add_u32 v28, 768, v0
    v_mul_u32_u24 v29, 6554, v28
    v_exp_f32 v43, v43
    v_exp_f32 v44, v44
    v_exp_f32 v45, v45
    v_cvt_pk_bf16_f32 v72, v40, v41
    v_mfma_f32_32x32x16_bf16 v[216:231], a[140:143], v[128:131], v[216:231]
    v_lshrrev_b32 v29, 20, v29
    v_mul_u32_u24 v29, 17920, v29
    v_lshl_add_u32 v235, v28, 4, v29
    v_exp_f32 v46, v46
    v_exp_f32 v47, v47
    v_exp_f32 v48, v48
    v_cvt_pk_bf16_f32 v73, v42, v43
    v_cvt_pk_bf16_f32 v74, v44, v45
    v_mfma_f32_32x32x16_bf16 v[216:231], a[144:147], v[132:135], v[216:231]
    v_add_u32 v28, 1024, v0
    v_mul_u32_u24 v29, 6554, v28
    v_exp_f32 v49, v49
    v_exp_f32 v50, v50
    v_exp_f32 v51, v51
    v_cvt_pk_bf16_f32 v75, v46, v47
    v_lshlrev_b32 v30, 2, v116
    v_sub_u32 v30, v30, v117
    v_cvt_f32_i32 v30, v30
    v_mov_b32 v31, 0x71800000
    v_fmaak_f32 v96, v30, v31, 0xf1000000
    v_fmaak_f32 v97, v30, v31, 0x71000000
    v_fmaak_f32 v98, v30, v31, 0x71c00000
    v_fmaak_f32 v99, v30, v31, 0x72200000
    v_fmaak_f32 v100, v30, v31, 0x72f00000
    v_fmaak_f32 v101, v30, v31, 0x73080000
    v_fmaak_f32 v102, v30, v31, 0x73180000
    v_fmaak_f32 v103, v30, v31, 0x73280000
    v_fmaak_f32 v104, v30, v31, 0x73780000
    v_fmaak_f32 v105, v30, v31, 0x73840000
    v_fmaak_f32 v106, v30, v31, 0x738c0000
    v_fmaak_f32 v107, v30, v31, 0x73940000
    v_fmaak_f32 v108, v30, v31, 0x73bc0000
    v_fmaak_f32 v109, v30, v31, 0x73c40000
    v_fmaak_f32 v110, v30, v31, 0x73cc0000
    v_fmaak_f32 v111, v30, v31, 0x73d40000
    v_min_f32 v96, 0, v96
    v_min_f32 v97, 0, v97
    v_min_f32 v98, 0, v98
    v_min_f32 v99, 0, v99
    v_min_f32 v100, 0, v100
    v_min_f32 v101, 0, v101
    v_min_f32 v102, 0, v102
    v_min_f32 v103, 0, v103
    v_min_f32 v104, 0, v104
    v_min_f32 v105, 0, v105
    v_min_f32 v106, 0, v106
    v_min_f32 v107, 0, v107
    v_min_f32 v108, 0, v108
    v_min_f32 v109, 0, v109
    v_min_f32 v110, 0, v110
    v_min_f32 v111, 0, v111
    v_exp_f32 v52, v52
    v_exp_f32 v53, v53
    v_exp_f32 v54, v54
    v_exp_f32 v55, v55
    v_cvt_pk_bf16_f32 v76, v48, v49
    v_cvt_pk_bf16_f32 v77, v50, v51
    v_cvt_pk_bf16_f32 v78, v52, v53
    v_cvt_pk_bf16_f32 v79, v54, v55
    v_mfma_f32_32x32x16_bf16 v[40:55], a[100:103], v[152:155], 0
    v_lshrrev_b32 v29, 20, v29
    v_mul_u32_u24 v29, 17920, v29
    v_lshl_add_u32 v236, v28, 4, v29
    v_exp_f32 v56, v56
    v_exp_f32 v57, v57
    v_exp_f32 v58, v58
    v_mfma_f32_32x32x16_bf16 v[40:55], a[104:107], v[156:159], v[40:55]
    s_lshl_b32 s89, s32, 4
    s_add_u32 s89, s89, s33
    s_mul_i32 s89, s89, 163840
    v_exp_f32 v59, v59
    v_exp_f32 v60, v60
    v_exp_f32 v61, v61
    v_cvt_pk_bf16_f32 v128, v56, v57
    s_waitcnt lgkmcnt(0)
    v_mfma_f32_32x32x16_bf16 v[168:183], a[124:127], v[72:75], 0
    s_mul_i32 s90, s34, 2560
    s_add_u32 s89, s89, s90
    s_add_u32 s89, s89, 8650752
    v_exp_f32 v62, v62
    v_exp_f32 v63, v63
    v_exp_f32 v64, v64
    v_cvt_pk_bf16_f32 v129, v58, v59
    v_cvt_pk_bf16_f32 v130, v60, v61
    v_mfma_f32_32x32x16_bf16 v[168:183], a[128:131], v[76:79], v[168:183]
    s_mul_i32 s39, s35, 5
    v_add_u32 v237, s39, v116
    v_exp_f32 v65, v65
    v_exp_f32 v66, v66
    v_exp_f32 v67, v67
    v_cvt_pk_bf16_f32 v131, v62, v63
    v_exp_f32 v68, v68
    v_exp_f32 v69, v69
    v_exp_f32 v70, v70
    v_exp_f32 v71, v71
    v_cvt_pk_bf16_f32 v132, v64, v65
    v_cvt_pk_bf16_f32 v133, v66, v67
    v_cvt_pk_bf16_f32 v134, v68, v69
    v_cvt_pk_bf16_f32 v135, v70, v71
    s_waitcnt vmcnt(10)
    s_barrier
    v_mfma_f32_32x32x16_bf16 v[56:71], a[100:103], v[160:163], 0
    v_subrev_u32 v112, 82432, v112
    v_subrev_u32 v113, 82432, v113
    v_subrev_u32 v114, 82432, v114
    v_subrev_u32 v115, 82432, v115
    ds_read_b64_tr_b16 a[108:109], v115 offset:41216
    v_exp_f32 v40, v40
    v_exp_f32 v41, v41
    v_exp_f32 v42, v42
    v_mfma_f32_32x32x16_bf16 v[56:71], a[104:107], v[164:167], v[56:71]
    ds_read_b64_tr_b16 a[110:111], v115 offset:42240
    ds_read_b64_tr_b16 a[112:113], v115 offset:45312
    v_and_b32 v28, 1, v237
    v_lshrrev_b32 v237, 1, v237
    v_lshlrev_b32 v237, 8, v237
    v_exp_f32 v43, v43
    v_exp_f32 v44, v44
    v_exp_f32 v45, v45
    v_cvt_pk_bf16_f32 v72, v40, v41
    v_mfma_f32_32x32x16_bf16 v[184:199], a[124:127], v[128:131], v[184:199]
    v_lshl_add_u32 v237, v28, 3, v237
    v_and_b32 v28, 15, v117
    v_lshl_add_u32 v237, v28, 4, v237
    v_lshrrev_b32 v28, 4, v117
    v_mul_u32_u24 v28, 2560, v28
    v_exp_f32 v46, v46
    v_exp_f32 v47, v47
    v_exp_f32 v48, v48
    v_cvt_pk_bf16_f32 v73, v42, v43
    v_cvt_pk_bf16_f32 v74, v44, v45
    v_mfma_f32_32x32x16_bf16 v[184:199], a[128:131], v[132:135], v[184:199]
    v_add_u32 v237, v237, v28
    v_add_u32 v237, 143360, v237
    v_exp_f32 v49, v49
    v_exp_f32 v50, v50
    v_exp_f32 v51, v51
    v_cvt_pk_bf16_f32 v75, v46, v47
    v_exp_f32 v52, v52
    v_exp_f32 v53, v53
    v_exp_f32 v54, v54
    v_exp_f32 v55, v55
    v_cvt_pk_bf16_f32 v76, v48, v49
    v_cvt_pk_bf16_f32 v77, v50, v51
    v_cvt_pk_bf16_f32 v78, v52, v53
    v_cvt_pk_bf16_f32 v79, v54, v55
    s_waitcnt lgkmcnt(0)
    v_mfma_f32_32x32x16_bf16 v[40:55], a[108:111], v[136:139], 0
    v_subrev_u32 v80, 82432, v80
    v_subrev_u32 v81, 82432, v81
    v_subrev_u32 v82, 82432, v82
    v_exp_f32 v56, v56
    v_exp_f32 v57, v57
    v_exp_f32 v58, v58
    v_mfma_f32_32x32x16_bf16 v[40:55], a[112:115], v[140:143], v[40:55]
    v_subrev_u32 v83, 82432, v83
    v_subrev_u32 v84, 82432, v84
    v_subrev_u32 v85, 82432, v85
    v_exp_f32 v59, v59
    v_exp_f32 v60, v60
    v_exp_f32 v61, v61
    v_cvt_pk_bf16_f32 v128, v56, v57
    v_mfma_f32_32x32x16_bf16 v[200:215], a[124:127], v[72:75], v[200:215]
    v_subrev_u32 v86, 82432, v86
    v_subrev_u32 v87, 82432, v87
    ds_read_b128 a[132:135], v86 offset:41216
    v_exp_f32 v62, v62
    v_exp_f32 v63, v63
    v_exp_f32 v64, v64
    v_cvt_pk_bf16_f32 v129, v58, v59
    v_cvt_pk_bf16_f32 v130, v60, v61
    v_mfma_f32_32x32x16_bf16 v[200:215], a[128:131], v[76:79], v[200:215]
    ds_read_b128 a[136:139], v87 offset:41216
    buffer_load_dwordx4 a[0:3], v88, s[16:19], s97 offen offset:0
    v_exp_f32 v65, v65
    v_exp_f32 v66, v66
    v_exp_f32 v67, v67
    v_cvt_pk_bf16_f32 v131, v62, v63
    v_exp_f32 v68, v68
    v_exp_f32 v69, v69
    v_exp_f32 v70, v70
    v_exp_f32 v71, v71
    v_cvt_pk_bf16_f32 v132, v64, v65
    v_cvt_pk_bf16_f32 v133, v66, v67
    v_cvt_pk_bf16_f32 v134, v68, v69
    v_cvt_pk_bf16_f32 v135, v70, v71
    v_mfma_f32_32x32x16_bf16 v[56:71], a[108:111], v[144:147], 0
    buffer_load_dwordx4 a[4:7], v89, s[16:19], s97 offen offset:1024
    v_exp_f32 v40, v40
    v_exp_f32 v41, v41
    v_exp_f32 v42, v42
    v_mfma_f32_32x32x16_bf16 v[56:71], a[112:115], v[148:151], v[56:71]
    v_exp_f32 v43, v43
    v_exp_f32 v44, v44
    v_exp_f32 v45, v45
    v_cvt_pk_bf16_f32 v72, v40, v41
    v_mfma_f32_32x32x16_bf16 v[216:231], a[124:127], v[128:131], v[216:231]
    v_exp_f32 v46, v46
    v_exp_f32 v47, v47
    v_exp_f32 v48, v48
    v_cvt_pk_bf16_f32 v73, v42, v43
    v_cvt_pk_bf16_f32 v74, v44, v45
    v_mfma_f32_32x32x16_bf16 v[216:231], a[128:131], v[132:135], v[216:231]
    v_exp_f32 v49, v49
    v_exp_f32 v50, v50
    v_exp_f32 v51, v51
    v_cvt_pk_bf16_f32 v75, v46, v47
    v_exp_f32 v52, v52
    v_exp_f32 v53, v53
    v_exp_f32 v54, v54
    v_exp_f32 v55, v55
    v_cvt_pk_bf16_f32 v76, v48, v49
    v_cvt_pk_bf16_f32 v77, v50, v51
    v_cvt_pk_bf16_f32 v78, v52, v53
    v_cvt_pk_bf16_f32 v79, v54, v55
    v_mfma_f32_32x32x16_bf16 v[40:55], a[108:111], v[152:155], 0
    buffer_load_dwordx4 a[8:11], v90, s[16:19], s97 offen offset:2048
    v_exp_f32 v56, v56
    v_exp_f32 v57, v57
    v_exp_f32 v58, v58
    v_mfma_f32_32x32x16_bf16 v[40:55], a[112:115], v[156:159], v[40:55]
    v_exp_f32 v59, v59
    v_exp_f32 v60, v60
    v_exp_f32 v61, v61
    v_cvt_pk_bf16_f32 v128, v56, v57
    s_waitcnt lgkmcnt(0)
    v_mfma_f32_32x32x16_bf16 v[168:183], a[132:135], v[72:75], v[168:183]
    v_exp_f32 v62, v62
    v_exp_f32 v63, v63
    v_exp_f32 v64, v64
    v_cvt_pk_bf16_f32 v129, v58, v59
    v_cvt_pk_bf16_f32 v130, v60, v61
    v_mfma_f32_32x32x16_bf16 v[168:183], a[136:139], v[76:79], v[168:183]
    v_exp_f32 v65, v65
    v_exp_f32 v66, v66
    v_exp_f32 v67, v67
    v_cvt_pk_bf16_f32 v131, v62, v63
    v_exp_f32 v68, v68
    v_exp_f32 v69, v69
    v_exp_f32 v70, v70
    v_exp_f32 v71, v71
    v_cvt_pk_bf16_f32 v132, v64, v65
    v_cvt_pk_bf16_f32 v133, v66, v67
    v_cvt_pk_bf16_f32 v134, v68, v69
    v_cvt_pk_bf16_f32 v135, v70, v71
    v_mfma_f32_32x32x16_bf16 v[56:71], a[108:111], v[160:163], 0
    ds_read_b64_tr_b16 a[116:117], v114 offset:41216
    v_exp_f32 v40, v40
    v_exp_f32 v41, v41
    v_exp_f32 v42, v42
    v_mfma_f32_32x32x16_bf16 v[56:71], a[112:115], v[164:167], v[56:71]
    ds_read_b64_tr_b16 a[118:119], v114 offset:42240
    v_exp_f32 v43, v43
    v_exp_f32 v44, v44
    v_exp_f32 v45, v45
    v_cvt_pk_bf16_f32 v72, v40, v41
    v_mfma_f32_32x32x16_bf16 v[184:199], a[132:135], v[128:131], v[184:199]
    ds_read_b64_tr_b16 a[120:121], v114 offset:45312
    v_exp_f32 v46, v46
    v_exp_f32 v47, v47
    v_exp_f32 v48, v48
    v_cvt_pk_bf16_f32 v73, v42, v43
    v_cvt_pk_bf16_f32 v74, v44, v45
    v_mfma_f32_32x32x16_bf16 v[184:199], a[136:139], v[132:135], v[184:199]
    buffer_load_dwordx4 a[12:15], v91, s[16:19], s97 offen offset:3072
    v_exp_f32 v49, v49
    v_exp_f32 v50, v50
    v_exp_f32 v51, v51
    v_cvt_pk_bf16_f32 v75, v46, v47
    v_exp_f32 v52, v52
    v_exp_f32 v53, v53
    v_exp_f32 v54, v54
    v_exp_f32 v55, v55
    v_cvt_pk_bf16_f32 v76, v48, v49
    v_cvt_pk_bf16_f32 v77, v50, v51
    v_cvt_pk_bf16_f32 v78, v52, v53
    v_cvt_pk_bf16_f32 v79, v54, v55
    s_waitcnt lgkmcnt(0)
    v_mfma_f32_32x32x16_bf16 v[40:55], a[116:119], v[136:139], 0
    ds_read_b128 a[140:143], v84 offset:41216
    v_exp_f32 v56, v56
    v_exp_f32 v57, v57
    v_exp_f32 v58, v58
    v_mfma_f32_32x32x16_bf16 v[40:55], a[120:123], v[140:143], v[40:55]
    ds_read_b128 a[144:147], v85 offset:41216
    v_exp_f32 v59, v59
    v_exp_f32 v60, v60
    v_exp_f32 v61, v61
    v_cvt_pk_bf16_f32 v128, v56, v57
    v_mfma_f32_32x32x16_bf16 v[200:215], a[132:135], v[72:75], v[200:215]
    buffer_load_dwordx4 a[16:19], v92, s[16:19], s97 offen offset:0
    v_exp_f32 v62, v62
    v_exp_f32 v63, v63
    v_exp_f32 v64, v64
    v_cvt_pk_bf16_f32 v129, v58, v59
    v_cvt_pk_bf16_f32 v130, v60, v61
    v_mfma_f32_32x32x16_bf16 v[200:215], a[136:139], v[76:79], v[200:215]
    v_exp_f32 v65, v65
    v_exp_f32 v66, v66
    v_exp_f32 v67, v67
    v_cvt_pk_bf16_f32 v131, v62, v63
    v_exp_f32 v68, v68
    v_exp_f32 v69, v69
    v_exp_f32 v70, v70
    v_exp_f32 v71, v71
    v_cvt_pk_bf16_f32 v132, v64, v65
    v_cvt_pk_bf16_f32 v133, v66, v67
    v_cvt_pk_bf16_f32 v134, v68, v69
    v_cvt_pk_bf16_f32 v135, v70, v71
    v_mfma_f32_32x32x16_bf16 v[56:71], a[116:119], v[144:147], 0
    buffer_load_dwordx4 a[20:23], v88, s[16:19], s98 offen offset:0
    v_exp_f32 v40, v40
    v_exp_f32 v41, v41
    v_exp_f32 v42, v42
    v_mfma_f32_32x32x16_bf16 v[56:71], a[120:123], v[148:151], v[56:71]
    v_exp_f32 v43, v43
    v_exp_f32 v44, v44
    v_exp_f32 v45, v45
    v_cvt_pk_bf16_f32 v72, v40, v41
    v_mfma_f32_32x32x16_bf16 v[216:231], a[132:135], v[128:131], v[216:231]
    v_exp_f32 v46, v46
    v_exp_f32 v47, v47
    v_exp_f32 v48, v48
    v_cvt_pk_bf16_f32 v73, v42, v43
    v_cvt_pk_bf16_f32 v74, v44, v45
    v_mfma_f32_32x32x16_bf16 v[216:231], a[136:139], v[132:135], v[216:231]
    v_exp_f32 v49, v49
    v_exp_f32 v50, v50
    v_exp_f32 v51, v51
    v_cvt_pk_bf16_f32 v75, v46, v47
    v_exp_f32 v52, v52
    v_exp_f32 v53, v53
    v_exp_f32 v54, v54
    v_exp_f32 v55, v55
    v_cvt_pk_bf16_f32 v76, v48, v49
    v_cvt_pk_bf16_f32 v77, v50, v51
    v_cvt_pk_bf16_f32 v78, v52, v53
    v_cvt_pk_bf16_f32 v79, v54, v55
    v_mfma_f32_32x32x16_bf16 v[40:55], a[116:119], v[152:155], 0
    buffer_load_dwordx4 a[24:27], v89, s[16:19], s98 offen offset:1024
    v_exp_f32 v56, v56
    v_exp_f32 v57, v57
    v_exp_f32 v58, v58
    v_mfma_f32_32x32x16_bf16 v[40:55], a[120:123], v[156:159], v[40:55]
    v_exp_f32 v59, v59
    v_exp_f32 v60, v60
    v_exp_f32 v61, v61
    v_cvt_pk_bf16_f32 v128, v56, v57
    s_waitcnt lgkmcnt(0)
    v_mfma_f32_32x32x16_bf16 v[168:183], a[140:143], v[72:75], v[168:183]
    v_exp_f32 v62, v62
    v_exp_f32 v63, v63
    v_exp_f32 v64, v64
    v_cvt_pk_bf16_f32 v129, v58, v59
    v_cvt_pk_bf16_f32 v130, v60, v61
    v_mfma_f32_32x32x16_bf16 v[168:183], a[144:147], v[76:79], v[168:183]
    v_exp_f32 v65, v65
    v_exp_f32 v66, v66
    v_exp_f32 v67, v67
    v_cvt_pk_bf16_f32 v131, v62, v63
    v_exp_f32 v68, v68
    v_exp_f32 v69, v69
    v_exp_f32 v70, v70
    v_exp_f32 v71, v71
    v_cvt_pk_bf16_f32 v132, v64, v65
    v_cvt_pk_bf16_f32 v133, v66, v67
    v_cvt_pk_bf16_f32 v134, v68, v69
    v_cvt_pk_bf16_f32 v135, v70, v71
    v_mfma_f32_32x32x16_bf16 v[56:71], a[116:119], v[160:163], 0
    ds_read_b64_tr_b16 a[100:101], v113 offset:41216
    v_exp_f32 v40, v40
    v_exp_f32 v41, v41
    v_exp_f32 v42, v42
    v_mfma_f32_32x32x16_bf16 v[56:71], a[120:123], v[164:167], v[56:71]
    ds_read_b64_tr_b16 a[102:103], v113 offset:42240
    v_exp_f32 v43, v43
    v_exp_f32 v44, v44
    v_exp_f32 v45, v45
    v_cvt_pk_bf16_f32 v72, v40, v41
    v_mfma_f32_32x32x16_bf16 v[184:199], a[140:143], v[128:131], v[184:199]
    ds_read_b64_tr_b16 a[104:105], v113 offset:45312
    v_exp_f32 v46, v46
    v_exp_f32 v47, v47
    v_exp_f32 v48, v48
    v_cvt_pk_bf16_f32 v73, v42, v43
    v_cvt_pk_bf16_f32 v74, v44, v45
    v_mfma_f32_32x32x16_bf16 v[184:199], a[144:147], v[132:135], v[184:199]
    buffer_load_dwordx4 a[28:31], v90, s[16:19], s98 offen offset:2048
    v_exp_f32 v49, v49
    v_exp_f32 v50, v50
    v_exp_f32 v51, v51
    v_cvt_pk_bf16_f32 v75, v46, v47
    v_exp_f32 v52, v52
    v_exp_f32 v53, v53
    v_exp_f32 v54, v54
    v_exp_f32 v55, v55
    v_cvt_pk_bf16_f32 v76, v48, v49
    v_cvt_pk_bf16_f32 v77, v50, v51
    v_cvt_pk_bf16_f32 v78, v52, v53
    v_cvt_pk_bf16_f32 v79, v54, v55
    s_waitcnt lgkmcnt(0)
    v_mfma_f32_32x32x16_bf16 v[40:55], a[100:103], v[136:139], 0
    ds_read_b128 a[124:127], v82 offset:41216
    v_exp_f32 v56, v56
    v_exp_f32 v57, v57
    v_exp_f32 v58, v58
    v_mfma_f32_32x32x16_bf16 v[40:55], a[104:107], v[140:143], v[40:55]
    ds_read_b128 a[128:131], v83 offset:41216
    v_exp_f32 v59, v59
    v_exp_f32 v60, v60
    v_exp_f32 v61, v61
    v_cvt_pk_bf16_f32 v128, v56, v57
    v_mfma_f32_32x32x16_bf16 v[200:215], a[140:143], v[72:75], v[200:215]
    buffer_load_dwordx4 a[32:35], v91, s[16:19], s98 offen offset:3072
    v_exp_f32 v62, v62
    v_exp_f32 v63, v63
    v_exp_f32 v64, v64
    v_cvt_pk_bf16_f32 v129, v58, v59
    v_cvt_pk_bf16_f32 v130, v60, v61
    v_mfma_f32_32x32x16_bf16 v[200:215], a[144:147], v[76:79], v[200:215]
    v_exp_f32 v65, v65
    v_exp_f32 v66, v66
    v_exp_f32 v67, v67
    v_cvt_pk_bf16_f32 v131, v62, v63
    v_exp_f32 v68, v68
    v_exp_f32 v69, v69
    v_exp_f32 v70, v70
    v_exp_f32 v71, v71
    v_cvt_pk_bf16_f32 v132, v64, v65
    v_cvt_pk_bf16_f32 v133, v66, v67
    v_cvt_pk_bf16_f32 v134, v68, v69
    v_cvt_pk_bf16_f32 v135, v70, v71
    v_mfma_f32_32x32x16_bf16 v[56:71], a[100:103], v[144:147], 0
    buffer_load_dwordx4 a[36:39], v92, s[16:19], s98 offen offset:0
    v_exp_f32 v40, v40
    v_exp_f32 v41, v41
    v_exp_f32 v42, v42
    v_mfma_f32_32x32x16_bf16 v[56:71], a[104:107], v[148:151], v[56:71]
    v_exp_f32 v43, v43
    v_exp_f32 v44, v44
    v_exp_f32 v45, v45
    v_cvt_pk_bf16_f32 v72, v40, v41
    v_mfma_f32_32x32x16_bf16 v[216:231], a[140:143], v[128:131], v[216:231]
    v_exp_f32 v46, v46
    v_exp_f32 v47, v47
    v_exp_f32 v48, v48
    v_cvt_pk_bf16_f32 v73, v42, v43
    v_cvt_pk_bf16_f32 v74, v44, v45
    v_mfma_f32_32x32x16_bf16 v[216:231], a[144:147], v[132:135], v[216:231]
    v_exp_f32 v49, v49
    v_exp_f32 v50, v50
    v_exp_f32 v51, v51
    v_cvt_pk_bf16_f32 v75, v46, v47
    v_exp_f32 v52, v52
    v_exp_f32 v53, v53
    v_exp_f32 v54, v54
    v_exp_f32 v55, v55
    v_cvt_pk_bf16_f32 v76, v48, v49
    v_cvt_pk_bf16_f32 v77, v50, v51
    v_cvt_pk_bf16_f32 v78, v52, v53
    v_cvt_pk_bf16_f32 v79, v54, v55
    v_mfma_f32_32x32x16_bf16 v[40:55], a[100:103], v[152:155], 0
    buffer_load_dwordx4 a[40:43], v88, s[16:19], s99 offen offset:0
    v_exp_f32 v56, v56
    v_exp_f32 v57, v57
    v_exp_f32 v58, v58
    v_mfma_f32_32x32x16_bf16 v[40:55], a[104:107], v[156:159], v[40:55]
    v_exp_f32 v59, v59
    v_exp_f32 v60, v60
    v_exp_f32 v61, v61
    v_cvt_pk_bf16_f32 v128, v56, v57
    s_waitcnt lgkmcnt(0)
    v_mfma_f32_32x32x16_bf16 v[168:183], a[124:127], v[72:75], v[168:183]
    v_exp_f32 v62, v62
    v_exp_f32 v63, v63
    v_exp_f32 v64, v64
    v_cvt_pk_bf16_f32 v129, v58, v59
    v_cvt_pk_bf16_f32 v130, v60, v61
    v_mfma_f32_32x32x16_bf16 v[168:183], a[128:131], v[76:79], v[168:183]
    v_exp_f32 v65, v65
    v_exp_f32 v66, v66
    v_exp_f32 v67, v67
    v_cvt_pk_bf16_f32 v131, v62, v63
    v_exp_f32 v68, v68
    v_exp_f32 v69, v69
    v_exp_f32 v70, v70
    v_exp_f32 v71, v71
    v_cvt_pk_bf16_f32 v132, v64, v65
    v_cvt_pk_bf16_f32 v133, v66, v67
    v_cvt_pk_bf16_f32 v134, v68, v69
    v_cvt_pk_bf16_f32 v135, v70, v71
    v_mfma_f32_32x32x16_bf16 v[56:71], a[100:103], v[160:163], 0
    ds_read_b64_tr_b16 a[108:109], v112 offset:41216
    v_exp_f32 v40, v40
    v_exp_f32 v41, v41
    v_exp_f32 v42, v42
    v_mfma_f32_32x32x16_bf16 v[56:71], a[104:107], v[164:167], v[56:71]
    ds_read_b64_tr_b16 a[110:111], v112 offset:42240
    v_exp_f32 v43, v43
    v_exp_f32 v44, v44
    v_exp_f32 v45, v45
    v_cvt_pk_bf16_f32 v72, v40, v41
    v_mfma_f32_32x32x16_bf16 v[184:199], a[124:127], v[128:131], v[184:199]
    ds_read_b64_tr_b16 a[112:113], v112 offset:45312
    v_exp_f32 v46, v46
    v_exp_f32 v47, v47
    v_exp_f32 v48, v48
    v_cvt_pk_bf16_f32 v73, v42, v43
    v_cvt_pk_bf16_f32 v74, v44, v45
    v_mfma_f32_32x32x16_bf16 v[184:199], a[128:131], v[132:135], v[184:199]
    buffer_load_dwordx4 a[44:47], v89, s[16:19], s99 offen offset:1024
    v_exp_f32 v49, v49
    v_exp_f32 v50, v50
    v_exp_f32 v51, v51
    v_cvt_pk_bf16_f32 v75, v46, v47
    v_exp_f32 v52, v52
    v_exp_f32 v53, v53
    v_exp_f32 v54, v54
    v_exp_f32 v55, v55
    v_cvt_pk_bf16_f32 v76, v48, v49
    v_cvt_pk_bf16_f32 v77, v50, v51
    v_cvt_pk_bf16_f32 v78, v52, v53
    v_cvt_pk_bf16_f32 v79, v54, v55
    s_waitcnt lgkmcnt(0)
    v_mfma_f32_32x32x16_bf16 v[40:55], a[108:111], v[136:139], 0
    ds_read_b128 a[132:135], v80 offset:41216
    v_exp_f32 v56, v56
    v_exp_f32 v57, v57
    v_exp_f32 v58, v58
    v_mfma_f32_32x32x16_bf16 v[40:55], a[112:115], v[140:143], v[40:55]
    ds_read_b128 a[136:139], v81 offset:41216
    v_exp_f32 v59, v59
    v_exp_f32 v60, v60
    v_exp_f32 v61, v61
    v_cvt_pk_bf16_f32 v128, v56, v57
    v_mfma_f32_32x32x16_bf16 v[200:215], a[124:127], v[72:75], v[200:215]
    buffer_load_dwordx4 a[48:51], v90, s[16:19], s99 offen offset:2048
    v_exp_f32 v62, v62
    v_exp_f32 v63, v63
    v_exp_f32 v64, v64
    v_cvt_pk_bf16_f32 v129, v58, v59
    v_cvt_pk_bf16_f32 v130, v60, v61
    v_mfma_f32_32x32x16_bf16 v[200:215], a[128:131], v[76:79], v[200:215]
    v_exp_f32 v65, v65
    v_exp_f32 v66, v66
    v_exp_f32 v67, v67
    v_cvt_pk_bf16_f32 v131, v62, v63
    v_exp_f32 v68, v68
    v_exp_f32 v69, v69
    v_exp_f32 v70, v70
    v_exp_f32 v71, v71
    v_cvt_pk_bf16_f32 v132, v64, v65
    v_cvt_pk_bf16_f32 v133, v66, v67
    v_cvt_pk_bf16_f32 v134, v68, v69
    v_cvt_pk_bf16_f32 v135, v70, v71
    v_mfma_f32_32x32x16_bf16 v[56:71], a[108:111], v[144:147], 0
    buffer_load_dwordx4 a[52:55], v91, s[16:19], s99 offen offset:3072
    v_exp_f32 v40, v40
    v_exp_f32 v41, v41
    v_exp_f32 v42, v42
    v_mfma_f32_32x32x16_bf16 v[56:71], a[112:115], v[148:151], v[56:71]
    v_exp_f32 v43, v43
    v_exp_f32 v44, v44
    v_exp_f32 v45, v45
    v_cvt_pk_bf16_f32 v72, v40, v41
    v_mfma_f32_32x32x16_bf16 v[216:231], a[124:127], v[128:131], v[216:231]
    v_exp_f32 v46, v46
    v_exp_f32 v47, v47
    v_exp_f32 v48, v48
    v_cvt_pk_bf16_f32 v73, v42, v43
    v_cvt_pk_bf16_f32 v74, v44, v45
    v_mfma_f32_32x32x16_bf16 v[216:231], a[128:131], v[132:135], v[216:231]
    v_exp_f32 v49, v49
    v_exp_f32 v50, v50
    v_exp_f32 v51, v51
    v_cvt_pk_bf16_f32 v75, v46, v47
    v_exp_f32 v52, v52
    v_exp_f32 v53, v53
    v_exp_f32 v54, v54
    v_exp_f32 v55, v55
    v_cvt_pk_bf16_f32 v76, v48, v49
    v_cvt_pk_bf16_f32 v77, v50, v51
    v_cvt_pk_bf16_f32 v78, v52, v53
    v_cvt_pk_bf16_f32 v79, v54, v55
    v_mfma_f32_32x32x16_bf16 v[40:55], a[108:111], v[152:155], 0
    buffer_load_dwordx4 a[56:59], v92, s[16:19], s99 offen offset:0
    v_exp_f32 v56, v56
    v_exp_f32 v57, v57
    v_exp_f32 v58, v58
    v_mfma_f32_32x32x16_bf16 v[40:55], a[112:115], v[156:159], v[40:55]
    v_exp_f32 v59, v59
    v_exp_f32 v60, v60
    v_exp_f32 v61, v61
    v_cvt_pk_bf16_f32 v128, v56, v57
    s_waitcnt lgkmcnt(0)
    v_mfma_f32_32x32x16_bf16 v[168:183], a[132:135], v[72:75], v[168:183]
    v_exp_f32 v62, v62
    v_exp_f32 v63, v63
    v_exp_f32 v64, v64
    v_cvt_pk_bf16_f32 v129, v58, v59
    v_cvt_pk_bf16_f32 v130, v60, v61
    v_mfma_f32_32x32x16_bf16 v[168:183], a[136:139], v[76:79], v[168:183]
    v_exp_f32 v65, v65
    v_exp_f32 v66, v66
    v_exp_f32 v67, v67
    v_cvt_pk_bf16_f32 v131, v62, v63
    v_exp_f32 v68, v68
    v_exp_f32 v69, v69
    v_exp_f32 v70, v70
    v_exp_f32 v71, v71
    v_cvt_pk_bf16_f32 v132, v64, v65
    v_cvt_pk_bf16_f32 v133, v66, v67
    v_cvt_pk_bf16_f32 v134, v68, v69
    v_cvt_pk_bf16_f32 v135, v70, v71
    s_waitcnt vmcnt(15)
    s_barrier
    v_mfma_f32_32x32x16_bf16 v[56:71], a[108:111], v[160:163], 0
    ds_read_b64_tr_b16 a[116:117], v115 offset:0
    v_exp_f32 v40, v40
    v_exp_f32 v41, v41
    v_exp_f32 v42, v42
    v_mfma_f32_32x32x16_bf16 v[56:71], a[112:115], v[164:167], v[56:71]
    ds_read_b64_tr_b16 a[118:119], v115 offset:1024
    v_exp_f32 v43, v43
    v_exp_f32 v44, v44
    v_exp_f32 v45, v45
    v_cvt_pk_bf16_f32 v72, v40, v41
    v_mfma_f32_32x32x16_bf16 v[184:199], a[132:135], v[128:131], v[184:199]
    ds_read_b64_tr_b16 a[120:121], v115 offset:4096
    v_exp_f32 v46, v46
    v_exp_f32 v47, v47
    v_exp_f32 v48, v48
    v_cvt_pk_bf16_f32 v73, v42, v43
    v_cvt_pk_bf16_f32 v74, v44, v45
    v_mfma_f32_32x32x16_bf16 v[184:199], a[136:139], v[132:135], v[184:199]
    buffer_load_dwordx4 a[60:63], v88, s[16:19], s100 offen offset:0
    v_exp_f32 v49, v49
    v_exp_f32 v50, v50
    v_exp_f32 v51, v51
    v_cvt_pk_bf16_f32 v75, v46, v47
    v_exp_f32 v52, v52
    v_exp_f32 v53, v53
    v_exp_f32 v54, v54
    v_exp_f32 v55, v55
    v_cvt_pk_bf16_f32 v76, v48, v49
    v_cvt_pk_bf16_f32 v77, v50, v51
    v_cvt_pk_bf16_f32 v78, v52, v53
    v_cvt_pk_bf16_f32 v79, v54, v55
    s_waitcnt lgkmcnt(0)
    v_mfma_f32_32x32x16_bf16 v[40:55], a[116:119], v[136:139], 0
    ds_read_b128 a[140:143], v86 offset:0
    v_exp_f32 v56, v56
    v_exp_f32 v57, v57
    v_exp_f32 v58, v58
    v_mfma_f32_32x32x16_bf16 v[40:55], a[120:123], v[140:143], v[40:55]
    ds_read_b128 a[144:147], v87 offset:0
    v_exp_f32 v59, v59
    v_exp_f32 v60, v60
    v_exp_f32 v61, v61
    v_cvt_pk_bf16_f32 v128, v56, v57
    v_mfma_f32_32x32x16_bf16 v[200:215], a[132:135], v[72:75], v[200:215]
    buffer_load_dwordx4 a[64:67], v89, s[16:19], s100 offen offset:1024
    v_exp_f32 v62, v62
    v_exp_f32 v63, v63
    v_exp_f32 v64, v64
    v_cvt_pk_bf16_f32 v129, v58, v59
    v_cvt_pk_bf16_f32 v130, v60, v61
    v_mfma_f32_32x32x16_bf16 v[200:215], a[136:139], v[76:79], v[200:215]
    v_exp_f32 v65, v65
    v_exp_f32 v66, v66
    v_exp_f32 v67, v67
    v_cvt_pk_bf16_f32 v131, v62, v63
    v_exp_f32 v68, v68
    v_exp_f32 v69, v69
    v_exp_f32 v70, v70
    v_exp_f32 v71, v71
    v_cvt_pk_bf16_f32 v132, v64, v65
    v_cvt_pk_bf16_f32 v133, v66, v67
    v_cvt_pk_bf16_f32 v134, v68, v69
    v_cvt_pk_bf16_f32 v135, v70, v71
    v_mfma_f32_32x32x16_bf16 v[56:71], a[116:119], v[144:147], 0
    buffer_load_dwordx4 a[68:71], v90, s[16:19], s100 offen offset:2048
    v_exp_f32 v40, v40
    v_exp_f32 v41, v41
    v_exp_f32 v42, v42
    v_mfma_f32_32x32x16_bf16 v[56:71], a[120:123], v[148:151], v[56:71]
    v_exp_f32 v43, v43
    v_exp_f32 v44, v44
    v_exp_f32 v45, v45
    v_cvt_pk_bf16_f32 v72, v40, v41
    v_mfma_f32_32x32x16_bf16 v[216:231], a[132:135], v[128:131], v[216:231]
    v_exp_f32 v46, v46
    v_exp_f32 v47, v47
    v_exp_f32 v48, v48
    v_cvt_pk_bf16_f32 v73, v42, v43
    v_cvt_pk_bf16_f32 v74, v44, v45
    v_mfma_f32_32x32x16_bf16 v[216:231], a[136:139], v[132:135], v[216:231]
    v_exp_f32 v49, v49
    v_exp_f32 v50, v50
    v_exp_f32 v51, v51
    v_cvt_pk_bf16_f32 v75, v46, v47
    v_exp_f32 v52, v52
    v_exp_f32 v53, v53
    v_exp_f32 v54, v54
    v_exp_f32 v55, v55
    v_cvt_pk_bf16_f32 v76, v48, v49
    v_cvt_pk_bf16_f32 v77, v50, v51
    v_cvt_pk_bf16_f32 v78, v52, v53
    v_cvt_pk_bf16_f32 v79, v54, v55
    v_mfma_f32_32x32x16_bf16 v[40:55], a[116:119], v[152:155], 0
    buffer_load_dwordx4 a[72:75], v91, s[16:19], s100 offen offset:3072
    v_exp_f32 v56, v56
    v_exp_f32 v57, v57
    v_exp_f32 v58, v58
    v_mfma_f32_32x32x16_bf16 v[40:55], a[120:123], v[156:159], v[40:55]
    v_exp_f32 v59, v59
    v_exp_f32 v60, v60
    v_exp_f32 v61, v61
    v_cvt_pk_bf16_f32 v128, v56, v57
    s_waitcnt lgkmcnt(0)
    v_mfma_f32_32x32x16_bf16 v[168:183], a[140:143], v[72:75], v[168:183]
    v_exp_f32 v62, v62
    v_exp_f32 v63, v63
    v_exp_f32 v64, v64
    v_cvt_pk_bf16_f32 v129, v58, v59
    v_cvt_pk_bf16_f32 v130, v60, v61
    v_mfma_f32_32x32x16_bf16 v[168:183], a[144:147], v[76:79], v[168:183]
    v_exp_f32 v65, v65
    v_exp_f32 v66, v66
    v_exp_f32 v67, v67
    v_cvt_pk_bf16_f32 v131, v62, v63
    v_exp_f32 v68, v68
    v_exp_f32 v69, v69
    v_exp_f32 v70, v70
    v_exp_f32 v71, v71
    v_cvt_pk_bf16_f32 v132, v64, v65
    v_cvt_pk_bf16_f32 v133, v66, v67
    v_cvt_pk_bf16_f32 v134, v68, v69
    v_cvt_pk_bf16_f32 v135, v70, v71
    v_mfma_f32_32x32x16_bf16 v[56:71], a[116:119], v[160:163], v[96:111]
    ds_read_b64_tr_b16 a[100:101], v114 offset:0
    v_exp_f32 v40, v40
    v_exp_f32 v41, v41
    v_exp_f32 v42, v42
    v_mfma_f32_32x32x16_bf16 v[56:71], a[120:123], v[164:167], v[56:71]
    ds_read_b64_tr_b16 a[102:103], v114 offset:1024
    v_exp_f32 v43, v43
    v_exp_f32 v44, v44
    v_exp_f32 v45, v45
    v_cvt_pk_bf16_f32 v72, v40, v41
    v_mfma_f32_32x32x16_bf16 v[184:199], a[140:143], v[128:131], v[184:199]
    ds_read_b64_tr_b16 a[104:105], v114 offset:4096
    v_exp_f32 v46, v46
    v_exp_f32 v47, v47
    v_exp_f32 v48, v48
    v_cvt_pk_bf16_f32 v73, v42, v43
    v_cvt_pk_bf16_f32 v74, v44, v45
    v_mfma_f32_32x32x16_bf16 v[184:199], a[144:147], v[132:135], v[184:199]
    buffer_load_dwordx4 a[76:79], v92, s[16:19], s100 offen offset:0
    v_exp_f32 v49, v49
    v_exp_f32 v50, v50
    v_exp_f32 v51, v51
    v_cvt_pk_bf16_f32 v75, v46, v47
    v_exp_f32 v52, v52
    v_exp_f32 v53, v53
    v_exp_f32 v54, v54
    v_exp_f32 v55, v55
    v_cvt_pk_bf16_f32 v76, v48, v49
    v_cvt_pk_bf16_f32 v77, v50, v51
    v_cvt_pk_bf16_f32 v78, v52, v53
    v_cvt_pk_bf16_f32 v79, v54, v55
    s_waitcnt lgkmcnt(0)
    v_mfma_f32_32x32x16_bf16 v[40:55], a[100:103], v[136:139], 0
    ds_read_b128 a[124:127], v84 offset:0
    v_exp_f32 v56, v56
    v_exp_f32 v57, v57
    v_exp_f32 v58, v58
    v_mfma_f32_32x32x16_bf16 v[40:55], a[104:107], v[140:143], v[40:55]
    ds_read_b128 a[128:131], v85 offset:0
    v_exp_f32 v59, v59
    v_exp_f32 v60, v60
    v_exp_f32 v61, v61
    v_cvt_pk_bf16_f32 v128, v56, v57
    v_mfma_f32_32x32x16_bf16 v[200:215], a[140:143], v[72:75], v[200:215]
    buffer_load_dwordx4 a[80:83], v88, s[16:19], s101 offen offset:0
    v_exp_f32 v62, v62
    v_exp_f32 v63, v63
    v_exp_f32 v64, v64
    v_cvt_pk_bf16_f32 v129, v58, v59
    v_cvt_pk_bf16_f32 v130, v60, v61
    v_mfma_f32_32x32x16_bf16 v[200:215], a[144:147], v[76:79], v[200:215]
    v_exp_f32 v65, v65
    v_exp_f32 v66, v66
    v_exp_f32 v67, v67
    v_cvt_pk_bf16_f32 v131, v62, v63
    v_exp_f32 v68, v68
    v_exp_f32 v69, v69
    v_exp_f32 v70, v70
    v_exp_f32 v71, v71
    v_cvt_pk_bf16_f32 v132, v64, v65
    v_cvt_pk_bf16_f32 v133, v66, v67
    v_cvt_pk_bf16_f32 v134, v68, v69
    v_cvt_pk_bf16_f32 v135, v70, v71
    v_mfma_f32_32x32x16_bf16 v[56:71], a[100:103], v[144:147], 0
    buffer_load_dwordx4 a[84:87], v89, s[16:19], s101 offen offset:1024
    v_exp_f32 v40, v40
    v_exp_f32 v41, v41
    v_exp_f32 v42, v42
    v_mfma_f32_32x32x16_bf16 v[56:71], a[104:107], v[148:151], v[56:71]
    v_exp_f32 v43, v43
    v_exp_f32 v44, v44
    v_exp_f32 v45, v45
    v_cvt_pk_bf16_f32 v72, v40, v41
    v_mfma_f32_32x32x16_bf16 v[216:231], a[140:143], v[128:131], v[216:231]
    v_exp_f32 v46, v46
    v_exp_f32 v47, v47
    v_exp_f32 v48, v48
    v_cvt_pk_bf16_f32 v73, v42, v43
    v_cvt_pk_bf16_f32 v74, v44, v45
    v_mfma_f32_32x32x16_bf16 v[216:231], a[144:147], v[132:135], v[216:231]
    v_exp_f32 v49, v49
    v_exp_f32 v50, v50
    v_exp_f32 v51, v51
    v_cvt_pk_bf16_f32 v75, v46, v47
    v_exp_f32 v52, v52
    v_exp_f32 v53, v53
    v_exp_f32 v54, v54
    v_exp_f32 v55, v55
    v_cvt_pk_bf16_f32 v76, v48, v49
    v_cvt_pk_bf16_f32 v77, v50, v51
    v_cvt_pk_bf16_f32 v78, v52, v53
    v_cvt_pk_bf16_f32 v79, v54, v55
    v_mfma_f32_32x32x16_bf16 v[40:55], a[100:103], v[152:155], v[96:111]
    ds_read_b64_tr_b16 a[108:109], v113 offset:0
    v_exp_f32 v56, v56
    v_exp_f32 v57, v57
    v_exp_f32 v58, v58
    v_mfma_f32_32x32x16_bf16 v[40:55], a[104:107], v[156:159], v[40:55]
    ds_read_b64_tr_b16 a[110:111], v113 offset:1024
    v_exp_f32 v59, v59
    v_exp_f32 v60, v60
    v_exp_f32 v61, v61
    v_cvt_pk_bf16_f32 v128, v56, v57
    s_waitcnt lgkmcnt(2)
    v_mfma_f32_32x32x16_bf16 v[168:183], a[124:127], v[72:75], v[168:183]
    ds_read_b64_tr_b16 a[112:113], v113 offset:4096
    v_exp_f32 v62, v62
    v_exp_f32 v63, v63
    v_exp_f32 v64, v64
    v_cvt_pk_bf16_f32 v129, v58, v59
    v_cvt_pk_bf16_f32 v130, v60, v61
    v_mfma_f32_32x32x16_bf16 v[168:183], a[128:131], v[76:79], v[168:183]
    buffer_load_dwordx4 a[88:91], v90, s[16:19], s101 offen offset:2048
    v_exp_f32 v65, v65
    v_exp_f32 v66, v66
    v_exp_f32 v67, v67
    v_cvt_pk_bf16_f32 v131, v62, v63
    v_exp_f32 v68, v68
    v_exp_f32 v69, v69
    v_exp_f32 v70, v70
    v_exp_f32 v71, v71
    v_cvt_pk_bf16_f32 v132, v64, v65
    v_cvt_pk_bf16_f32 v133, v66, v67
    v_cvt_pk_bf16_f32 v134, v68, v69
    v_cvt_pk_bf16_f32 v135, v70, v71
    s_waitcnt lgkmcnt(0)
    v_mfma_f32_32x32x16_bf16 v[56:71], a[108:111], v[136:139], 0
    ds_read_b128 a[132:135], v82 offset:0
    v_exp_f32 v40, v40
    v_exp_f32 v41, v41
    v_exp_f32 v42, v42
    v_mfma_f32_32x32x16_bf16 v[56:71], a[112:115], v[140:143], v[56:71]
    ds_read_b128 a[136:139], v83 offset:0
    v_exp_f32 v43, v43
    v_exp_f32 v44, v44
    v_exp_f32 v45, v45
    v_cvt_pk_bf16_f32 v72, v40, v41
    v_mfma_f32_32x32x16_bf16 v[184:199], a[124:127], v[128:131], v[184:199]
    buffer_load_dwordx4 a[92:95], v91, s[16:19], s101 offen offset:3072
    v_exp_f32 v46, v46
    v_exp_f32 v47, v47
    v_exp_f32 v48, v48
    v_cvt_pk_bf16_f32 v73, v42, v43
    v_cvt_pk_bf16_f32 v74, v44, v45
    v_mfma_f32_32x32x16_bf16 v[184:199], a[128:131], v[132:135], v[184:199]
    v_exp_f32 v49, v49
    v_exp_f32 v50, v50
    v_exp_f32 v51, v51
    v_cvt_pk_bf16_f32 v75, v46, v47
    v_exp_f32 v52, v52
    v_exp_f32 v53, v53
    v_exp_f32 v54, v54
    v_exp_f32 v55, v55
    v_cvt_pk_bf16_f32 v76, v48, v49
    v_cvt_pk_bf16_f32 v77, v50, v51
    v_cvt_pk_bf16_f32 v78, v52, v53
    v_cvt_pk_bf16_f32 v79, v54, v55
    v_mfma_f32_32x32x16_bf16 v[40:55], a[108:111], v[144:147], v[96:111]
    ds_read_b64_tr_b16 a[116:117], v112 offset:0
    ds_read_b64_tr_b16 a[118:119], v112 offset:1024
    v_exp_f32 v56, v56
    v_exp_f32 v57, v57
    v_exp_f32 v58, v58
    v_mfma_f32_32x32x16_bf16 v[40:55], a[112:115], v[148:151], v[40:55]
    ds_read_b64_tr_b16 a[120:121], v112 offset:4096
    buffer_load_dwordx4 a[96:99], v92, s[16:19], s101 offen offset:0
    v_exp_f32 v59, v59
    v_exp_f32 v60, v60
    v_exp_f32 v61, v61
    v_cvt_pk_bf16_f32 v128, v56, v57
    v_mfma_f32_32x32x16_bf16 v[200:215], a[124:127], v[72:75], v[200:215]
    v_exp_f32 v62, v62
    v_exp_f32 v63, v63
    v_exp_f32 v64, v64
    v_cvt_pk_bf16_f32 v129, v58, v59
    v_cvt_pk_bf16_f32 v130, v60, v61
    v_mfma_f32_32x32x16_bf16 v[200:215], a[128:131], v[76:79], v[200:215]
    v_exp_f32 v65, v65
    v_exp_f32 v66, v66
    v_exp_f32 v67, v67
    v_cvt_pk_bf16_f32 v131, v62, v63
    v_exp_f32 v68, v68
    v_exp_f32 v69, v69
    v_exp_f32 v70, v70
    v_exp_f32 v71, v71
    v_cvt_pk_bf16_f32 v132, v64, v65
    v_cvt_pk_bf16_f32 v133, v66, v67
    v_cvt_pk_bf16_f32 v134, v68, v69
    v_cvt_pk_bf16_f32 v135, v70, v71
    s_waitcnt lgkmcnt(0)
    v_mfma_f32_32x32x16_bf16 v[56:71], a[116:119], v[136:139], v[96:111]
    ds_read_b128 a[140:143], v80 offset:0
    v_exp_f32 v40, v40
    v_exp_f32 v41, v41
    v_exp_f32 v42, v42
    v_mfma_f32_32x32x16_bf16 v[56:71], a[120:123], v[140:143], v[56:71]
    ds_read_b128 a[144:147], v81 offset:0
    v_exp_f32 v43, v43
    v_exp_f32 v44, v44
    v_exp_f32 v45, v45
    v_cvt_pk_bf16_f32 v72, v40, v41
    s_waitcnt lgkmcnt(5)
    v_mfma_f32_32x32x16_bf16 v[168:183], a[132:135], v[128:131], v[168:183]
    v_exp_f32 v46, v46
    v_exp_f32 v47, v47
    v_exp_f32 v48, v48
    v_cvt_pk_bf16_f32 v73, v42, v43
    v_cvt_pk_bf16_f32 v74, v44, v45
    v_mfma_f32_32x32x16_bf16 v[168:183], a[136:139], v[132:135], v[168:183]
    v_exp_f32 v49, v49
    v_exp_f32 v50, v50
    v_exp_f32 v51, v51
    v_cvt_pk_bf16_f32 v75, v46, v47
    v_exp_f32 v52, v52
    v_exp_f32 v53, v53
    v_exp_f32 v54, v54
    v_exp_f32 v55, v55
    v_cvt_pk_bf16_f32 v76, v48, v49
    v_cvt_pk_bf16_f32 v77, v50, v51
    v_cvt_pk_bf16_f32 v78, v52, v53
    v_cvt_pk_bf16_f32 v79, v54, v55
    v_exp_f32 v56, v56
    v_exp_f32 v57, v57
    v_exp_f32 v58, v58
    v_exp_f32 v59, v59
    v_exp_f32 v60, v60
    v_exp_f32 v61, v61
    v_cvt_pk_bf16_f32 v128, v56, v57
    v_mfma_f32_32x32x16_bf16 v[184:199], a[132:135], v[72:75], v[184:199]
    v_exp_f32 v62, v62
    v_exp_f32 v63, v63
    v_exp_f32 v64, v64
    v_cvt_pk_bf16_f32 v129, v58, v59
    v_cvt_pk_bf16_f32 v130, v60, v61
    v_mfma_f32_32x32x16_bf16 v[184:199], a[136:139], v[76:79], v[184:199]
    v_exp_f32 v65, v65
    v_exp_f32 v66, v66
    v_exp_f32 v67, v67
    v_cvt_pk_bf16_f32 v131, v62, v63
    v_exp_f32 v68, v68
    v_exp_f32 v69, v69
    v_exp_f32 v70, v70
    v_exp_f32 v71, v71
    v_cvt_pk_bf16_f32 v132, v64, v65
    v_cvt_pk_bf16_f32 v133, v66, v67
    v_cvt_pk_bf16_f32 v134, v68, v69
    v_cvt_pk_bf16_f32 v135, v70, v71
    s_waitcnt lgkmcnt(0)
    s_nop 1
    v_mfma_f32_32x32x16_bf16 v[168:183], a[140:143], v[128:131], v[168:183]
    v_mfma_f32_32x32x16_bf16 v[168:183], a[144:147], v[132:135], v[168:183]
    s_nop 15
    s_mov_b64 s[80:81], 0
    s_mov_b32 s78, 0x2b800000
    s_mov_b32 s79, 0x53800000
    v_mov_b32 v26, v176
    v_mov_b32 v27, v176
    v_mov_b32 v28, v192
    v_mov_b32 v29, v192
    v_mov_b32 v30, v208
    v_mov_b32 v31, v208
    v_mov_b32 v32, v224
    v_mov_b32 v33, v224
    s_nop 1
    v_permlane32_swap_b32 v26, v27
    v_permlane32_swap_b32 v28, v29
    v_permlane32_swap_b32 v30, v31
    v_permlane32_swap_b32 v32, v33
    s_nop 1
    v_cmp_nle_f32 vcc, s78, v27
    s_or_b64 s[80:81], s[80:81], vcc
    v_cmp_nge_f32 vcc, s79, v27
    s_or_b64 s[80:81], s[80:81], vcc
    v_cmp_nle_f32 vcc, s78, v29
    s_or_b64 s[80:81], s[80:81], vcc
    v_cmp_nge_f32 vcc, s79, v29
    s_or_b64 s[80:81], s[80:81], vcc
    v_cmp_nle_f32 vcc, s78, v31
    s_or_b64 s[80:81], s[80:81], vcc
    v_cmp_nge_f32 vcc, s79, v31
    s_or_b64 s[80:81], s[80:81], vcc
    v_cmp_nle_f32 vcc, s78, v33
    s_or_b64 s[80:81], s[80:81], vcc
    v_cmp_nge_f32 vcc, s79, v33
    s_or_b64 s[80:81], s[80:81], vcc
    s_cmp_eq_u64 s[80:81], 0
    s_cbranch_scc0 L_slow
L_slow_ret:
    v_rcp_f32 v27, v27
    v_rcp_f32 v29, v29
    v_rcp_f32 v31, v31
    v_rcp_f32 v33, v33
    v_cmp_eq_u32 s[82:83], 0, v116
    v_pk_mul_f32 v[168:169], v[168:169], v[26:27] op_sel:[0,1] op_sel_hi:[1,1]
    v_pk_mul_f32 v[170:171], v[170:171], v[26:27] op_sel:[0,1] op_sel_hi:[1,1]
    v_pk_mul_f32 v[172:173], v[172:173], v[26:27] op_sel:[0,1] op_sel_hi:[1,1]
    v_pk_mul_f32 v[174:175], v[174:175], v[26:27] op_sel:[0,1] op_sel_hi:[1,1]
    v_pk_mul_f32 v[176:177], v[176:177], v[26:27] op_sel:[0,1] op_sel_hi:[1,1]
    v_pk_mul_f32 v[178:179], v[178:179], v[26:27] op_sel:[0,1] op_sel_hi:[1,1]
    v_cvt_pk_bf16_f32 v168, v168, v169
    v_cvt_pk_bf16_f32 v169, v170, v171
    v_cvt_pk_bf16_f32 v172, v172, v173
    v_cvt_pk_bf16_f32 v173, v174, v175
    v_cvt_pk_bf16_f32 v176, v176, v177
    v_cvt_pk_bf16_f32 v177, v178, v179
    ds_write_b64 v237, v[168:169] offset:0
    ds_write_b64 v237, v[172:173] offset:256
    s_mov_b64 exec, s[82:83]
    ds_write_b64 v237, v[176:177] offset:512
    s_mov_b64 exec, -1
    v_pk_mul_f32 v[184:185], v[184:185], v[28:29] op_sel:[0,1] op_sel_hi:[1,1]
    v_pk_mul_f32 v[186:187], v[186:187], v[28:29] op_sel:[0,1] op_sel_hi:[1,1]
    v_pk_mul_f32 v[188:189], v[188:189], v[28:29] op_sel:[0,1] op_sel_hi:[1,1]
    v_pk_mul_f32 v[190:191], v[190:191], v[28:29] op_sel:[0,1] op_sel_hi:[1,1]
    v_pk_mul_f32 v[192:193], v[192:193], v[28:29] op_sel:[0,1] op_sel_hi:[1,1]
    v_pk_mul_f32 v[194:195], v[194:195], v[28:29] op_sel:[0,1] op_sel_hi:[1,1]
    v_cvt_pk_bf16_f32 v184, v184, v185
    v_cvt_pk_bf16_f32 v185, v186, v187
    v_cvt_pk_bf16_f32 v188, v188, v189
    v_cvt_pk_bf16_f32 v189, v190, v191
    v_cvt_pk_bf16_f32 v192, v192, v193
    v_cvt_pk_bf16_f32 v193, v194, v195
    ds_write_b64 v237, v[184:185] offset:5120
    ds_write_b64 v237, v[188:189] offset:5376
    s_mov_b64 exec, s[82:83]
    ds_write_b64 v237, v[192:193] offset:5632
    s_mov_b64 exec, -1
    v_pk_mul_f32 v[200:201], v[200:201], v[30:31] op_sel:[0,1] op_sel_hi:[1,1]
    v_pk_mul_f32 v[202:203], v[202:203], v[30:31] op_sel:[0,1] op_sel_hi:[1,1]
    v_pk_mul_f32 v[204:205], v[204:205], v[30:31] op_sel:[0,1] op_sel_hi:[1,1]
    v_pk_mul_f32 v[206:207], v[206:207], v[30:31] op_sel:[0,1] op_sel_hi:[1,1]
    v_pk_mul_f32 v[208:209], v[208:209], v[30:31] op_sel:[0,1] op_sel_hi:[1,1]
    v_pk_mul_f32 v[210:211], v[210:211], v[30:31] op_sel:[0,1] op_sel_hi:[1,1]
    v_cvt_pk_bf16_f32 v200, v200, v201
    v_cvt_pk_bf16_f32 v201, v202, v203
    v_cvt_pk_bf16_f32 v204, v204, v205
    v_cvt_pk_bf16_f32 v205, v206, v207
    v_cvt_pk_bf16_f32 v208, v208, v209
    v_cvt_pk_bf16_f32 v209, v210, v211
    ds_write_b64 v237, v[200:201] offset:10240
    ds_write_b64 v237, v[204:205] offset:10496
    s_mov_b64 exec, s[82:83]
    ds_write_b64 v237, v[208:209] offset:10752
    s_mov_b64 exec, -1
    v_pk_mul_f32 v[216:217], v[216:217], v[32:33] op_sel:[0,1] op_sel_hi:[1,1]
    v_pk_mul_f32 v[218:219], v[218:219], v[32:33] op_sel:[0,1] op_sel_hi:[1,1]
    v_pk_mul_f32 v[220:221], v[220:221], v[32:33] op_sel:[0,1] op_sel_hi:[1,1]
    v_pk_mul_f32 v[222:223], v[222:223], v[32:33] op_sel:[0,1] op_sel_hi:[1,1]
    v_pk_mul_f32 v[224:225], v[224:225], v[32:33] op_sel:[0,1] op_sel_hi:[1,1]
    v_pk_mul_f32 v[226:227], v[226:227], v[32:33] op_sel:[0,1] op_sel_hi:[1,1]
    v_cvt_pk_bf16_f32 v216, v216, v217
    v_cvt_pk_bf16_f32 v217, v218, v219
    v_cvt_pk_bf16_f32 v220, v220, v221
    v_cvt_pk_bf16_f32 v221, v222, v223
    v_cvt_pk_bf16_f32 v224, v224, v225
    v_cvt_pk_bf16_f32 v225, v226, v227
    ds_write_b64 v237, v[216:217] offset:15360
    ds_write_b64 v237, v[220:221] offset:15616
    s_mov_b64 exec, s[82:83]
    ds_write_b64 v237, v[224:225] offset:15872
    s_mov_b64 exec, -1
    v_lshlrev_b32 v26, 4, v0
    v_add_u32 v27, 143360, v26
    s_waitcnt lgkmcnt(0)
    s_barrier
    ds_read_b128 v[40:43], v27 offset:0
    ds_read_b128 v[44:47], v27 offset:4096
    ds_read_b128 v[48:51], v27 offset:8192
    ds_read_b128 v[52:55], v27 offset:12288
    ds_read_b128 v[56:59], v27 offset:16384
    s_waitcnt lgkmcnt(4)
    buffer_store_dwordx4 v[40:43], v232, s[24:27], s89 offen sc1
    s_waitcnt lgkmcnt(3)
    buffer_store_dwordx4 v[44:47], v233, s[24:27], s89 offen sc1
    s_waitcnt lgkmcnt(2)
    buffer_store_dwordx4 v[48:51], v234, s[24:27], s89 offen sc1
    s_waitcnt lgkmcnt(1)
    buffer_store_dwordx4 v[52:55], v235, s[24:27], s89 offen sc1
    s_waitcnt lgkmcnt(0)
    buffer_store_dwordx4 v[56:59], v236, s[24:27], s89 offen sc1
    s_waitcnt vmcnt(0)
    s_barrier
    s_cmp_lg_u32 s35, 0
    s_cbranch_scc1 fl_18
    s_lshl_b32 s38, s32, 4
    s_add_u32 s38, s38, s33
    s_lshl_b32 s38, s38, 3
    s_add_u32 s38, s38, s34
    s_add_u32 s38, s38, 256
    s_lshl_b32 s38, s38, 7
    v_mov_b32 v124, s40
    buffer_store_dword v124, off, s[24:27], s38 sc1
fl_18:
    v_add_u32 v26, s54, v118
    s_bfe_u32 s38, s75, 0x40000
    s_mul_i32 s38, s38, 20480
    v_add_u32 v27, s38, v26
    ds_write_b128 v27, a[0:3] offset:0
    ds_write_b128 v27, a[4:7] offset:1024
    ds_write_b128 v27, a[8:11] offset:2048
    ds_write_b128 v27, a[12:15] offset:3072
    ds_write_b128 v27, a[16:19] offset:4096
    s_bfe_u32 s38, s75, 0x40004
    s_mul_i32 s38, s38, 20480
    v_add_u32 v27, s38, v26
    ds_write_b128 v27, a[20:23] offset:0
    ds_write_b128 v27, a[24:27] offset:1024
    ds_write_b128 v27, a[28:31] offset:2048
    ds_write_b128 v27, a[32:35] offset:3072
    ds_write_b128 v27, a[36:39] offset:4096
    s_bfe_u32 s38, s75, 0x40008
    s_mul_i32 s38, s38, 20480
    v_add_u32 v27, s38, v26
    ds_write_b128 v27, a[40:43] offset:0
    ds_write_b128 v27, a[44:47] offset:1024
    ds_write_b128 v27, a[48:51] offset:2048
    ds_write_b128 v27, a[52:55] offset:3072
    ds_write_b128 v27, a[56:59] offset:4096
    s_bfe_u32 s38, s75, 0x4000c
    s_mul_i32 s38, s38, 20480
    v_add_u32 v27, s38, v26
    ds_write_b128 v27, a[60:63] offset:0
    ds_write_b128 v27, a[64:67] offset:1024
    ds_write_b128 v27, a[68:71] offset:2048
    ds_write_b128 v27, a[72:75] offset:3072
    ds_write_b128 v27, a[76:79] offset:4096
    s_bfe_u32 s38, s75, 0x40010
    s_mul_i32 s38, s38, 20480
    v_add_u32 v27, s38, v26
    ds_write_b128 v27, a[80:83] offset:0
    ds_write_b128 v27, a[84:87] offset:1024
    ds_write_b128 v27, a[88:91] offset:2048
    ds_write_b128 v27, a[92:95] offset:3072
    ds_write_b128 v27, a[96:99] offset:4096
    s_branch L_tail
L_B:
    s_mov_b32 s78, 0x3fb8aa3b
    s_mov_b32 s79, 0x358637bd
    s_nop 4
    ds_read_b64_tr_b16 a[160:161], v20 offset:40960
    ds_read_b64_tr_b16 a[162:163], v20 offset:42240
    ds_read_b64_tr_b16 a[164:165], v20 offset:40992
    ds_read_b64_tr_b16 a[166:167], v20 offset:42272
    ds_read_b64_tr_b16 a[168:169], v20 offset:41024
    ds_read_b64_tr_b16 a[170:171], v20 offset:42304
    ds_read_b64_tr_b16 a[172:173], v20 offset:41056
    ds_read_b64_tr_b16 a[174:175], v20 offset:42336
    ds_read_b64_tr_b16 a[176:177], v20 offset:41088
    ds_read_b64_tr_b16 a[178:179], v20 offset:42368
    s_waitcnt lgkmcnt(8)
    v_mfma_f32_16x16x32_bf16 v[208:211], a[160:163], a[0:3], 0
    ds_read_b64_tr_b16 a[180:181], v20 offset:46080
    v_cvt_pk_bf16_f32 v44, v168, v169
    v_cvt_pk_bf16_f32 v45, v170, v171
    v_cvt_pk_bf16_f32 v46, v172, v173
    v_cvt_pk_bf16_f32 v47, v174, v175
    ds_write_b128 v23, v[44:47] offset:21760
    v_mfma_f32_16x16x32_bf16 v[212:215], a[160:163], a[4:7], 0
    ds_read_b64_tr_b16 a[182:183], v20 offset:47360
    v_cvt_pk_bf16_f32 v48, v176, v177
    v_cvt_pk_bf16_f32 v49, v178, v179
    v_cvt_pk_bf16_f32 v50, v180, v181
    v_cvt_pk_bf16_f32 v51, v182, v183
    ds_write_b128 v23, v[48:51] offset:26112
    s_waitcnt lgkmcnt(10)
    v_mfma_f32_16x16x32_bf16 v[216:219], a[164:167], a[0:3], 0
    ds_read_b64_tr_b16 a[184:185], v20 offset:46112
    v_cvt_pk_bf16_f32 v52, v184, v185
    v_cvt_pk_bf16_f32 v53, v186, v187
    v_cvt_pk_bf16_f32 v54, v188, v189
    v_cvt_pk_bf16_f32 v55, v190, v191
    ds_write_b128 v23, v[52:55] offset:30464
    v_mfma_f32_16x16x32_bf16 v[220:223], a[164:167], a[4:7], 0
    ds_read_b64_tr_b16 a[186:187], v20 offset:47392
    v_cvt_pk_bf16_f32 v40, v192, v193
    v_cvt_pk_bf16_f32 v41, v194, v195
    v_cvt_pk_bf16_f32 v42, v196, v197
    v_cvt_pk_bf16_f32 v43, v198, v199
    ds_write_b128 v23, v[40:43] offset:34816
    s_waitcnt lgkmcnt(12)
    v_mfma_f32_16x16x32_bf16 v[224:227], a[168:171], a[0:3], 0
    ds_read_b64_tr_b16 a[188:189], v20 offset:46144
    v_cvt_pk_bf16_f32 v44, v200, v201
    v_cvt_pk_bf16_f32 v45, v202, v203
    v_cvt_pk_bf16_f32 v46, v204, v205
    v_cvt_pk_bf16_f32 v47, v206, v207
    ds_write_b128 v23, v[44:47] offset:39168
    v_mfma_f32_16x16x32_bf16 v[228:231], a[168:171], a[4:7], 0
    ds_read_b64_tr_b16 a[190:191], v20 offset:47424
    v_mul_f32 v26, s78, v128
    v_mul_f32 v27, s78, v129
    v_mul_f32 v28, s78, v130
    v_mul_f32 v29, s78, v131
    v_min_f32 v26, 0, v26
    s_waitcnt lgkmcnt(13)
    v_mfma_f32_16x16x32_bf16 v[232:235], a[172:175], a[0:3], 0
    ds_read_b64_tr_b16 a[192:193], v20 offset:46176
    v_min_f32 v27, 0, v27
    v_min_f32 v28, 0, v28
    v_min_f32 v29, 0, v29
    v_exp_f32 v26, v26
    v_exp_f32 v27, v27
    v_mfma_f32_16x16x32_bf16 v[236:239], a[172:175], a[4:7], 0
    ds_read_b64_tr_b16 a[194:195], v20 offset:47456
    v_exp_f32 v28, v28
    v_exp_f32 v29, v29
    v_max_f32 v128, 0, v128
    v_max_f32 v129, 0, v129
    v_max_f32 v130, 0, v130
    s_waitcnt lgkmcnt(13)
    v_mfma_f32_16x16x32_bf16 v[240:243], a[176:179], a[0:3], 0
    ds_read_b64_tr_b16 a[196:197], v20 offset:46208
    v_max_f32 v131, 0, v131
    v_add_f32 v26, s79, v26
    v_add_f32 v27, s79, v27
    v_add_f32 v28, s79, v28
    v_add_f32 v29, s79, v29
    v_mfma_f32_16x16x32_bf16 v[244:247], a[176:179], a[4:7], 0
    ds_read_b64_tr_b16 a[198:199], v20 offset:47488
    v_add_f32 v128, v128, v26
    v_add_f32 v129, v129, v27
    v_add_f32 v130, v130, v28
    v_add_f32 v131, v131, v29
    s_waitcnt lgkmcnt(12)
    v_mfma_f32_16x16x32_bf16 v[208:211], a[180:183], a[8:11], v[208:211]
    ds_read_b64_tr_b16 a[160:161], v20 offset:51200
    v_mul_f32 v26, s78, v132
    v_mul_f32 v27, s78, v133
    v_mul_f32 v28, s78, v134
    v_mul_f32 v29, s78, v135
    v_min_f32 v26, 0, v26
    v_mfma_f32_16x16x32_bf16 v[212:215], a[180:183], a[12:15], v[212:215]
    ds_read_b64_tr_b16 a[162:163], v20 offset:52480
    v_min_f32 v27, 0, v27
    v_min_f32 v28, 0, v28
    v_min_f32 v29, 0, v29
    v_exp_f32 v26, v26
    v_exp_f32 v27, v27
    s_waitcnt lgkmcnt(10)
    v_mfma_f32_16x16x32_bf16 v[216:219], a[184:187], a[8:11], v[216:219]
    ds_read_b64_tr_b16 a[164:165], v20 offset:51232
    v_exp_f32 v28, v28
    v_exp_f32 v29, v29
    v_max_f32 v132, 0, v132
    v_max_f32 v133, 0, v133
    v_max_f32 v134, 0, v134
    v_mfma_f32_16x16x32_bf16 v[220:223], a[184:187], a[12:15], v[220:223]
    ds_read_b64_tr_b16 a[166:167], v20 offset:52512
    v_max_f32 v135, 0, v135
    v_add_f32 v26, s79, v26
    v_add_f32 v27, s79, v27
    v_add_f32 v28, s79, v28
    v_add_f32 v29, s79, v29
    s_waitcnt lgkmcnt(8)
    v_mfma_f32_16x16x32_bf16 v[224:227], a[188:191], a[8:11], v[224:227]
    ds_read_b64_tr_b16 a[168:169], v20 offset:51264
    v_add_f32 v132, v132, v26
    v_add_f32 v133, v133, v27
    v_add_f32 v134, v134, v28
    v_add_f32 v135, v135, v29
    v_cvt_pk_bf16_f32 v40, v128, v129
    v_mfma_f32_16x16x32_bf16 v[228:231], a[188:191], a[12:15], v[228:231]
    ds_read_b64_tr_b16 a[170:171], v20 offset:52544
    v_cvt_pk_bf16_f32 v41, v130, v131
    v_cvt_pk_bf16_f32 v42, v132, v133
    v_cvt_pk_bf16_f32 v43, v134, v135
    ds_write_b128 v23, v[40:43] offset:0
    v_mul_f32 v26, s78, v136
    s_waitcnt lgkmcnt(9)
    v_mfma_f32_16x16x32_bf16 v[232:235], a[192:195], a[8:11], v[232:235]
    ds_read_b64_tr_b16 a[172:173], v20 offset:51296
    v_mul_f32 v27, s78, v137
    v_mul_f32 v28, s78, v138
    v_mul_f32 v29, s78, v139
    v_min_f32 v26, 0, v26
    v_min_f32 v27, 0, v27
    v_mfma_f32_16x16x32_bf16 v[236:239], a[192:195], a[12:15], v[236:239]
    ds_read_b64_tr_b16 a[174:175], v20 offset:52576
    v_min_f32 v28, 0, v28
    v_min_f32 v29, 0, v29
    v_exp_f32 v26, v26
    v_exp_f32 v27, v27
    v_exp_f32 v28, v28
    s_waitcnt lgkmcnt(9)
    v_mfma_f32_16x16x32_bf16 v[240:243], a[196:199], a[8:11], v[240:243]
    ds_read_b64_tr_b16 a[176:177], v20 offset:51328
    v_exp_f32 v29, v29
    v_max_f32 v136, 0, v136
    v_max_f32 v137, 0, v137
    v_max_f32 v138, 0, v138
    v_max_f32 v139, 0, v139
    v_mfma_f32_16x16x32_bf16 v[244:247], a[196:199], a[12:15], v[244:247]
    ds_read_b64_tr_b16 a[178:179], v20 offset:52608
    v_add_f32 v26, s79, v26
    v_add_f32 v27, s79, v27
    v_add_f32 v28, s79, v28
    v_add_f32 v29, s79, v29
    s_waitcnt lgkmcnt(9)
    v_mfma_f32_16x16x32_bf16 v[208:211], a[160:163], a[16:19], v[208:211]
    ds_read_b64_tr_b16 a[180:181], v20 offset:56320
    v_add_f32 v136, v136, v26
    v_add_f32 v137, v137, v27
    v_add_f32 v138, v138, v28
    v_add_f32 v139, v139, v29
    v_mul_f32 v26, s78, v140
    v_mfma_f32_16x16x32_bf16 v[212:215], a[160:163], a[20:23], v[212:215]
    ds_read_b64_tr_b16 a[182:183], v20 offset:57600
    v_mul_f32 v27, s78, v141
    v_mul_f32 v28, s78, v142
    v_mul_f32 v29, s78, v143
    v_min_f32 v26, 0, v26
    v_min_f32 v27, 0, v27
    s_waitcnt lgkmcnt(9)
    v_mfma_f32_16x16x32_bf16 v[216:219], a[164:167], a[16:19], v[216:219]
    ds_read_b64_tr_b16 a[184:185], v20 offset:56352
    v_min_f32 v28, 0, v28
    v_min_f32 v29, 0, v29
    v_exp_f32 v26, v26
    v_exp_f32 v27, v27
    v_exp_f32 v28, v28
    v_mfma_f32_16x16x32_bf16 v[220:223], a[164:167], a[20:23], v[220:223]
    ds_read_b64_tr_b16 a[186:187], v20 offset:57632
    v_exp_f32 v29, v29
    v_max_f32 v140, 0, v140
    v_max_f32 v141, 0, v141
    v_max_f32 v142, 0, v142
    v_max_f32 v143, 0, v143
    s_waitcnt lgkmcnt(9)
    v_mfma_f32_16x16x32_bf16 v[224:227], a[168:171], a[16:19], v[224:227]
    ds_read_b64_tr_b16 a[188:189], v20 offset:56384
    v_add_f32 v26, s79, v26
    v_add_f32 v27, s79, v27
    v_add_f32 v28, s79, v28
    v_add_f32 v29, s79, v29
    v_add_f32 v140, v140, v26
    v_mfma_f32_16x16x32_bf16 v[228:231], a[168:171], a[20:23], v[228:231]
    ds_read_b64_tr_b16 a[190:191], v20 offset:57664
    v_add_f32 v141, v141, v27
    v_add_f32 v142, v142, v28
    v_add_f32 v143, v143, v29
    v_cvt_pk_bf16_f32 v44, v136, v137
    v_cvt_pk_bf16_f32 v45, v138, v139
    s_waitcnt lgkmcnt(8)
    v_mfma_f32_16x16x32_bf16 v[232:235], a[172:175], a[16:19], v[232:235]
    ds_read_b64_tr_b16 a[192:193], v20 offset:56416
    v_cvt_pk_bf16_f32 v46, v140, v141
    v_cvt_pk_bf16_f32 v47, v142, v143
    ds_write_b128 v23, v[44:47] offset:4352
    v_mul_f32 v26, s78, v144
    v_mul_f32 v27, s78, v145
    v_mfma_f32_16x16x32_bf16 v[236:239], a[172:175], a[20:23], v[236:239]
    ds_read_b64_tr_b16 a[194:195], v20 offset:57696
    v_mul_f32 v28, s78, v146
    v_mul_f32 v29, s78, v147
    v_min_f32 v26, 0, v26
    v_min_f32 v27, 0, v27
    v_min_f32 v28, 0, v28
    s_waitcnt lgkmcnt(9)
    v_mfma_f32_16x16x32_bf16 v[240:243], a[176:179], a[16:19], v[240:243]
    ds_read_b64_tr_b16 a[196:197], v20 offset:56448
    v_min_f32 v29, 0, v29
    v_exp_f32 v26, v26
    v_exp_f32 v27, v27
    v_exp_f32 v28, v28
    v_exp_f32 v29, v29
    v_mfma_f32_16x16x32_bf16 v[244:247], a[176:179], a[20:23], v[244:247]
    ds_read_b64_tr_b16 a[198:199], v20 offset:57728
    v_max_f32 v144, 0, v144
    v_max_f32 v145, 0, v145
    v_max_f32 v146, 0, v146
    v_max_f32 v147, 0, v147
    s_waitcnt lgkmcnt(9)
    v_mfma_f32_16x16x32_bf16 v[208:211], a[180:183], a[24:27], v[208:211]
    ds_read_b64_tr_b16 a[160:161], v21 offset:0
    v_add_f32 v26, s79, v26
    v_add_f32 v27, s79, v27
    v_add_f32 v28, s79, v28
    v_add_f32 v29, s79, v29
    v_add_f32 v144, v144, v26
    v_mfma_f32_16x16x32_bf16 v[212:215], a[180:183], a[28:31], v[212:215]
    ds_read_b64_tr_b16 a[162:163], v21 offset:1280
    v_add_f32 v145, v145, v27
    v_add_f32 v146, v146, v28
    v_add_f32 v147, v147, v29
    v_mul_f32 v26, s78, v148
    v_mul_f32 v27, s78, v149
    s_waitcnt lgkmcnt(9)
    v_mfma_f32_16x16x32_bf16 v[216:219], a[184:187], a[24:27], v[216:219]
    ds_read_b64_tr_b16 a[164:165], v21 offset:32
    v_mul_f32 v28, s78, v150
    v_mul_f32 v29, s78, v151
    v_min_f32 v26, 0, v26
    v_min_f32 v27, 0, v27
    v_min_f32 v28, 0, v28
    v_mfma_f32_16x16x32_bf16 v[220:223], a[184:187], a[28:31], v[220:223]
    ds_read_b64_tr_b16 a[166:167], v21 offset:1312
    v_min_f32 v29, 0, v29
    v_exp_f32 v26, v26
    v_exp_f32 v27, v27
    v_exp_f32 v28, v28
    v_exp_f32 v29, v29
    s_waitcnt lgkmcnt(9)
    v_mfma_f32_16x16x32_bf16 v[224:227], a[188:191], a[24:27], v[224:227]
    ds_read_b64_tr_b16 a[168:169], v21 offset:64
    v_max_f32 v148, 0, v148
    v_max_f32 v149, 0, v149
    v_max_f32 v150, 0, v150
    v_max_f32 v151, 0, v151
    v_add_f32 v26, s79, v26
    v_mfma_f32_16x16x32_bf16 v[228:231], a[188:191], a[28:31], v[228:231]
    ds_read_b64_tr_b16 a[170:171], v21 offset:1344
    v_add_f32 v27, s79, v27
    v_add_f32 v28, s79, v28
    v_add_f32 v29, s79, v29
    v_add_f32 v148, v148, v26
    v_add_f32 v149, v149, v27
    s_waitcnt lgkmcnt(8)
    v_mfma_f32_16x16x32_bf16 v[232:235], a[192:195], a[24:27], v[232:235]
    ds_read_b64_tr_b16 a[172:173], v21 offset:96
    v_add_f32 v150, v150, v28
    v_add_f32 v151, v151, v29
    v_cvt_pk_bf16_f32 v48, v144, v145
    v_cvt_pk_bf16_f32 v49, v146, v147
    v_cvt_pk_bf16_f32 v50, v148, v149
    v_mfma_f32_16x16x32_bf16 v[236:239], a[192:195], a[28:31], v[236:239]
    ds_read_b64_tr_b16 a[174:175], v21 offset:1376
    v_cvt_pk_bf16_f32 v51, v150, v151
    ds_write_b128 v23, v[48:51] offset:8704
    v_mul_f32 v26, s78, v152
    v_mul_f32 v27, s78, v153
    v_mul_f32 v28, s78, v154
    s_waitcnt lgkmcnt(9)
    v_mfma_f32_16x16x32_bf16 v[240:243], a[196:199], a[24:27], v[240:243]
    ds_read_b64_tr_b16 a[176:177], v21 offset:128
    v_mul_f32 v29, s78, v155
    v_min_f32 v26, 0, v26
    v_min_f32 v27, 0, v27
    v_min_f32 v28, 0, v28
    v_min_f32 v29, 0, v29
    v_mfma_f32_16x16x32_bf16 v[244:247], a[196:199], a[28:31], v[244:247]
    ds_read_b64_tr_b16 a[178:179], v21 offset:1408
    v_exp_f32 v26, v26
    v_exp_f32 v27, v27
    v_exp_f32 v28, v28
    v_exp_f32 v29, v29
    s_waitcnt lgkmcnt(9)
    v_mfma_f32_16x16x32_bf16 v[208:211], a[160:163], a[32:35], v[208:211]
    ds_read_b64_tr_b16 a[180:181], v21 offset:5120
    v_max_f32 v152, 0, v152
    v_max_f32 v153, 0, v153
    v_max_f32 v154, 0, v154
    v_max_f32 v155, 0, v155
    v_add_f32 v26, s79, v26
    v_mfma_f32_16x16x32_bf16 v[212:215], a[160:163], a[36:39], v[212:215]
    ds_read_b64_tr_b16 a[182:183], v21 offset:6400
    v_add_f32 v27, s79, v27
    v_add_f32 v28, s79, v28
    v_add_f32 v29, s79, v29
    v_add_f32 v152, v152, v26
    v_add_f32 v153, v153, v27
    s_waitcnt lgkmcnt(9)
    v_mfma_f32_16x16x32_bf16 v[216:219], a[164:167], a[32:35], v[216:219]
    ds_read_b64_tr_b16 a[184:185], v21 offset:5152
    v_add_f32 v154, v154, v28
    v_add_f32 v155, v155, v29
    v_mul_f32 v26, s78, v156
    v_mul_f32 v27, s78, v157
    v_mul_f32 v28, s78, v158
    v_mfma_f32_16x16x32_bf16 v[220:223], a[164:167], a[36:39], v[220:223]
    ds_read_b64_tr_b16 a[186:187], v21 offset:6432
    v_mul_f32 v29, s78, v159
    v_min_f32 v26, 0, v26
    v_min_f32 v27, 0, v27
    v_min_f32 v28, 0, v28
    v_min_f32 v29, 0, v29
    s_waitcnt lgkmcnt(9)
    v_mfma_f32_16x16x32_bf16 v[224:227], a[168:171], a[32:35], v[224:227]
    ds_read_b64_tr_b16 a[188:189], v21 offset:5184
    v_exp_f32 v26, v26
    v_exp_f32 v27, v27
    v_exp_f32 v28, v28
    v_exp_f32 v29, v29
    v_max_f32 v156, 0, v156
    v_mfma_f32_16x16x32_bf16 v[228:231], a[168:171], a[36:39], v[228:231]
    ds_read_b64_tr_b16 a[190:191], v21 offset:6464
    v_max_f32 v157, 0, v157
    v_max_f32 v158, 0, v158
    v_max_f32 v159, 0, v159
    v_add_f32 v26, s79, v26
    v_add_f32 v27, s79, v27
    s_waitcnt lgkmcnt(9)
    v_mfma_f32_16x16x32_bf16 v[232:235], a[172:175], a[32:35], v[232:235]
    ds_read_b64_tr_b16 a[192:193], v21 offset:5216
    v_add_f32 v28, s79, v28
    v_add_f32 v29, s79, v29
    v_add_f32 v156, v156, v26
    v_add_f32 v157, v157, v27
    v_add_f32 v158, v158, v28
    v_mfma_f32_16x16x32_bf16 v[236:239], a[172:175], a[36:39], v[236:239]
    ds_read_b64_tr_b16 a[194:195], v21 offset:6496
    v_add_f32 v159, v159, v29
    v_cvt_pk_bf16_f32 v52, v152, v153
    v_cvt_pk_bf16_f32 v53, v154, v155
    v_cvt_pk_bf16_f32 v54, v156, v157
    v_cvt_pk_bf16_f32 v55, v158, v159
    s_waitcnt lgkmcnt(8)
    v_mfma_f32_16x16x32_bf16 v[240:243], a[176:179], a[32:35], v[240:243]
    ds_read_b64_tr_b16 a[196:197], v21 offset:5248
    ds_write_b128 v23, v[52:55] offset:13056
    v_mul_f32 v26, s78, v160
    v_mul_f32 v27, s78, v161
    v_mul_f32 v28, s78, v162
    v_mul_f32 v29, s78, v163
    v_mfma_f32_16x16x32_bf16 v[244:247], a[176:179], a[36:39], v[244:247]
    ds_read_b64_tr_b16 a[198:199], v21 offset:6528
    v_min_f32 v26, 0, v26
    v_min_f32 v27, 0, v27
    v_min_f32 v28, 0, v28
    v_min_f32 v29, 0, v29
    s_cmp_lg_u32 s35, 0
    s_cbranch_scc1 pp_20
    buffer_load_dword v121, v94, s[24:27], 0 offen sc1
pp_20:
    s_waitcnt lgkmcnt(9)
    v_mfma_f32_16x16x32_bf16 v[208:211], a[180:183], a[40:43], v[208:211]
    ds_read_b64_tr_b16 a[160:161], v21 offset:10240
    v_exp_f32 v26, v26
    v_exp_f32 v27, v27
    v_exp_f32 v28, v28
    v_exp_f32 v29, v29
    v_max_f32 v160, 0, v160
    v_mfma_f32_16x16x32_bf16 v[212:215], a[180:183], a[44:47], v[212:215]
    ds_read_b64_tr_b16 a[162:163], v21 offset:11520
    v_max_f32 v161, 0, v161
    v_max_f32 v162, 0, v162
    v_max_f32 v163, 0, v163
    v_add_f32 v26, s79, v26
    v_add_f32 v27, s79, v27
    s_waitcnt lgkmcnt(9)
    v_mfma_f32_16x16x32_bf16 v[216:219], a[184:187], a[40:43], v[216:219]
    ds_read_b64_tr_b16 a[164:165], v21 offset:10272
    v_add_f32 v28, s79, v28
    v_add_f32 v29, s79, v29
    v_add_f32 v160, v160, v26
    v_add_f32 v161, v161, v27
    v_add_f32 v162, v162, v28
    v_mfma_f32_16x16x32_bf16 v[220:223], a[184:187], a[44:47], v[220:223]
    ds_read_b64_tr_b16 a[166:167], v21 offset:11552
    v_add_f32 v163, v163, v29
    v_mul_f32 v26, s78, v164
    v_mul_f32 v27, s78, v165
    v_mul_f32 v28, s78, v166
    v_mul_f32 v29, s78, v167
    s_waitcnt lgkmcnt(9)
    v_mfma_f32_16x16x32_bf16 v[224:227], a[188:191], a[40:43], v[224:227]
    ds_read_b64_tr_b16 a[168:169], v21 offset:10304
    v_min_f32 v26, 0, v26
    v_min_f32 v27, 0, v27
    v_min_f32 v28, 0, v28
    v_min_f32 v29, 0, v29
    v_exp_f32 v26, v26
    v_mfma_f32_16x16x32_bf16 v[228:231], a[188:191], a[44:47], v[228:231]
    ds_read_b64_tr_b16 a[170:171], v21 offset:11584
    v_exp_f32 v27, v27
    v_exp_f32 v28, v28
    v_exp_f32 v29, v29
    v_max_f32 v164, 0, v164
    s_waitcnt lgkmcnt(9)
    v_mfma_f32_16x16x32_bf16 v[232:235], a[192:195], a[40:43], v[232:235]
    ds_read_b64_tr_b16 a[172:173], v21 offset:10336
    v_max_f32 v165, 0, v165
    v_max_f32 v166, 0, v166
    v_max_f32 v167, 0, v167
    v_add_f32 v26, s79, v26
    v_mfma_f32_16x16x32_bf16 v[236:239], a[192:195], a[44:47], v[236:239]
    ds_read_b64_tr_b16 a[174:175], v21 offset:11616
    v_add_f32 v27, s79, v27
    v_add_f32 v28, s79, v28
    v_add_f32 v29, s79, v29
    v_add_f32 v164, v164, v26
    s_waitcnt lgkmcnt(8)
    v_mfma_f32_16x16x32_bf16 v[240:243], a[196:199], a[40:43], v[240:243]
    ds_read_b64_tr_b16 a[176:177], v21 offset:10368
    v_add_f32 v165, v165, v27
    v_add_f32 v166, v166, v28
    v_add_f32 v167, v167, v29
    v_cvt_pk_bf16_f32 v40, v160, v161
    v_mfma_f32_16x16x32_bf16 v[244:247], a[196:199], a[44:47], v[244:247]
    ds_read_b64_tr_b16 a[178:179], v21 offset:11648
    v_cvt_pk_bf16_f32 v41, v162, v163
    v_cvt_pk_bf16_f32 v42, v164, v165
    v_cvt_pk_bf16_f32 v43, v166, v167
    ds_write_b128 v23, v[40:43] offset:17408
    s_cmp_lg_u32 s35, 0
    s_cbranch_scc1 pollsk_23
    s_mov_b32 s60, 0
    s_waitcnt vmcnt(0)
    v_cmp_ne_u32 vcc, s40, v121
    s_nop 1
    s_cmp_eq_u64 vcc, 0
    s_cbranch_scc1 pollsk_23
    buffer_load_dword v121, v94, s[24:27], 0 offen sc1
    s_sleep 3
    buffer_load_dword v122, v94, s[24:27], 0 offen sc1
    s_sleep 3
    buffer_load_dword v123, v94, s[24:27], 0 offen sc1
poll_21:
    s_waitcnt vmcnt(2)
    v_cmp_ne_u32 vcc, s40, v121
    s_nop 1
    s_cmp_eq_u64 vcc, 0
    s_cbranch_scc1 polld_22
    buffer_load_dword v121, v94, s[24:27], 0 offen sc1
    s_waitcnt vmcnt(2)
    v_cmp_ne_u32 vcc, s40, v122
    s_nop 1
    s_cmp_eq_u64 vcc, 0
    s_cbranch_scc1 polld_22
    buffer_load_dword v122, v94, s[24:27], 0 offen sc1
    s_waitcnt vmcnt(2)
    v_cmp_ne_u32 vcc, s40, v123
    s_nop 1
    s_cmp_eq_u64 vcc, 0
    s_cbranch_scc1 polld_22
    buffer_load_dword v123, v94, s[24:27], 0 offen sc1
    s_add_u32 s60, s60, 1
    s_cmp_lt_u32 s60, 20000
    s_cbranch_scc1 poll_21
polld_22:
pollsk_23:
    s_waitcnt vmcnt(12) lgkmcnt(0)
    s_barrier
    s_waitcnt lgkmcnt(9)
    v_mfma_f32_16x16x32_bf16 v[208:211], a[160:163], a[48:51], v[208:211]
    ds_read_b64_tr_b16 a[180:181], v21 offset:15360
    s_mul_i32 s38, s35, 4352
    v_add_u32 v26, s38, v24
    v_add_u32 v27, 17408, v26
    ds_read_b128 v[128:131], v26 offset:0
    ds_read_b128 v[132:135], v26 offset:64
    v_mfma_f32_16x16x32_bf16 v[212:215], a[160:163], a[52:55], v[212:215]
    ds_read_b64_tr_b16 a[182:183], v21 offset:16640
    ds_read_b128 v[136:139], v26 offset:128
    ds_read_b128 v[140:143], v26 offset:192
    ds_read_b128 v[144:147], v27 offset:0
    ds_read_b128 v[148:151], v27 offset:64
    ds_read_b128 v[152:155], v27 offset:128
    s_waitcnt lgkmcnt(15)
    v_mfma_f32_16x16x32_bf16 v[216:219], a[164:167], a[48:51], v[216:219]
    ds_read_b64_tr_b16 a[184:185], v21 offset:15392
    ds_read_b128 v[156:159], v27 offset:192
    ds_read_b128 v[160:163], v27 offset:4352
    ds_read_b128 v[164:167], v27 offset:4416
    ds_read_b128 v[168:171], v27 offset:4480
    v_mfma_f32_16x16x32_bf16 v[220:223], a[164:167], a[52:55], v[220:223]
    ds_read_b64_tr_b16 a[186:187], v21 offset:16672
    ds_read_b128 v[172:175], v27 offset:4544
    ds_read_b128 v[176:179], v27 offset:8704
    ds_read_b128 v[180:183], v27 offset:8768
    ds_read_b128 v[184:187], v27 offset:8832
    s_waitcnt lgkmcnt(15)
    v_mfma_f32_16x16x32_bf16 v[224:227], a[168:171], a[48:51], v[224:227]
    ds_read_b64_tr_b16 a[188:189], v21 offset:15424
    ds_read_b128 v[188:191], v27 offset:8896
    ds_read_b128 v[192:195], v24 offset:17408
    ds_read_b128 v[196:199], v24 offset:17472
    ds_read_b128 v[200:203], v24 offset:17536
    v_mfma_f32_16x16x32_bf16 v[228:231], a[168:171], a[52:55], v[228:231]
    ds_read_b64_tr_b16 a[190:191], v21 offset:16704
    ds_read_b128 v[204:207], v24 offset:17600
    s_min_u32 s38, s35, 1
    s_mul_i32 s38, s38, 4352
    v_add_u32 v28, s38, v24
    s_waitcnt lgkmcnt(15)
    v_mfma_f32_16x16x32_bf16 v[232:235], a[172:175], a[48:51], v[232:235]
    ds_read_b64_tr_b16 a[192:193], v21 offset:15456
    ds_read_b128 v[40:43], v28 offset:34816
    ds_read_b128 v[44:47], v28 offset:34880
    ds_read_b128 v[48:51], v28 offset:34944
    ds_read_b128 v[52:55], v28 offset:35008
    v_mfma_f32_16x16x32_bf16 v[236:239], a[172:175], a[52:55], v[236:239]
    ds_read_b64_tr_b16 a[194:195], v21 offset:16736
    v_mov_b32 v76, 0x3f803f80
    v_mov_b32 v77, 0x3f803f80
    v_mov_b32 v78, 0x3f803f80
    s_waitcnt lgkmcnt(15)
    v_mfma_f32_16x16x32_bf16 v[240:243], a[176:179], a[48:51], v[240:243]
    ds_read_b64_tr_b16 a[196:197], v21 offset:15488
    v_mov_b32 v79, 0x3f803f80
    s_lshl_b32 s38, s35, 4
    v_lshl_add_u32 v29, v2, 2, s38
    v_mul_u32_u24 v30, 205, v29
    v_mfma_f32_16x16x32_bf16 v[244:247], a[176:179], a[52:55], v[244:247]
    ds_read_b64_tr_b16 a[198:199], v21 offset:16768
    v_lshrrev_b32 v30, 12, v30
    v_mul_u32_u24 v31, 20, v30
    v_sub_u32 v31, v29, v31
    v_lshlrev_b32 v31, 2, v31
    s_waitcnt lgkmcnt(15)
    v_mfma_f32_16x16x32_bf16 v[208:211], a[180:183], a[56:59], v[208:211]
    ds_read_b64_tr_b16 a[160:161], v22 offset:0
    s_waitcnt lgkmcnt(3)
    s_cmp_lt_u32 s35, 2
    s_cbranch_scc1 sel_19
    v_mov_b32 v40, 0x3f803f80
    v_mov_b32 v41, 0x3f803f80
    v_mov_b32 v42, 0x3f803f80
    v_mov_b32 v43, 0x3f803f80
    v_mov_b32 v44, 0x3f803f80
    v_mov_b32 v45, 0x3f803f80
    v_mov_b32 v46, 0x3f803f80
    v_mov_b32 v47, 0x3f803f80
    v_mov_b32 v48, 0x3f803f80
    v_mov_b32 v49, 0x3f803f80
    v_mov_b32 v50, 0x3f803f80
    v_mov_b32 v51, 0x3f803f80
    v_mov_b32 v52, 0x3f803f80
    v_mov_b32 v53, 0x3f803f80
    v_mov_b32 v54, 0x3f803f80
    v_mov_b32 v55, 0x3f803f80
    s_nop 1
sel_19:
    v_mfma_f32_16x16x32_bf16 v[212:215], a[180:183], a[60:63], v[212:215]
    ds_read_b64_tr_b16 a[162:163], v22 offset:1280
    v_mfma_f32_16x16x32_bf16 v[56:59], v[128:131], v[144:147], 0
    s_waitcnt lgkmcnt(15)
    v_mfma_f32_16x16x32_bf16 v[216:219], a[184:187], a[56:59], v[216:219]
    ds_read_b64_tr_b16 a[164:165], v22 offset:32
    v_mfma_f32_16x16x32_bf16 v[56:59], v[132:135], v[148:151], v[56:59]
    v_mfma_f32_16x16x32_bf16 v[220:223], a[184:187], a[60:63], v[220:223]
    ds_read_b64_tr_b16 a[166:167], v22 offset:1312
    v_mfma_f32_16x16x32_bf16 v[56:59], v[136:139], v[152:155], v[56:59]
    s_waitcnt lgkmcnt(13)
    v_mfma_f32_16x16x32_bf16 v[224:227], a[188:191], a[56:59], v[224:227]
    ds_read_b64_tr_b16 a[168:169], v22 offset:64
    v_mfma_f32_16x16x32_bf16 v[56:59], v[140:143], v[156:159], v[56:59]
    v_mfma_f32_16x16x32_bf16 v[228:231], a[188:191], a[60:63], v[228:231]
    ds_read_b64_tr_b16 a[170:171], v22 offset:1344
    v_mfma_f32_16x16x32_bf16 v[60:63], v[128:131], v[160:163], 0
    s_waitcnt lgkmcnt(8)
    v_mfma_f32_16x16x32_bf16 v[232:235], a[192:195], a[56:59], v[232:235]
    ds_read_b64_tr_b16 a[172:173], v22 offset:96
    v_mfma_f32_16x16x32_bf16 v[60:63], v[132:135], v[164:167], v[60:63]
    v_mfma_f32_16x16x32_bf16 v[236:239], a[192:195], a[60:63], v[236:239]
    ds_read_b64_tr_b16 a[174:175], v22 offset:1376
    v_mfma_f32_16x16x32_bf16 v[60:63], v[136:139], v[168:171], v[60:63]
    s_waitcnt lgkmcnt(8)
    v_mfma_f32_16x16x32_bf16 v[240:243], a[196:199], a[56:59], v[240:243]
    ds_read_b64_tr_b16 a[176:177], v22 offset:128
    v_mfma_f32_16x16x32_bf16 v[60:63], v[140:143], v[172:175], v[60:63]
    v_mfma_f32_16x16x32_bf16 v[244:247], a[196:199], a[60:63], v[244:247]
    ds_read_b64_tr_b16 a[178:179], v22 offset:1408
    v_mfma_f32_16x16x32_bf16 v[64:67], v[128:131], v[176:179], 0
    s_waitcnt lgkmcnt(8)
    v_mfma_f32_16x16x32_bf16 v[208:211], a[160:163], a[64:67], v[208:211]
    ds_read_b64_tr_b16 a[180:181], v22 offset:5120
    v_mfma_f32_16x16x32_bf16 v[64:67], v[132:135], v[180:183], v[64:67]
    v_mfma_f32_16x16x32_bf16 v[64:67], v[136:139], v[184:187], v[64:67]
    v_mfma_f32_16x16x32_bf16 v[212:215], a[160:163], a[68:71], v[212:215]
    ds_read_b64_tr_b16 a[182:183], v22 offset:6400
    v_mfma_f32_16x16x32_bf16 v[64:67], v[140:143], v[188:191], v[64:67]
    s_waitcnt lgkmcnt(8)
    v_mfma_f32_16x16x32_bf16 v[216:219], a[164:167], a[64:67], v[216:219]
    ds_read_b64_tr_b16 a[184:185], v22 offset:5152
    v_mfma_f32_16x16x32_bf16 v[68:71], v[128:131], v[76:79], 0
    v_mfma_f32_16x16x32_bf16 v[220:223], a[164:167], a[68:71], v[220:223]
    ds_read_b64_tr_b16 a[186:187], v22 offset:6432
    v_mfma_f32_16x16x32_bf16 v[68:71], v[132:135], v[76:79], v[68:71]
    s_waitcnt lgkmcnt(8)
    v_mfma_f32_16x16x32_bf16 v[224:227], a[168:171], a[64:67], v[224:227]
    ds_read_b64_tr_b16 a[188:189], v22 offset:5184
    v_mfma_f32_16x16x32_bf16 v[68:71], v[136:139], v[76:79], v[68:71]
    v_mfma_f32_16x16x32_bf16 v[228:231], a[168:171], a[68:71], v[228:231]
    ds_read_b64_tr_b16 a[190:191], v22 offset:6464
    v_mfma_f32_16x16x32_bf16 v[68:71], v[140:143], v[76:79], v[68:71]
    s_waitcnt lgkmcnt(8)
    v_mfma_f32_16x16x32_bf16 v[232:235], a[172:175], a[64:67], v[232:235]
    ds_read_b64_tr_b16 a[192:193], v22 offset:5216
    v_mfma_f32_16x16x32_bf16 v[72:75], v[192:195], v[40:43], 0
    v_mfma_f32_16x16x32_bf16 v[236:239], a[172:175], a[68:71], v[236:239]
    ds_read_b64_tr_b16 a[194:195], v22 offset:6496
    v_mfma_f32_16x16x32_bf16 v[72:75], v[196:199], v[44:47], v[72:75]
    s_waitcnt lgkmcnt(8)
    v_mfma_f32_16x16x32_bf16 v[240:243], a[176:179], a[64:67], v[240:243]
    ds_read_b64_tr_b16 a[196:197], v22 offset:5248
    v_mfma_f32_16x16x32_bf16 v[72:75], v[200:203], v[48:51], v[72:75]
    v_mfma_f32_16x16x32_bf16 v[244:247], a[176:179], a[68:71], v[244:247]
    ds_read_b64_tr_b16 a[198:199], v22 offset:6528
    v_mfma_f32_16x16x32_bf16 v[72:75], v[204:207], v[52:55], v[72:75]
    s_waitcnt lgkmcnt(8)
    v_mfma_f32_16x16x32_bf16 v[208:211], a[180:183], a[72:75], v[208:211]
    ds_read_b64_tr_b16 a[160:161], v22 offset:10240
    s_nop 7
    s_add_u32 s42, s35, 0
    s_sub_u32 s42, s42, 1
    s_lshl_b32 s38, s42, 4
    v_add_u32 v32, s38, v3
    v_and_b32 v32, 0xff, v32
    v_mul_u32_u24 v33, 205, v32
    v_mfma_f32_16x16x32_bf16 v[212:215], a[180:183], a[76:79], v[212:215]
    ds_read_b64_tr_b16 a[162:163], v22 offset:11520
    v_lshrrev_b32 v33, 12, v33
    v_mul_u32_u24 v32, 80, v32
    v_add_u32 v32, v32, v31
    v_add_u32 v32, 126976, v32
    v_cmp_eq_u32 vcc, v30, v33
    s_cmp_le_u32 s42, 4
    s_cselect_b64 s[80:81], vcc, 0
    s_waitcnt lgkmcnt(8)
    v_mfma_f32_16x16x32_bf16 v[216:219], a[184:187], a[72:75], v[216:219]
    ds_read_b64_tr_b16 a[164:165], v22 offset:10272
    s_mov_b64 exec, s[80:81]
    ds_write_b128 v32, v[56:59]
    s_mov_b64 exec, -1
    s_add_u32 s42, s35, 1
    s_sub_u32 s42, s42, 1
    s_lshl_b32 s38, s42, 4
    v_add_u32 v32, s38, v3
    v_and_b32 v32, 0xff, v32
    v_mul_u32_u24 v33, 205, v32
    v_mfma_f32_16x16x32_bf16 v[220:223], a[184:187], a[76:79], v[220:223]
    ds_read_b64_tr_b16 a[166:167], v22 offset:11552
    v_lshrrev_b32 v33, 12, v33
    v_mul_u32_u24 v32, 80, v32
    v_add_u32 v32, v32, v31
    v_add_u32 v32, 126976, v32
    v_cmp_eq_u32 vcc, v30, v33
    s_cmp_le_u32 s42, 4
    s_cselect_b64 s[80:81], vcc, 0
    s_waitcnt lgkmcnt(8)
    v_mfma_f32_16x16x32_bf16 v[224:227], a[188:191], a[72:75], v[224:227]
    ds_read_b64_tr_b16 a[168:169], v22 offset:10304
    s_mov_b64 exec, s[80:81]
    ds_write_b128 v32, v[60:63]
    s_mov_b64 exec, -1
    s_add_u32 s42, s35, 2
    s_sub_u32 s42, s42, 1
    s_lshl_b32 s38, s42, 4
    v_add_u32 v32, s38, v3
    v_and_b32 v32, 0xff, v32
    v_mul_u32_u24 v33, 205, v32
    v_mfma_f32_16x16x32_bf16 v[228:231], a[188:191], a[76:79], v[228:231]
    ds_read_b64_tr_b16 a[170:171], v22 offset:11584
    v_lshrrev_b32 v33, 12, v33
    v_mul_u32_u24 v32, 80, v32
    v_add_u32 v32, v32, v31
    v_add_u32 v32, 126976, v32
    v_cmp_eq_u32 vcc, v30, v33
    s_cmp_le_u32 s42, 4
    s_cselect_b64 s[80:81], vcc, 0
    s_waitcnt lgkmcnt(8)
    v_mfma_f32_16x16x32_bf16 v[232:235], a[192:195], a[72:75], v[232:235]
    ds_read_b64_tr_b16 a[172:173], v22 offset:10336
    s_mov_b64 exec, s[80:81]
    ds_write_b128 v32, v[64:67]
    s_mov_b64 exec, -1
    v_lshlrev_b32 v32, 2, v29
    v_add_u32 v32, 133376, v32
    v_cmp_eq_u32 vcc, 0, v3
    s_mov_b64 s[80:81], vcc
    s_mov_b64 exec, s[80:81]
    ds_write_b128 v32, v[68:71]
    s_mov_b64 exec, -1
    s_min_u32 s38, s35, 1
    v_mfma_f32_16x16x32_bf16 v[236:239], a[192:195], a[76:79], v[236:239]
    ds_read_b64_tr_b16 a[174:175], v22 offset:11616
    s_add_u32 s38, s38, 3
    s_lshl_b32 s38, s38, 4
    v_add_u32 v32, s38, v3
    v_cmp_le_u32 vcc, 60, v32
    v_mul_u32_u24 v32, 80, v32
    v_lshl_add_u32 v32, v2, 4, v32
    v_add_u32 v32, 126992, v32
    s_waitcnt lgkmcnt(8)
    v_mfma_f32_16x16x32_bf16 v[240:243], a[196:199], a[72:75], v[240:243]
    ds_read_b64_tr_b16 a[176:177], v22 offset:10368
    s_mov_b64 s[80:81], vcc
    v_lshlrev_b32 v33, 4, v2
    v_add_u32 v33, 133632, v33
    v_cmp_eq_u32 vcc, 0, v3
    s_cmp_eq_u32 s35, 2
    s_cselect_b64 s[80:81], vcc, s[80:81]
    v_mfma_f32_16x16x32_bf16 v[244:247], a[196:199], a[76:79], v[244:247]
    ds_read_b64_tr_b16 a[178:179], v22 offset:11648
    s_cselect_b64 vcc, -1, 0
    s_nop 1
    v_cndmask_b32 v32, v32, v33, vcc
    s_cmp_eq_u32 s35, 3
    s_cselect_b64 s[80:81], 0, s[80:81]
    s_mov_b64 exec, s[80:81]
    ds_write_b128 v32, v[72:75]
    s_mov_b64 exec, -1
    s_waitcnt vmcnt(2) lgkmcnt(0)
    s_barrier
    s_waitcnt lgkmcnt(8)
    v_mfma_f32_16x16x32_bf16 v[208:211], a[160:163], a[80:83], v[208:211]
    ds_read_b64_tr_b16 a[180:181], v22 offset:15360
    v_lshlrev_b32 v26, 2, v0
    v_add_u32 v27, 126976, v26
    ds_read_b32 v40, v27 offset:0
    v_mfma_f32_16x16x32_bf16 v[212:215], a[160:163], a[84:87], v[212:215]
    ds_read_b64_tr_b16 a[182:183], v22 offset:16640
    ds_read_b32 v41, v27 offset:1024
    ds_read_b32 v42, v27 offset:2048
    ds_read_b32 v43, v27 offset:3072
    s_waitcnt lgkmcnt(12)
    v_mfma_f32_16x16x32_bf16 v[216:219], a[164:167], a[80:83], v[216:219]
    ds_read_b64_tr_b16 a[184:185], v22 offset:15392
    ds_read_b32 v44, v27 offset:4096
    ds_read_b32 v45, v27 offset:5120
    v_mfma_f32_16x16x32_bf16 v[220:223], a[164:167], a[84:87], v[220:223]
    ds_read_b64_tr_b16 a[186:187], v22 offset:16672
    ds_read_b32 v46, v27 offset:6144
    s_waitcnt lgkmcnt(15)
    v_mfma_f32_16x16x32_bf16 v[224:227], a[168:171], a[80:83], v[224:227]
    ds_read_b64_tr_b16 a[188:189], v22 offset:15424
    s_lshl_b32 s84, s34, 13
    s_add_u32 s84, s84, 6291456
    v_mfma_f32_16x16x32_bf16 v[228:231], a[168:171], a[84:87], v[228:231]
    ds_read_b64_tr_b16 a[190:191], v22 offset:16704
    v_cmp_gt_u32 vcc, 144, v0
    s_waitcnt lgkmcnt(2)
    s_waitcnt lgkmcnt(15)
    v_mfma_f32_16x16x32_bf16 v[232:235], a[172:175], a[80:83], v[232:235]
    ds_read_b64_tr_b16 a[192:193], v22 offset:15456
    buffer_atomic_add_f32 v40, v26, s[24:27], s84 offen offset:0
    buffer_atomic_add_f32 v41, v26, s[24:27], s84 offen offset:1024
    v_mfma_f32_16x16x32_bf16 v[236:239], a[172:175], a[84:87], v[236:239]
    ds_read_b64_tr_b16 a[194:195], v22 offset:16736
    buffer_atomic_add_f32 v42, v26, s[24:27], s84 offen offset:2048
    buffer_atomic_add_f32 v43, v26, s[24:27], s84 offen offset:3072
    s_waitcnt lgkmcnt(15)
    v_mfma_f32_16x16x32_bf16 v[240:243], a[176:179], a[80:83], v[240:243]
    ds_read_b64_tr_b16 a[196:197], v22 offset:15488
    s_add_u32 s88, s84, 4096
    buffer_atomic_add_f32 v44, v26, s[24:27], s88 offen offset:0
    v_mfma_f32_16x16x32_bf16 v[244:247], a[176:179], a[84:87], v[244:247]
    ds_read_b64_tr_b16 a[198:199], v22 offset:16768
    buffer_atomic_add_f32 v45, v26, s[24:27], s88 offen offset:1024
    s_and_saveexec_b64 s[52:53], vcc
    s_cbranch_execz a7_24
    buffer_atomic_add_f32 v46, v26, s[24:27], s88 offen offset:2048
a7_24:
    s_mov_b64 exec, s[52:53]
    s_waitcnt lgkmcnt(14)
    v_mfma_f32_16x16x32_bf16 v[208:211], a[180:183], a[88:91], v[208:211]
    ds_read_b64_tr_b16 a[160:161], v20 offset:0
    v_mfma_f32_16x16x32_bf16 v[212:215], a[180:183], a[92:95], v[212:215]
    ds_read_b64_tr_b16 a[162:163], v20 offset:1280
    s_waitcnt lgkmcnt(9)
    v_mfma_f32_16x16x32_bf16 v[216:219], a[184:187], a[88:91], v[216:219]
    ds_read_b64_tr_b16 a[164:165], v20 offset:32
    v_mfma_f32_16x16x32_bf16 v[220:223], a[184:187], a[92:95], v[220:223]
    ds_read_b64_tr_b16 a[166:167], v20 offset:1312
    s_waitcnt lgkmcnt(8)
    v_mfma_f32_16x16x32_bf16 v[224:227], a[188:191], a[88:91], v[224:227]
    ds_read_b64_tr_b16 a[168:169], v20 offset:64
    v_mfma_f32_16x16x32_bf16 v[228:231], a[188:191], a[92:95], v[228:231]
    ds_read_b64_tr_b16 a[170:171], v20 offset:1344
    s_waitcnt lgkmcnt(8)
    v_mfma_f32_16x16x32_bf16 v[232:235], a[192:195], a[88:91], v[232:235]
    ds_read_b64_tr_b16 a[172:173], v20 offset:96
    v_mfma_f32_16x16x32_bf16 v[236:239], a[192:195], a[92:95], v[236:239]
    ds_read_b64_tr_b16 a[174:175], v20 offset:1376
    s_waitcnt lgkmcnt(8)
    v_mfma_f32_16x16x32_bf16 v[240:243], a[196:199], a[88:91], v[240:243]
    ds_read_b64_tr_b16 a[176:177], v20 offset:128
    v_mfma_f32_16x16x32_bf16 v[244:247], a[196:199], a[92:95], v[244:247]
    ds_read_b64_tr_b16 a[178:179], v20 offset:1408
    s_waitcnt lgkmcnt(8)
    v_mfma_f32_16x16x32_bf16 v[208:211], a[160:163], a[96:99], v[208:211]
    ds_read_b64_tr_b16 a[180:181], v20 offset:5120
    v_mfma_f32_16x16x32_bf16 v[212:215], a[160:163], a[100:103], v[212:215]
    ds_read_b64_tr_b16 a[182:183], v20 offset:6400
    s_waitcnt lgkmcnt(8)
    v_mfma_f32_16x16x32_bf16 v[216:219], a[164:167], a[96:99], v[216:219]
    ds_read_b64_tr_b16 a[184:185], v20 offset:5152
    v_mfma_f32_16x16x32_bf16 v[220:223], a[164:167], a[100:103], v[220:223]
    ds_read_b64_tr_b16 a[186:187], v20 offset:6432
    s_waitcnt lgkmcnt(8)
    v_mfma_f32_16x16x32_bf16 v[224:227], a[168:171], a[96:99], v[224:227]
    ds_read_b64_tr_b16 a[188:189], v20 offset:5184
    v_mfma_f32_16x16x32_bf16 v[228:231], a[168:171], a[100:103], v[228:231]
    ds_read_b64_tr_b16 a[190:191], v20 offset:6464
    s_waitcnt lgkmcnt(8)
    v_mfma_f32_16x16x32_bf16 v[232:235], a[172:175], a[96:99], v[232:235]
    ds_read_b64_tr_b16 a[192:193], v20 offset:5216
    v_mfma_f32_16x16x32_bf16 v[236:239], a[172:175], a[100:103], v[236:239]
    ds_read_b64_tr_b16 a[194:195], v20 offset:6496
    s_waitcnt lgkmcnt(8)
    v_mfma_f32_16x16x32_bf16 v[240:243], a[176:179], a[96:99], v[240:243]
    ds_read_b64_tr_b16 a[196:197], v20 offset:5248
    v_mfma_f32_16x16x32_bf16 v[244:247], a[176:179], a[100:103], v[244:247]
    ds_read_b64_tr_b16 a[198:199], v20 offset:6528
    s_waitcnt lgkmcnt(8)
    v_mfma_f32_16x16x32_bf16 v[208:211], a[180:183], a[104:107], v[208:211]
    ds_read_b64_tr_b16 a[160:161], v20 offset:10240
    v_mfma_f32_16x16x32_bf16 v[212:215], a[180:183], a[108:111], v[212:215]
    ds_read_b64_tr_b16 a[162:163], v20 offset:11520
    s_waitcnt lgkmcnt(8)
    v_mfma_f32_16x16x32_bf16 v[216:219], a[184:187], a[104:107], v[216:219]
    ds_read_b64_tr_b16 a[164:165], v20 offset:10272
    v_mfma_f32_16x16x32_bf16 v[220:223], a[184:187], a[108:111], v[220:223]
    ds_read_b64_tr_b16 a[166:167], v20 offset:11552
    s_waitcnt lgkmcnt(8)
    v_mfma_f32_16x16x32_bf16 v[224:227], a[188:191], a[104:107], v[224:227]
    ds_read_b64_tr_b16 a[168:169], v20 offset:10304
    v_mfma_f32_16x16x32_bf16 v[228:231], a[188:191], a[108:111], v[228:231]
    ds_read_b64_tr_b16 a[170:171], v20 offset:11584
    s_waitcnt lgkmcnt(8)
    v_mfma_f32_16x16x32_bf16 v[232:235], a[192:195], a[104:107], v[232:235]
    ds_read_b64_tr_b16 a[172:173], v20 offset:10336
    v_mfma_f32_16x16x32_bf16 v[236:239], a[192:195], a[108:111], v[236:239]
    ds_read_b64_tr_b16 a[174:175], v20 offset:11616
    s_waitcnt lgkmcnt(8)
    v_mfma_f32_16x16x32_bf16 v[240:243], a[196:199], a[104:107], v[240:243]
    ds_read_b64_tr_b16 a[176:177], v20 offset:10368
    v_mfma_f32_16x16x32_bf16 v[244:247], a[196:199], a[108:111], v[244:247]
    ds_read_b64_tr_b16 a[178:179], v20 offset:11648
    s_waitcnt lgkmcnt(8)
    v_mfma_f32_16x16x32_bf16 v[208:211], a[160:163], a[112:115], v[208:211]
    ds_read_b64_tr_b16 a[180:181], v20 offset:15360
    v_mfma_f32_16x16x32_bf16 v[212:215], a[160:163], a[116:119], v[212:215]
    ds_read_b64_tr_b16 a[182:183], v20 offset:16640
    s_waitcnt lgkmcnt(8)
    v_mfma_f32_16x16x32_bf16 v[216:219], a[164:167], a[112:115], v[216:219]
    ds_read_b64_tr_b16 a[184:185], v20 offset:15392
    v_mfma_f32_16x16x32_bf16 v[220:223], a[164:167], a[116:119], v[220:223]
    ds_read_b64_tr_b16 a[186:187], v20 offset:16672
    s_waitcnt lgkmcnt(8)
    v_mfma_f32_16x16x32_bf16 v[224:227], a[168:171], a[112:115], v[224:227]
    ds_read_b64_tr_b16 a[188:189], v20 offset:15424
    v_mfma_f32_16x16x32_bf16 v[228:231], a[168:171], a[116:119], v[228:231]
    ds_read_b64_tr_b16 a[190:191], v20 offset:16704
    s_waitcnt lgkmcnt(8)
    v_mfma_f32_16x16x32_bf16 v[232:235], a[172:175], a[112:115], v[232:235]
    ds_read_b64_tr_b16 a[192:193], v20 offset:15456
    v_mfma_f32_16x16x32_bf16 v[236:239], a[172:175], a[116:119], v[236:239]
    ds_read_b64_tr_b16 a[194:195], v20 offset:16736
    s_waitcnt lgkmcnt(8)
    v_mfma_f32_16x16x32_bf16 v[240:243], a[176:179], a[112:115], v[240:243]
    ds_read_b64_tr_b16 a[196:197], v20 offset:15488
    v_mfma_f32_16x16x32_bf16 v[244:247], a[176:179], a[116:119], v[244:247]
    ds_read_b64_tr_b16 a[198:199], v20 offset:16768
    s_waitcnt lgkmcnt(8)
    v_mfma_f32_16x16x32_bf16 v[208:211], a[180:183], a[120:123], v[208:211]
    ds_read_b64_tr_b16 a[160:161], v20 offset:20480
    v_mfma_f32_16x16x32_bf16 v[212:215], a[180:183], a[124:127], v[212:215]
    ds_read_b64_tr_b16 a[162:163], v20 offset:21760
    s_waitcnt lgkmcnt(8)
    v_mfma_f32_16x16x32_bf16 v[216:219], a[184:187], a[120:123], v[216:219]
    ds_read_b64_tr_b16 a[164:165], v20 offset:20512
    v_mfma_f32_16x16x32_bf16 v[220:223], a[184:187], a[124:127], v[220:223]
    ds_read_b64_tr_b16 a[166:167], v20 offset:21792
    s_waitcnt lgkmcnt(8)
    v_mfma_f32_16x16x32_bf16 v[224:227], a[188:191], a[120:123], v[224:227]
    ds_read_b64_tr_b16 a[168:169], v20 offset:20544
    v_mfma_f32_16x16x32_bf16 v[228:231], a[188:191], a[124:127], v[228:231]
    ds_read_b64_tr_b16 a[170:171], v20 offset:21824
    s_waitcnt lgkmcnt(8)
    v_mfma_f32_16x16x32_bf16 v[232:235], a[192:195], a[120:123], v[232:235]
    ds_read_b64_tr_b16 a[172:173], v20 offset:20576
    v_mfma_f32_16x16x32_bf16 v[236:239], a[192:195], a[124:127], v[236:239]
    ds_read_b64_tr_b16 a[174:175], v20 offset:21856
    s_waitcnt lgkmcnt(8)
    v_mfma_f32_16x16x32_bf16 v[240:243], a[196:199], a[120:123], v[240:243]
    ds_read_b64_tr_b16 a[176:177], v20 offset:20608
    v_mfma_f32_16x16x32_bf16 v[244:247], a[196:199], a[124:127], v[244:247]
    ds_read_b64_tr_b16 a[178:179], v20 offset:21888
    s_waitcnt lgkmcnt(8)
    v_mfma_f32_16x16x32_bf16 v[208:211], a[160:163], a[128:131], v[208:211]
    ds_read_b64_tr_b16 a[180:181], v20 offset:25600
    v_mfma_f32_16x16x32_bf16 v[212:215], a[160:163], a[132:135], v[212:215]
    ds_read_b64_tr_b16 a[182:183], v20 offset:26880
    s_waitcnt lgkmcnt(8)
    v_mfma_f32_16x16x32_bf16 v[216:219], a[164:167], a[128:131], v[216:219]
    ds_read_b64_tr_b16 a[184:185], v20 offset:25632
    v_mfma_f32_16x16x32_bf16 v[220:223], a[164:167], a[132:135], v[220:223]
    ds_read_b64_tr_b16 a[186:187], v20 offset:26912
    s_waitcnt lgkmcnt(8)
    v_mfma_f32_16x16x32_bf16 v[224:227], a[168:171], a[128:131], v[224:227]
    ds_read_b64_tr_b16 a[188:189], v20 offset:25664
    v_mfma_f32_16x16x32_bf16 v[228:231], a[168:171], a[132:135], v[228:231]
    ds_read_b64_tr_b16 a[190:191], v20 offset:26944
    s_waitcnt lgkmcnt(8)
    v_mfma_f32_16x16x32_bf16 v[232:235], a[172:175], a[128:131], v[232:235]
    ds_read_b64_tr_b16 a[192:193], v20 offset:25696
    v_mfma_f32_16x16x32_bf16 v[236:239], a[172:175], a[132:135], v[236:239]
    ds_read_b64_tr_b16 a[194:195], v20 offset:26976
    s_waitcnt lgkmcnt(8)
    v_mfma_f32_16x16x32_bf16 v[240:243], a[176:179], a[128:131], v[240:243]
    ds_read_b64_tr_b16 a[196:197], v20 offset:25728
    v_mfma_f32_16x16x32_bf16 v[244:247], a[176:179], a[132:135], v[244:247]
    ds_read_b64_tr_b16 a[198:199], v20 offset:27008
    s_waitcnt lgkmcnt(8)
    v_mfma_f32_16x16x32_bf16 v[208:211], a[180:183], a[136:139], v[208:211]
    ds_read_b64_tr_b16 a[160:161], v20 offset:30720
    v_mfma_f32_16x16x32_bf16 v[212:215], a[180:183], a[140:143], v[212:215]
    ds_read_b64_tr_b16 a[162:163], v20 offset:32000
    s_waitcnt lgkmcnt(8)
    v_mfma_f32_16x16x32_bf16 v[216:219], a[184:187], a[136:139], v[216:219]
    ds_read_b64_tr_b16 a[164:165], v20 offset:30752
    v_mfma_f32_16x16x32_bf16 v[220:223], a[184:187], a[140:143], v[220:223]
    ds_read_b64_tr_b16 a[166:167], v20 offset:32032
    s_waitcnt lgkmcnt(8)
    v_mfma_f32_16x16x32_bf16 v[224:227], a[188:191], a[136:139], v[224:227]
    ds_read_b64_tr_b16 a[168:169], v20 offset:30784
    v_mfma_f32_16x16x32_bf16 v[228:231], a[188:191], a[140:143], v[228:231]
    ds_read_b64_tr_b16 a[170:171], v20 offset:32064
    s_waitcnt lgkmcnt(8)
    v_mfma_f32_16x16x32_bf16 v[232:235], a[192:195], a[136:139], v[232:235]
    ds_read_b64_tr_b16 a[172:173], v20 offset:30816
    v_mfma_f32_16x16x32_bf16 v[236:239], a[192:195], a[140:143], v[236:239]
    ds_read_b64_tr_b16 a[174:175], v20 offset:32096
    s_waitcnt lgkmcnt(8)
    v_mfma_f32_16x16x32_bf16 v[240:243], a[196:199], a[136:139], v[240:243]
    ds_read_b64_tr_b16 a[176:177], v20 offset:30848
    v_mfma_f32_16x16x32_bf16 v[244:247], a[196:199], a[140:143], v[244:247]
    ds_read_b64_tr_b16 a[178:179], v20 offset:32128
    s_waitcnt lgkmcnt(8)
    v_mfma_f32_16x16x32_bf16 v[208:211], a[160:163], a[144:147], v[208:211]
    ds_read_b64_tr_b16 a[180:181], v20 offset:35840
    v_mfma_f32_16x16x32_bf16 v[212:215], a[160:163], a[148:151], v[212:215]
    ds_read_b64_tr_b16 a[182:183], v20 offset:37120
    s_waitcnt lgkmcnt(8)
    v_mfma_f32_16x16x32_bf16 v[216:219], a[164:167], a[144:147], v[216:219]
    ds_read_b64_tr_b16 a[184:185], v20 offset:35872
    v_mfma_f32_16x16x32_bf16 v[220:223], a[164:167], a[148:151], v[220:223]
    ds_read_b64_tr_b16 a[186:187], v20 offset:37152
    s_waitcnt lgkmcnt(8)
    v_mfma_f32_16x16x32_bf16 v[224:227], a[168:171], a[144:147], v[224:227]
    ds_read_b64_tr_b16 a[188:189], v20 offset:35904
    v_mfma_f32_16x16x32_bf16 v[228:231], a[168:171], a[148:151], v[228:231]
    ds_read_b64_tr_b16 a[190:191], v20 offset:37184
    s_waitcnt lgkmcnt(8)
    v_mfma_f32_16x16x32_bf16 v[232:235], a[172:175], a[144:147], v[232:235]
    ds_read_b64_tr_b16 a[192:193], v20 offset:35936
    v_mfma_f32_16x16x32_bf16 v[236:239], a[172:175], a[148:151], v[236:239]
    ds_read_b64_tr_b16 a[194:195], v20 offset:37216
    s_waitcnt lgkmcnt(8)
    v_mfma_f32_16x16x32_bf16 v[240:243], a[176:179], a[144:147], v[240:243]
    ds_read_b64_tr_b16 a[196:197], v20 offset:35968
    v_mfma_f32_16x16x32_bf16 v[244:247], a[176:179], a[148:151], v[244:247]
    ds_read_b64_tr_b16 a[198:199], v20 offset:37248
    s_waitcnt lgkmcnt(8)
    v_mfma_f32_16x16x32_bf16 v[208:211], a[180:183], a[152:155], v[208:211]
    v_mfma_f32_16x16x32_bf16 v[212:215], a[180:183], a[156:159], v[212:215]
    s_waitcnt lgkmcnt(6)
    v_mfma_f32_16x16x32_bf16 v[216:219], a[184:187], a[152:155], v[216:219]
    v_mfma_f32_16x16x32_bf16 v[220:223], a[184:187], a[156:159], v[220:223]
    s_waitcnt lgkmcnt(4)
    v_mfma_f32_16x16x32_bf16 v[224:227], a[188:191], a[152:155], v[224:227]
    v_mfma_f32_16x16x32_bf16 v[228:231], a[188:191], a[156:159], v[228:231]
    s_waitcnt lgkmcnt(2)
    v_mfma_f32_16x16x32_bf16 v[232:235], a[192:195], a[152:155], v[232:235]
    v_mfma_f32_16x16x32_bf16 v[236:239], a[192:195], a[156:159], v[236:239]
    s_waitcnt lgkmcnt(0)
    v_mfma_f32_16x16x32_bf16 v[240:243], a[196:199], a[152:155], v[240:243]
    v_mfma_f32_16x16x32_bf16 v[244:247], a[196:199], a[156:159], v[244:247]
    s_waitcnt vmcnt(0)
    s_barrier
    s_cmp_lg_u32 s35, 0
    s_cbranch_scc1 fl_25
    s_lshl_b32 s38, s32, 7
    s_add_u32 s38, s38, s91
    s_lshl_b32 s38, s38, 7
    v_mov_b32 v124, s40
    buffer_store_dword v124, off, s[24:27], s38 sc1
fl_25:
    v_mul_f32 v26, s78, v208
    v_mul_f32 v27, s78, v209
    v_mul_f32 v28, s78, v210
    v_mul_f32 v29, s78, v211
    v_min_f32 v26, 0, v26
    v_min_f32 v27, 0, v27
    v_min_f32 v28, 0, v28
    v_min_f32 v29, 0, v29
    v_exp_f32 v26, v26
    v_exp_f32 v27, v27
    v_exp_f32 v28, v28
    v_exp_f32 v29, v29
    v_max_f32 v208, 0, v208
    v_max_f32 v209, 0, v209
    v_max_f32 v210, 0, v210
    v_max_f32 v211, 0, v211
    v_add_f32 v26, s79, v26
    v_add_f32 v27, s79, v27
    v_add_f32 v28, s79, v28
    v_add_f32 v29, s79, v29
    v_add_f32 v208, v208, v26
    v_add_f32 v209, v209, v27
    v_add_f32 v210, v210, v28
    v_add_f32 v211, v211, v29
    v_mul_f32 v26, s78, v212
    v_mul_f32 v27, s78, v213
    v_mul_f32 v28, s78, v214
    v_mul_f32 v29, s78, v215
    v_min_f32 v26, 0, v26
    v_min_f32 v27, 0, v27
    v_min_f32 v28, 0, v28
    v_min_f32 v29, 0, v29
    v_exp_f32 v26, v26
    v_exp_f32 v27, v27
    v_exp_f32 v28, v28
    v_exp_f32 v29, v29
    v_max_f32 v212, 0, v212
    v_max_f32 v213, 0, v213
    v_max_f32 v214, 0, v214
    v_max_f32 v215, 0, v215
    v_add_f32 v26, s79, v26
    v_add_f32 v27, s79, v27
    v_add_f32 v28, s79, v28
    v_add_f32 v29, s79, v29
    v_add_f32 v212, v212, v26
    v_add_f32 v213, v213, v27
    v_add_f32 v214, v214, v28
    v_add_f32 v215, v215, v29
    v_mul_f32 v26, s78, v216
    v_mul_f32 v27, s78, v217
    v_mul_f32 v28, s78, v218
    v_mul_f32 v29, s78, v219
    v_min_f32 v26, 0, v26
    v_min_f32 v27, 0, v27
    v_min_f32 v28, 0, v28
    v_min_f32 v29, 0, v29
    v_exp_f32 v26, v26
    v_exp_f32 v27, v27
    v_exp_f32 v28, v28
    v_exp_f32 v29, v29
    v_max_f32 v216, 0, v216
    v_max_f32 v217, 0, v217
    v_max_f32 v218, 0, v218
    v_max_f32 v219, 0, v219
    v_add_f32 v26, s79, v26
    v_add_f32 v27, s79, v27
    v_add_f32 v28, s79, v28
    v_add_f32 v29, s79, v29
    v_add_f32 v216, v216, v26
    v_add_f32 v217, v217, v27
    v_add_f32 v218, v218, v28
    v_add_f32 v219, v219, v29
    v_mul_f32 v26, s78, v220
    v_mul_f32 v27, s78, v221
    v_mul_f32 v28, s78, v222
    v_mul_f32 v29, s78, v223
    v_min_f32 v26, 0, v26
    v_min_f32 v27, 0, v27
    v_min_f32 v28, 0, v28
    v_min_f32 v29, 0, v29
    v_exp_f32 v26, v26
    v_exp_f32 v27, v27
    v_exp_f32 v28, v28
    v_exp_f32 v29, v29
    v_max_f32 v220, 0, v220
    v_max_f32 v221, 0, v221
    v_max_f32 v222, 0, v222
    v_max_f32 v223, 0, v223
    v_add_f32 v26, s79, v26
    v_add_f32 v27, s79, v27
    v_add_f32 v28, s79, v28
    v_add_f32 v29, s79, v29
    v_add_f32 v220, v220, v26
    v_add_f32 v221, v221, v27
    v_add_f32 v222, v222, v28
    v_add_f32 v223, v223, v29
    v_mul_f32 v26, s78, v224
    v_mul_f32 v27, s78, v225
    v_mul_f32 v28, s78, v226
    v_mul_f32 v29, s78, v227
    v_min_f32 v26, 0, v26
    v_min_f32 v27, 0, v27
    v_min_f32 v28, 0, v28
    v_min_f32 v29, 0, v29
    v_exp_f32 v26, v26
    v_exp_f32 v27, v27
    v_exp_f32 v28, v28
    v_exp_f32 v29, v29
    v_max_f32 v224, 0, v224
    v_max_f32 v225, 0, v225
    v_max_f32 v226, 0, v226
    v_max_f32 v227, 0, v227
    v_add_f32 v26, s79, v26
    v_add_f32 v27, s79, v27
    v_add_f32 v28, s79, v28
    v_add_f32 v29, s79, v29
    v_add_f32 v224, v224, v26
    v_add_f32 v225, v225, v27
    v_add_f32 v226, v226, v28
    v_add_f32 v227, v227, v29
    v_mul_f32 v26, s78, v228
    v_mul_f32 v27, s78, v229
    v_mul_f32 v28, s78, v230
    v_mul_f32 v29, s78, v231
    v_min_f32 v26, 0, v26
    v_min_f32 v27, 0, v27
    v_min_f32 v28, 0, v28
    v_min_f32 v29, 0, v29
    v_exp_f32 v26, v26
    v_exp_f32 v27, v27
    v_exp_f32 v28, v28
    v_exp_f32 v29, v29
    v_max_f32 v228, 0, v228
    v_max_f32 v229, 0, v229
    v_max_f32 v230, 0, v230
    v_max_f32 v231, 0, v231
    v_add_f32 v26, s79, v26
    v_add_f32 v27, s79, v27
    v_add_f32 v28, s79, v28
    v_add_f32 v29, s79, v29
    v_add_f32 v228, v228, v26
    v_add_f32 v229, v229, v27
    v_add_f32 v230, v230, v28
    v_add_f32 v231, v231, v29
    v_mul_f32 v26, s78, v232
    v_mul_f32 v27, s78, v233
    v_mul_f32 v28, s78, v234
    v_mul_f32 v29, s78, v235
    v_min_f32 v26, 0, v26
    v_min_f32 v27, 0, v27
    v_min_f32 v28, 0, v28
    v_min_f32 v29, 0, v29
    v_exp_f32 v26, v26
    v_exp_f32 v27, v27
    v_exp_f32 v28, v28
    v_exp_f32 v29, v29
    v_max_f32 v232, 0, v232
    v_max_f32 v233, 0, v233
    v_max_f32 v234, 0, v234
    v_max_f32 v235, 0, v235
    v_add_f32 v26, s79, v26
    v_add_f32 v27, s79, v27
    v_add_f32 v28, s79, v28
    v_add_f32 v29, s79, v29
    v_add_f32 v232, v232, v26
    v_add_f32 v233, v233, v27
    v_add_f32 v234, v234, v28
    v_add_f32 v235, v235, v29
    v_mul_f32 v26, s78, v236
    v_mul_f32 v27, s78, v237
    v_mul_f32 v28, s78, v238
    v_mul_f32 v29, s78, v239
    v_min_f32 v26, 0, v26
    v_min_f32 v27, 0, v27
    v_min_f32 v28, 0, v28
    v_min_f32 v29, 0, v29
    v_exp_f32 v26, v26
    v_exp_f32 v27, v27
    v_exp_f32 v28, v28
    v_exp_f32 v29, v29
    v_max_f32 v236, 0, v236
    v_max_f32 v237, 0, v237
    v_max_f32 v238, 0, v238
    v_max_f32 v239, 0, v239
    v_add_f32 v26, s79, v26
    v_add_f32 v27, s79, v27
    v_add_f32 v28, s79, v28
    v_add_f32 v29, s79, v29
    v_add_f32 v236, v236, v26
    v_add_f32 v237, v237, v27
    v_add_f32 v238, v238, v28
    v_add_f32 v239, v239, v29
    v_mul_f32 v26, s78, v240
    v_mul_f32 v27, s78, v241
    v_mul_f32 v28, s78, v242
    v_mul_f32 v29, s78, v243
    v_min_f32 v26, 0, v26
    v_min_f32 v27, 0, v27
    v_min_f32 v28, 0, v28
    v_min_f32 v29, 0, v29
    v_exp_f32 v26, v26
    v_exp_f32 v27, v27
    v_exp_f32 v28, v28
    v_exp_f32 v29, v29
    v_max_f32 v240, 0, v240
    v_max_f32 v241, 0, v241
    v_max_f32 v242, 0, v242
    v_max_f32 v243, 0, v243
    v_add_f32 v26, s79, v26
    v_add_f32 v27, s79, v27
    v_add_f32 v28, s79, v28
    v_add_f32 v29, s79, v29
    v_add_f32 v240, v240, v26
    v_add_f32 v241, v241, v27
    v_add_f32 v242, v242, v28
    v_add_f32 v243, v243, v29
    v_mul_f32 v26, s78, v244
    v_mul_f32 v27, s78, v245
    v_mul_f32 v28, s78, v246
    v_mul_f32 v29, s78, v247
    v_min_f32 v26, 0, v26
    v_min_f32 v27, 0, v27
    v_min_f32 v28, 0, v28
    v_min_f32 v29, 0, v29
    v_exp_f32 v26, v26
    v_exp_f32 v27, v27
    v_exp_f32 v28, v28
    v_exp_f32 v29, v29
    v_max_f32 v244, 0, v244
    v_max_f32 v245, 0, v245
    v_max_f32 v246, 0, v246
    v_max_f32 v247, 0, v247
    v_add_f32 v26, s79, v26
    v_add_f32 v27, s79, v27
    v_add_f32 v28, s79, v28
    v_add_f32 v29, s79, v29
    v_add_f32 v244, v244, v26
    v_add_f32 v245, v245, v27
    v_add_f32 v246, v246, v28
    v_add_f32 v247, v247, v29
    s_cmp_lg_u32 s35, 0
    s_cbranch_scc1 pp_26
    buffer_load_dword v121, v93, s[24:27], 0 offen sc1
pp_26:
    v_cvt_pk_bf16_f32 v200, v208, v209
    v_cvt_pk_bf16_f32 v201, v210, v211
    v_cvt_pk_bf16_f32 v202, v216, v217
    v_cvt_pk_bf16_f32 v203, v218, v219
    v_cvt_pk_bf16_f32 v248, v224, v225
    v_cvt_pk_bf16_f32 v249, v226, v227
    v_cvt_pk_bf16_f32 v250, v232, v233
    v_cvt_pk_bf16_f32 v251, v234, v235
    v_cvt_pk_bf16_f32 v112, v240, v241
    v_cvt_pk_bf16_f32 v113, v242, v243
    v_mov_b32 v114, 0
    v_mov_b32 v115, 0
    v_cvt_pk_bf16_f32 v204, v212, v213
    v_cvt_pk_bf16_f32 v205, v214, v215
    v_cvt_pk_bf16_f32 v206, v220, v221
    v_cvt_pk_bf16_f32 v207, v222, v223
    v_cvt_pk_bf16_f32 v252, v228, v229
    v_cvt_pk_bf16_f32 v253, v230, v231
    v_cvt_pk_bf16_f32 v254, v236, v237
    v_cvt_pk_bf16_f32 v255, v238, v239
    v_cvt_pk_bf16_f32 v80, v244, v245
    v_cvt_pk_bf16_f32 v81, v246, v247
    v_mov_b32 v82, 0
    v_mov_b32 v83, 0
    v_lshlrev_b32 v26, 4, v0
    v_mov_b32 v30, 0
    v_mov_b32 v31, 0
    v_mov_b32 v32, 0
    v_mov_b32 v33, 0
    ds_write_b128 v26, v[30:33] offset:0
    ds_write_b128 v26, v[30:33] offset:4096
    ds_write_b128 v26, v[30:33] offset:8192
    ds_write_b128 v26, v[30:33] offset:12288
    v_cmp_gt_u32 vcc, 68, v0
    s_and_saveexec_b64 s[52:53], vcc
    ds_write_b128 v26, v[30:33] offset:16384
    s_mov_b64 exec, s[52:53]
    s_cmp_lg_u32 s35, 0
    s_cbranch_scc1 pollsk_29
    s_mov_b32 s60, 0
    s_waitcnt vmcnt(0)
    v_cmp_ne_u32 vcc, s40, v121
    s_nop 1
    s_cmp_eq_u64 vcc, 0
    s_cbranch_scc1 pollsk_29
    buffer_load_dword v121, v93, s[24:27], 0 offen sc1
    s_sleep 3
    buffer_load_dword v122, v93, s[24:27], 0 offen sc1
    s_sleep 3
    buffer_load_dword v123, v93, s[24:27], 0 offen sc1
poll_27:
    s_waitcnt vmcnt(2)
    v_cmp_ne_u32 vcc, s40, v121
    s_nop 1
    s_cmp_eq_u64 vcc, 0
    s_cbranch_scc1 polld_28
    buffer_load_dword v121, v93, s[24:27], 0 offen sc1
    s_waitcnt vmcnt(2)
    v_cmp_ne_u32 vcc, s40, v122
    s_nop 1
    s_cmp_eq_u64 vcc, 0
    s_cbranch_scc1 polld_28
    buffer_load_dword v122, v93, s[24:27], 0 offen sc1
    s_waitcnt vmcnt(2)
    v_cmp_ne_u32 vcc, s40, v123
    s_nop 1
    s_cmp_eq_u64 vcc, 0
    s_cbranch_scc1 polld_28
    buffer_load_dword v123, v93, s[24:27], 0 offen sc1
    s_add_u32 s60, s60, 1
    s_cmp_lt_u32 s60, 20000
    s_cbranch_scc1 poll_27
polld_28:
pollsk_29:
    s_waitcnt lgkmcnt(0)
    s_barrier
    v_lshlrev_b32 v32, 4, v0
    v_add_u32 v33, 256, v0
    v_min_u32 v33, 419, v33
    v_lshlrev_b32 v33, 4, v33
    s_lshl_b32 s38, s34, 13
    s_add_u32 s38, s38, 6291456
    buffer_load_dwordx4 v[152:155], v32, s[24:27], s38 offen sc1
    buffer_load_dwordx4 v[156:159], v33, s[24:27], s38 offen sc1
    s_waitcnt vmcnt(0)
    v_cvt_pk_bf16_f32 v30, v152, v153
    v_cvt_pk_bf16_f32 v31, v154, v155
    v_cvt_pk_bf16_f32 v32, v156, v157
    v_cvt_pk_bf16_f32 v33, v158, v159
    ds_write_b64 v96, v[30:31]
    v_cmp_gt_u32 vcc, 420, v98
    s_and_saveexec_b64 s[52:53], vcc
    ds_write_b64 v97, v[32:33]
    s_mov_b64 exec, s[52:53]
    s_waitcnt lgkmcnt(0)
    s_barrier
    ds_read_b128 v[40:43], v99 offset:0
    ds_read_b128 v[128:131], v106 offset:16640
    ds_read_b128 v[44:47], v99 offset:3328
    ds_read_b128 v[132:135], v107 offset:16640
    ds_read_b128 v[48:51], v99 offset:3392
    ds_read_b128 v[136:139], v107 offset:16704
    ds_read_b128 v[52:55], v99 offset:6656
    ds_read_b128 v[140:143], v108 offset:16640
    ds_read_b128 v[56:59], v99 offset:6720
    ds_read_b128 v[144:147], v108 offset:16704
    ds_read_b128 v[60:63], v99 offset:10048
    ds_read_b128 v[148:151], v109 offset:16704
    ds_read_b128 v[64:67], v99 offset:10112
    ds_read_b128 v[152:155], v109 offset:16768
    ds_read_b128 v[68:71], v99 offset:13376
    ds_read_b128 v[156:159], v110 offset:16704
    ds_read_b128 v[72:75], v99 offset:13440
    ds_read_b128 v[160:163], v110 offset:16768
    s_waitcnt lgkmcnt(15)
    v_mfma_f32_16x16x32_bf16 v[164:167], v[40:43], v[200:203], 0
    v_mfma_f32_16x16x32_bf16 v[208:211], v[128:131], v[200:203], 0
    v_mfma_f32_16x16x32_bf16 v[184:187], v[40:43], v[204:207], 0
    v_mfma_f32_16x16x32_bf16 v[228:231], v[128:131], v[204:207], 0
    s_waitcnt lgkmcnt(14)
    v_mfma_f32_16x16x32_bf16 v[168:171], v[44:47], v[200:203], 0
    v_mfma_f32_16x16x32_bf16 v[212:215], v[132:135], v[200:203], 0
    v_mfma_f32_16x16x32_bf16 v[188:191], v[44:47], v[204:207], 0
    v_mfma_f32_16x16x32_bf16 v[232:235], v[132:135], v[204:207], 0
    s_waitcnt lgkmcnt(12)
    v_mfma_f32_16x16x32_bf16 v[168:171], v[48:51], v[248:251], v[168:171]
    v_mfma_f32_16x16x32_bf16 v[212:215], v[136:139], v[248:251], v[212:215]
    v_mfma_f32_16x16x32_bf16 v[188:191], v[48:51], v[252:255], v[188:191]
    v_mfma_f32_16x16x32_bf16 v[232:235], v[136:139], v[252:255], v[232:235]
    s_waitcnt lgkmcnt(10)
    v_mfma_f32_16x16x32_bf16 v[172:175], v[52:55], v[200:203], 0
    v_mfma_f32_16x16x32_bf16 v[216:219], v[140:143], v[200:203], 0
    v_mfma_f32_16x16x32_bf16 v[192:195], v[52:55], v[204:207], 0
    v_mfma_f32_16x16x32_bf16 v[236:239], v[140:143], v[204:207], 0
    s_waitcnt lgkmcnt(8)
    v_mfma_f32_16x16x32_bf16 v[172:175], v[56:59], v[248:251], v[172:175]
    v_mfma_f32_16x16x32_bf16 v[216:219], v[144:147], v[248:251], v[216:219]
    v_mfma_f32_16x16x32_bf16 v[192:195], v[56:59], v[252:255], v[192:195]
    v_mfma_f32_16x16x32_bf16 v[236:239], v[144:147], v[252:255], v[236:239]
    s_waitcnt lgkmcnt(6)
    v_mfma_f32_16x16x32_bf16 v[176:179], v[60:63], v[248:251], 0
    v_mfma_f32_16x16x32_bf16 v[220:223], v[148:151], v[248:251], 0
    v_mfma_f32_16x16x32_bf16 v[196:199], v[60:63], v[252:255], 0
    v_mfma_f32_16x16x32_bf16 v[240:243], v[148:151], v[252:255], 0
    s_waitcnt lgkmcnt(4)
    v_mfma_f32_16x16x32_bf16 v[176:179], v[64:67], v[112:115], v[176:179]
    v_mfma_f32_16x16x32_bf16 v[220:223], v[152:155], v[112:115], v[220:223]
    v_mfma_f32_16x16x32_bf16 v[196:199], v[64:67], v[80:83], v[196:199]
    v_mfma_f32_16x16x32_bf16 v[240:243], v[152:155], v[80:83], v[240:243]
    s_waitcnt lgkmcnt(2)
    v_mfma_f32_16x16x32_bf16 v[180:183], v[68:71], v[248:251], 0
    v_mfma_f32_16x16x32_bf16 v[224:227], v[156:159], v[248:251], 0
    v_mfma_f32_16x16x32_bf16 v[76:79], v[68:71], v[252:255], 0
    v_mfma_f32_16x16x32_bf16 v[244:247], v[156:159], v[252:255], 0
    s_waitcnt lgkmcnt(0)
    v_mfma_f32_16x16x32_bf16 v[180:183], v[72:75], v[112:115], v[180:183]
    v_mfma_f32_16x16x32_bf16 v[224:227], v[160:163], v[112:115], v[224:227]
    v_mfma_f32_16x16x32_bf16 v[76:79], v[72:75], v[80:83], v[76:79]
    v_mfma_f32_16x16x32_bf16 v[244:247], v[160:163], v[80:83], v[244:247]
    s_nop 7
    v_pk_add_f32 v[208:209], v[208:209], s[78:79] op_sel:[0,1] op_sel_hi:[1,1]
    v_pk_add_f32 v[210:211], v[210:211], s[78:79] op_sel:[0,1] op_sel_hi:[1,1]
    v_rcp_f32 v208, v208
    v_rcp_f32 v209, v209
    v_rcp_f32 v210, v210
    v_rcp_f32 v211, v211
    v_pk_add_f32 v[228:229], v[228:229], s[78:79] op_sel:[0,1] op_sel_hi:[1,1]
    v_pk_add_f32 v[230:231], v[230:231], s[78:79] op_sel:[0,1] op_sel_hi:[1,1]
    v_rcp_f32 v228, v228
    v_rcp_f32 v229, v229
    v_rcp_f32 v230, v230
    v_rcp_f32 v231, v231
    v_pk_mul_f32 v[164:165], v[164:165], v[208:209]
    v_pk_mul_f32 v[166:167], v[166:167], v[210:211]
    v_cvt_pk_bf16_f32 v164, v164, v165
    v_cvt_pk_bf16_f32 v165, v166, v167
    ds_write_b64 v100, v[164:165] offset:0
    v_pk_mul_f32 v[184:185], v[184:185], v[228:229]
    v_pk_mul_f32 v[186:187], v[186:187], v[230:231]
    v_cvt_pk_bf16_f32 v184, v184, v185
    v_cvt_pk_bf16_f32 v185, v186, v187
    ds_write_b64 v100, v[184:185] offset:128
    v_pk_add_f32 v[212:213], v[212:213], s[78:79] op_sel:[0,1] op_sel_hi:[1,1]
    v_pk_add_f32 v[214:215], v[214:215], s[78:79] op_sel:[0,1] op_sel_hi:[1,1]
    v_rcp_f32 v212, v212
    v_rcp_f32 v213, v213
    v_rcp_f32 v214, v214
    v_rcp_f32 v215, v215
    v_pk_add_f32 v[232:233], v[232:233], s[78:79] op_sel:[0,1] op_sel_hi:[1,1]
    v_pk_add_f32 v[234:235], v[234:235], s[78:79] op_sel:[0,1] op_sel_hi:[1,1]
    v_rcp_f32 v232, v232
    v_rcp_f32 v233, v233
    v_rcp_f32 v234, v234
    v_rcp_f32 v235, v235
    v_pk_mul_f32 v[168:169], v[168:169], v[212:213]
    v_pk_mul_f32 v[170:171], v[170:171], v[214:215]
    v_cvt_pk_bf16_f32 v168, v168, v169
    v_cvt_pk_bf16_f32 v169, v170, v171
    ds_write_b64 v100, v[168:169] offset:512
    v_pk_mul_f32 v[188:189], v[188:189], v[232:233]
    v_pk_mul_f32 v[190:191], v[190:191], v[234:235]
    v_cvt_pk_bf16_f32 v188, v188, v189
    v_cvt_pk_bf16_f32 v189, v190, v191
    ds_write_b64 v100, v[188:189] offset:640
    v_pk_add_f32 v[216:217], v[216:217], s[78:79] op_sel:[0,1] op_sel_hi:[1,1]
    v_pk_add_f32 v[218:219], v[218:219], s[78:79] op_sel:[0,1] op_sel_hi:[1,1]
    v_rcp_f32 v216, v216
    v_rcp_f32 v217, v217
    v_rcp_f32 v218, v218
    v_rcp_f32 v219, v219
    v_pk_add_f32 v[236:237], v[236:237], s[78:79] op_sel:[0,1] op_sel_hi:[1,1]
    v_pk_add_f32 v[238:239], v[238:239], s[78:79] op_sel:[0,1] op_sel_hi:[1,1]
    v_rcp_f32 v236, v236
    v_rcp_f32 v237, v237
    v_rcp_f32 v238, v238
    v_rcp_f32 v239, v239
    v_pk_mul_f32 v[172:173], v[172:173], v[216:217]
    v_pk_mul_f32 v[174:175], v[174:175], v[218:219]
    v_cvt_pk_bf16_f32 v172, v172, v173
    v_cvt_pk_bf16_f32 v173, v174, v175
    ds_write_b64 v100, v[172:173] offset:1024
    v_pk_mul_f32 v[192:193], v[192:193], v[236:237]
    v_pk_mul_f32 v[194:195], v[194:195], v[238:239]
    v_cvt_pk_bf16_f32 v192, v192, v193
    v_cvt_pk_bf16_f32 v193, v194, v195
    ds_write_b64 v100, v[192:193] offset:1152
    v_pk_add_f32 v[220:221], v[220:221], s[78:79] op_sel:[0,1] op_sel_hi:[1,1]
    v_pk_add_f32 v[222:223], v[222:223], s[78:79] op_sel:[0,1] op_sel_hi:[1,1]
    v_rcp_f32 v220, v220
    v_rcp_f32 v221, v221
    v_rcp_f32 v222, v222
    v_rcp_f32 v223, v223
    v_pk_add_f32 v[240:241], v[240:241], s[78:79] op_sel:[0,1] op_sel_hi:[1,1]
    v_pk_add_f32 v[242:243], v[242:243], s[78:79] op_sel:[0,1] op_sel_hi:[1,1]
    v_rcp_f32 v240, v240
    v_rcp_f32 v241, v241
    v_rcp_f32 v242, v242
    v_rcp_f32 v243, v243
    v_pk_mul_f32 v[176:177], v[176:177], v[220:221]
    v_pk_mul_f32 v[178:179], v[178:179], v[222:223]
    v_cvt_pk_bf16_f32 v176, v176, v177
    v_cvt_pk_bf16_f32 v177, v178, v179
    ds_write_b64 v100, v[176:177] offset:1536
    v_pk_mul_f32 v[196:197], v[196:197], v[240:241]
    v_pk_mul_f32 v[198:199], v[198:199], v[242:243]
    v_cvt_pk_bf16_f32 v196, v196, v197
    v_cvt_pk_bf16_f32 v197, v198, v199
    ds_write_b64 v100, v[196:197] offset:1664
    v_pk_add_f32 v[224:225], v[224:225], s[78:79] op_sel:[0,1] op_sel_hi:[1,1]
    v_pk_add_f32 v[226:227], v[226:227], s[78:79] op_sel:[0,1] op_sel_hi:[1,1]
    v_rcp_f32 v224, v224
    v_rcp_f32 v225, v225
    v_rcp_f32 v226, v226
    v_rcp_f32 v227, v227
    v_pk_add_f32 v[244:245], v[244:245], s[78:79] op_sel:[0,1] op_sel_hi:[1,1]
    v_pk_add_f32 v[246:247], v[246:247], s[78:79] op_sel:[0,1] op_sel_hi:[1,1]
    v_rcp_f32 v244, v244
    v_rcp_f32 v245, v245
    v_rcp_f32 v246, v246
    v_rcp_f32 v247, v247
    v_pk_mul_f32 v[180:181], v[180:181], v[224:225]
    v_pk_mul_f32 v[182:183], v[182:183], v[226:227]
    v_cvt_pk_bf16_f32 v180, v180, v181
    v_cvt_pk_bf16_f32 v181, v182, v183
    ds_write_b64 v100, v[180:181] offset:2048
    v_pk_mul_f32 v[76:77], v[76:77], v[244:245]
    v_pk_mul_f32 v[78:79], v[78:79], v[246:247]
    v_cvt_pk_bf16_f32 v76, v76, v77
    v_cvt_pk_bf16_f32 v77, v78, v79
    ds_write_b64 v100, v[76:77] offset:2176
    v_lshlrev_b32 v26, 4, v0
    v_add_u32 v27, 143360, v26
    s_waitcnt lgkmcnt(0)
    s_barrier
    ds_read_b128 v[40:43], v27 offset:0
    ds_read_b128 v[44:47], v27 offset:4096
    ds_read_b128 v[48:51], v27 offset:8192
    ds_read_b128 v[52:55], v27 offset:12288
    ds_read_b128 v[56:59], v27 offset:16384
    s_waitcnt lgkmcnt(4)
    buffer_store_dwordx4 v[40:43], v101, s[24:27], s89 offen sc1
    s_waitcnt lgkmcnt(3)
    buffer_store_dwordx4 v[44:47], v102, s[24:27], s89 offen sc1
    s_waitcnt lgkmcnt(2)
    buffer_store_dwordx4 v[48:51], v103, s[24:27], s89 offen sc1
    s_waitcnt lgkmcnt(1)
    buffer_store_dwordx4 v[52:55], v104, s[24:27], s89 offen sc1
    s_waitcnt lgkmcnt(0)
    buffer_store_dwordx4 v[56:59], v105, s[24:27], s89 offen sc1
    s_waitcnt vmcnt(0)
    s_barrier
    s_cmp_lg_u32 s35, 0
    s_cbranch_scc1 fl_30
    s_lshl_b32 s38, s32, 4
    s_add_u32 s38, s38, s33
    s_lshl_b32 s38, s38, 3
    s_add_u32 s38, s38, s34
    s_add_u32 s38, s38, 256
    s_lshl_b32 s38, s38, 7
    v_mov_b32 v124, s40
    buffer_store_dword v124, off, s[24:27], s38 sc1
fl_30:
    s_bfe_u32 s38, s75, 0x40000
    s_mul_i32 s38, s38, 20480
    s_add_u32 s38, s38, s54
    s_mov_b32 m0, s38
    s_nop 0
    buffer_load_dwordx4 v88, s[16:19], s97 offen offset:0 lds
    buffer_load_dwordx4 v89, s[16:19], s97 offen offset:1024 lds
    buffer_load_dwordx4 v90, s[16:19], s97 offen offset:2048 lds
    buffer_load_dwordx4 v91, s[16:19], s97 offen offset:3072 lds
    s_add_u32 m0, m0, 4096
    s_nop 0
    buffer_load_dwordx4 v92, s[16:19], s97 offen lds
    s_bfe_u32 s38, s75, 0x40004
    s_mul_i32 s38, s38, 20480
    s_add_u32 s38, s38, s54
    s_mov_b32 m0, s38
    s_nop 0
    buffer_load_dwordx4 v88, s[16:19], s98 offen offset:0 lds
    buffer_load_dwordx4 v89, s[16:19], s98 offen offset:1024 lds
    buffer_load_dwordx4 v90, s[16:19], s98 offen offset:2048 lds
    buffer_load_dwordx4 v91, s[16:19], s98 offen offset:3072 lds
    s_add_u32 m0, m0, 4096
    s_nop 0
    buffer_load_dwordx4 v92, s[16:19], s98 offen lds
    s_bfe_u32 s38, s75, 0x40008
    s_mul_i32 s38, s38, 20480
    s_add_u32 s38, s38, s54
    s_mov_b32 m0, s38
    s_nop 0
    buffer_load_dwordx4 v88, s[16:19], s99 offen offset:0 lds
    buffer_load_dwordx4 v89, s[16:19], s99 offen offset:1024 lds
    buffer_load_dwordx4 v90, s[16:19], s99 offen offset:2048 lds
    buffer_load_dwordx4 v91, s[16:19], s99 offen offset:3072 lds
    s_add_u32 m0, m0, 4096
    s_nop 0
    buffer_load_dwordx4 v92, s[16:19], s99 offen lds
    s_bfe_u32 s38, s75, 0x4000c
    s_mul_i32 s38, s38, 20480
    s_add_u32 s38, s38, s54
    s_mov_b32 m0, s38
    s_nop 0
    buffer_load_dwordx4 v88, s[16:19], s100 offen offset:0 lds
    buffer_load_dwordx4 v89, s[16:19], s100 offen offset:1024 lds
    buffer_load_dwordx4 v90, s[16:19], s100 offen offset:2048 lds
    buffer_load_dwordx4 v91, s[16:19], s100 offen offset:3072 lds
    s_add_u32 m0, m0, 4096
    s_nop 0
    buffer_load_dwordx4 v92, s[16:19], s100 offen lds
    s_bfe_u32 s38, s75, 0x40010
    s_mul_i32 s38, s38, 20480
    s_add_u32 s38, s38, s54
    s_mov_b32 m0, s38
    s_nop 0
    buffer_load_dwordx4 v88, s[16:19], s101 offen offset:0 lds
    buffer_load_dwordx4 v89, s[16:19], s101 offen offset:1024 lds
    buffer_load_dwordx4 v90, s[16:19], s101 offen offset:2048 lds
    buffer_load_dwordx4 v91, s[16:19], s101 offen offset:3072 lds
    s_add_u32 m0, m0, 4096
    s_nop 0
    buffer_load_dwordx4 v92, s[16:19], s101 offen lds
    s_branch L_tail
L_tail:
    s_mov_b32 s55, s72
    s_cmp_lg_u32 s35, 0
    s_cbranch_scc1 pp_31
    buffer_load_dword v121, v119, s[24:27], 0 offen sc1
pp_31:
    v_mov_b32 v125, v118
    v_add_u32 v126, 20480, v118
    s_lshl_b32 s38, s32, 4
    s_add_u32 s38, s38, s73
    s_mul_i32 s85, s38, 163840
    s_mul_i32 s38, s35, 40960
    s_add_u32 s85, s85, s38
    s_add_u32 s85, s85, 8650752
    s_mov_b32 s56, s55
    v_mul_u32_u24 v26, 160, v3
    v_lshl_add_u32 v26, v2, 3, v26
    s_add_u32 s38, s54, 143360
    v_add_u32 v26, s38, v26
    v_add_u32 v27, s38, v118
    v_add_u32 v33, 0, v1
    v_mul_u32_u24 v34, 6554, v33
    v_lshrrev_b32 v34, 16, v34
    v_mul_u32_u24 v34, 2400, v34
    v_lshl_add_u32 v28, v33, 4, v34
    v_add_u32 v33, 64, v1
    v_mul_u32_u24 v34, 6554, v33
    v_lshrrev_b32 v34, 16, v34
    v_mul_u32_u24 v34, 2400, v34
    v_lshl_add_u32 v29, v33, 4, v34
    v_add_u32 v33, 128, v1
    v_mul_u32_u24 v34, 6554, v33
    v_lshrrev_b32 v34, 16, v34
    v_mul_u32_u24 v34, 2400, v34
    v_lshl_add_u32 v30, v33, 4, v34
    v_add_u32 v33, 192, v1
    v_mul_u32_u24 v34, 6554, v33
    v_lshrrev_b32 v34, 16, v34
    v_mul_u32_u24 v34, 2400, v34
    v_lshl_add_u32 v31, v33, 4, v34
    v_add_u32 v33, 256, v1
    v_mul_u32_u24 v34, 6554, v33
    v_lshrrev_b32 v34, 16, v34
    v_mul_u32_u24 v34, 2400, v34
    v_lshl_add_u32 v32, v33, 4, v34
    s_lshl_b32 s38, s73, 7
    s_lshl_b32 s39, s35, 5
    s_add_u32 s38, s38, s39
    s_mul_i32 s38, s38, 2560
    s_mul_i32 s39, s32, 1280
    s_add_u32 s38, s38, s39
    s_mul_i32 s39, s74, 160
    s_add_u32 s88, s38, s39
    s_cmp_lg_u32 s35, 0
    s_cbranch_scc1 pollsk_34
    s_mov_b32 s60, 0
    s_waitcnt vmcnt(0)
    v_cmp_ne_u32 vcc, s40, v121
    s_nop 1
    s_cmp_eq_u64 vcc, 0
    s_cbranch_scc1 pollsk_34
    buffer_load_dword v121, v119, s[24:27], 0 offen sc1
    s_sleep 3
    buffer_load_dword v122, v119, s[24:27], 0 offen sc1
    s_sleep 3
    buffer_load_dword v123, v119, s[24:27], 0 offen sc1
poll_32:
    s_waitcnt vmcnt(2)
    v_cmp_ne_u32 vcc, s40, v121
    s_nop 1
    s_cmp_eq_u64 vcc, 0
    s_cbranch_scc1 polld_33
    buffer_load_dword v121, v119, s[24:27], 0 offen sc1
    s_waitcnt vmcnt(2)
    v_cmp_ne_u32 vcc, s40, v122
    s_nop 1
    s_cmp_eq_u64 vcc, 0
    s_cbranch_scc1 polld_33
    buffer_load_dword v122, v119, s[24:27], 0 offen sc1
    s_waitcnt vmcnt(2)
    v_cmp_ne_u32 vcc, s40, v123
    s_nop 1
    s_cmp_eq_u64 vcc, 0
    s_cbranch_scc1 polld_33
    buffer_load_dword v123, v119, s[24:27], 0 offen sc1
    s_add_u32 s60, s60, 1
    s_cmp_lt_u32 s60, 20000
    s_cbranch_scc1 poll_32
polld_33:
pollsk_34:
    s_waitcnt vmcnt(0) lgkmcnt(0)
    s_barrier
    s_lshl_b32 s36, s56, 10
    s_add_u32 s36, s36, s85
    buffer_load_dwordx4 a[0:3], v125, s[24:27], s36 offen sc1
    buffer_load_dwordx4 a[4:7], v126, s[24:27], s36 offen sc1
    s_add_u32 s56, s56, 1
    s_cmp_eq_u32 s56, 20
    s_cselect_b32 s56, 0, s56
    s_lshl_b32 s36, s56, 10
    s_add_u32 s36, s36, s85
    buffer_load_dwordx4 a[8:11], v125, s[24:27], s36 offen sc1
    buffer_load_dwordx4 a[12:15], v126, s[24:27], s36 offen sc1
    s_add_u32 s56, s56, 1
    s_cmp_eq_u32 s56, 20
    s_cselect_b32 s56, 0, s56
    s_lshl_b32 s36, s56, 10
    s_add_u32 s36, s36, s85
    buffer_load_dwordx4 a[16:19], v125, s[24:27], s36 offen sc1
    buffer_load_dwordx4 a[20:23], v126, s[24:27], s36 offen sc1
    s_add_u32 s56, s56, 1
    s_cmp_eq_u32 s56, 20
    s_cselect_b32 s56, 0, s56
    s_lshl_b32 s36, s56, 10
    s_add_u32 s36, s36, s85
    buffer_load_dwordx4 a[24:27], v125, s[24:27], s36 offen sc1
    buffer_load_dwordx4 a[28:31], v126, s[24:27], s36 offen sc1
    s_add_u32 s56, s56, 1
    s_cmp_eq_u32 s56, 20
    s_cselect_b32 s56, 0, s56
    s_lshl_b32 s36, s56, 10
    s_add_u32 s36, s36, s85
    buffer_load_dwordx4 a[32:35], v125, s[24:27], s36 offen sc1
    buffer_load_dwordx4 a[36:39], v126, s[24:27], s36 offen sc1
    s_add_u32 s56, s56, 1
    s_cmp_eq_u32 s56, 20
    s_cselect_b32 s56, 0, s56
    s_lshl_b32 s36, s56, 10
    s_add_u32 s36, s36, s85
    buffer_load_dwordx4 a[40:43], v125, s[24:27], s36 offen sc1
    buffer_load_dwordx4 a[44:47], v126, s[24:27], s36 offen sc1
    s_add_u32 s56, s56, 1
    s_cmp_eq_u32 s56, 20
    s_cselect_b32 s56, 0, s56
    ds_read_b64_tr_b16 a[160:161], v20 offset:0
    ds_read_b64_tr_b16 a[162:163], v20 offset:1280
    ds_read_b64_tr_b16 a[164:165], v20 offset:32
    ds_read_b64_tr_b16 a[166:167], v20 offset:1312
    ds_read_b64_tr_b16 a[168:169], v20 offset:64
    ds_read_b64_tr_b16 a[170:171], v20 offset:1344
    ds_read_b64_tr_b16 a[172:173], v20 offset:96
    ds_read_b64_tr_b16 a[174:175], v20 offset:1376
    ds_read_b64_tr_b16 a[176:177], v20 offset:128
    ds_read_b64_tr_b16 a[178:179], v20 offset:1408
    s_waitcnt vmcnt(10)
    s_waitcnt lgkmcnt(8)
    v_mfma_f32_16x16x32_bf16 v[208:211], a[160:163], a[0:3], 0
    ds_read_b64_tr_b16 a[180:181], v20 offset:5120
    s_lshl_b32 s36, s56, 10
    v_mfma_f32_16x16x32_bf16 v[212:215], a[160:163], a[4:7], 0
    ds_read_b64_tr_b16 a[182:183], v20 offset:6400
    s_add_u32 s36, s36, s85
    s_waitcnt lgkmcnt(8)
    v_mfma_f32_16x16x32_bf16 v[216:219], a[164:167], a[0:3], 0
    ds_read_b64_tr_b16 a[184:185], v20 offset:5152
    buffer_load_dwordx4 a[48:51], v125, s[24:27], s36 offen sc1
    v_mfma_f32_16x16x32_bf16 v[220:223], a[164:167], a[4:7], 0
    ds_read_b64_tr_b16 a[186:187], v20 offset:6432
    buffer_load_dwordx4 a[52:55], v126, s[24:27], s36 offen sc1
    s_waitcnt lgkmcnt(8)
    v_mfma_f32_16x16x32_bf16 v[224:227], a[168:171], a[0:3], 0
    ds_read_b64_tr_b16 a[188:189], v20 offset:5184
    v_mfma_f32_16x16x32_bf16 v[228:231], a[168:171], a[4:7], 0
    ds_read_b64_tr_b16 a[190:191], v20 offset:6464
    s_add_u32 s56, s56, 1
    s_waitcnt lgkmcnt(8)
    v_mfma_f32_16x16x32_bf16 v[232:235], a[172:175], a[0:3], 0
    ds_read_b64_tr_b16 a[192:193], v20 offset:5216
    s_cmp_eq_u32 s56, 20
    v_mfma_f32_16x16x32_bf16 v[236:239], a[172:175], a[4:7], 0
    ds_read_b64_tr_b16 a[194:195], v20 offset:6496
    s_cselect_b32 s56, 0, s56
    s_waitcnt lgkmcnt(8)
    v_mfma_f32_16x16x32_bf16 v[240:243], a[176:179], a[0:3], 0
    ds_read_b64_tr_b16 a[196:197], v20 offset:5248
    v_mfma_f32_16x16x32_bf16 v[244:247], a[176:179], a[4:7], 0
    ds_read_b64_tr_b16 a[198:199], v20 offset:6528
    s_waitcnt vmcnt(10)
    s_waitcnt lgkmcnt(8)
    v_mfma_f32_16x16x32_bf16 v[208:211], a[180:183], a[8:11], v[208:211]
    ds_read_b64_tr_b16 a[160:161], v20 offset:10240
    s_lshl_b32 s36, s56, 10
    v_mfma_f32_16x16x32_bf16 v[212:215], a[180:183], a[12:15], v[212:215]
    ds_read_b64_tr_b16 a[162:163], v20 offset:11520
    s_add_u32 s36, s36, s85
    s_waitcnt lgkmcnt(8)
    v_mfma_f32_16x16x32_bf16 v[216:219], a[184:187], a[8:11], v[216:219]
    ds_read_b64_tr_b16 a[164:165], v20 offset:10272
    buffer_load_dwordx4 a[56:59], v125, s[24:27], s36 offen sc1
    v_mfma_f32_16x16x32_bf16 v[220:223], a[184:187], a[12:15], v[220:223]
    ds_read_b64_tr_b16 a[166:167], v20 offset:11552
    buffer_load_dwordx4 a[60:63], v126, s[24:27], s36 offen sc1
    s_waitcnt lgkmcnt(8)
    v_mfma_f32_16x16x32_bf16 v[224:227], a[188:191], a[8:11], v[224:227]
    ds_read_b64_tr_b16 a[168:169], v20 offset:10304
    v_mfma_f32_16x16x32_bf16 v[228:231], a[188:191], a[12:15], v[228:231]
    ds_read_b64_tr_b16 a[170:171], v20 offset:11584
    s_add_u32 s56, s56, 1
    s_waitcnt lgkmcnt(8)
    v_mfma_f32_16x16x32_bf16 v[232:235], a[192:195], a[8:11], v[232:235]
    ds_read_b64_tr_b16 a[172:173], v20 offset:10336
    s_cmp_eq_u32 s56, 20
    v_mfma_f32_16x16x32_bf16 v[236:239], a[192:195], a[12:15], v[236:239]
    ds_read_b64_tr_b16 a[174:175], v20 offset:11616
    s_cselect_b32 s56, 0, s56
    s_waitcnt lgkmcnt(8)
    v_mfma_f32_16x16x32_bf16 v[240:243], a[196:199], a[8:11], v[240:243]
    ds_read_b64_tr_b16 a[176:177], v20 offset:10368
    v_mfma_f32_16x16x32_bf16 v[244:247], a[196:199], a[12:15], v[244:247]
    ds_read_b64_tr_b16 a[178:179], v20 offset:11648
    s_waitcnt vmcnt(10)
    s_waitcnt lgkmcnt(8)
    v_mfma_f32_16x16x32_bf16 v[208:211], a[160:163], a[16:19], v[208:211]
    ds_read_b64_tr_b16 a[180:181], v20 offset:15360
    s_lshl_b32 s36, s56, 10
    v_mfma_f32_16x16x32_bf16 v[212:215], a[160:163], a[20:23], v[212:215]
    ds_read_b64_tr_b16 a[182:183], v20 offset:16640
    s_add_u32 s36, s36, s85
    s_waitcnt lgkmcnt(8)
    v_mfma_f32_16x16x32_bf16 v[216:219], a[164:167], a[16:19], v[216:219]
    ds_read_b64_tr_b16 a[184:185], v20 offset:15392
    buffer_load_dwordx4 a[64:67], v125, s[24:27], s36 offen sc1
    v_mfma_f32_16x16x32_bf16 v[220:223], a[164:167], a[20:23], v[220:223]
    ds_read_b64_tr_b16 a[186:187], v20 offset:16672
    buffer_load_dwordx4 a[68:71], v126, s[24:27], s36 offen sc1
    s_waitcnt lgkmcnt(8)
    v_mfma_f32_16x16x32_bf16 v[224:227], a[168:171], a[16:19], v[224:227]
    ds_read_b64_tr_b16 a[188:189], v20 offset:15424
    v_mfma_f32_16x16x32_bf16 v[228:231], a[168:171], a[20:23], v[228:231]
    ds_read_b64_tr_b16 a[190:191], v20 offset:16704
    s_add_u32 s56, s56, 1
    s_waitcnt lgkmcnt(8)
    v_mfma_f32_16x16x32_bf16 v[232:235], a[172:175], a[16:19], v[232:235]
    ds_read_b64_tr_b16 a[192:193], v20 offset:15456
    s_cmp_eq_u32 s56, 20
    v_mfma_f32_16x16x32_bf16 v[236:239], a[172:175], a[20:23], v[236:239]
    ds_read_b64_tr_b16 a[194:195], v20 offset:16736
    s_cselect_b32 s56, 0, s56
    s_waitcnt lgkmcnt(8)
    v_mfma_f32_16x16x32_bf16 v[240:243], a[176:179], a[16:19], v[240:243]
    ds_read_b64_tr_b16 a[196:197], v20 offset:15488
    v_mfma_f32_16x16x32_bf16 v[244:247], a[176:179], a[20:23], v[244:247]
    ds_read_b64_tr_b16 a[198:199], v20 offset:16768
    s_waitcnt vmcnt(10)
    s_waitcnt lgkmcnt(8)
    v_mfma_f32_16x16x32_bf16 v[208:211], a[180:183], a[24:27], v[208:211]
    ds_read_b64_tr_b16 a[160:161], v20 offset:20480
    s_lshl_b32 s36, s56, 10
    v_mfma_f32_16x16x32_bf16 v[212:215], a[180:183], a[28:31], v[212:215]
    ds_read_b64_tr_b16 a[162:163], v20 offset:21760
    s_add_u32 s36, s36, s85
    s_waitcnt lgkmcnt(8)
    v_mfma_f32_16x16x32_bf16 v[216:219], a[184:187], a[24:27], v[216:219]
    ds_read_b64_tr_b16 a[164:165], v20 offset:20512
    buffer_load_dwordx4 a[72:75], v125, s[24:27], s36 offen sc1
    v_mfma_f32_16x16x32_bf16 v[220:223], a[184:187], a[28:31], v[220:223]
    ds_read_b64_tr_b16 a[166:167], v20 offset:21792
    buffer_load_dwordx4 a[76:79], v126, s[24:27], s36 offen sc1
    s_waitcnt lgkmcnt(8)
    v_mfma_f32_16x16x32_bf16 v[224:227], a[188:191], a[24:27], v[224:227]
    ds_read_b64_tr_b16 a[168:169], v20 offset:20544
    v_mfma_f32_16x16x32_bf16 v[228:231], a[188:191], a[28:31], v[228:231]
    ds_read_b64_tr_b16 a[170:171], v20 offset:21824
    s_add_u32 s56, s56, 1
    s_waitcnt lgkmcnt(8)
    v_mfma_f32_16x16x32_bf16 v[232:235], a[192:195], a[24:27], v[232:235]
    ds_read_b64_tr_b16 a[172:173], v20 offset:20576
    s_cmp_eq_u32 s56, 20
    v_mfma_f32_16x16x32_bf16 v[236:239], a[192:195], a[28:31], v[236:239]
    ds_read_b64_tr_b16 a[174:175], v20 offset:21856
    s_cselect_b32 s56, 0, s56
    s_waitcnt lgkmcnt(8)
    v_mfma_f32_16x16x32_bf16 v[240:243], a[196:199], a[24:27], v[240:243]
    ds_read_b64_tr_b16 a[176:177], v20 offset:20608
    v_mfma_f32_16x16x32_bf16 v[244:247], a[196:199], a[28:31], v[244:247]
    ds_read_b64_tr_b16 a[178:179], v20 offset:21888
    s_waitcnt vmcnt(10)
    s_waitcnt lgkmcnt(8)
    v_mfma_f32_16x16x32_bf16 v[208:211], a[160:163], a[32:35], v[208:211]
    ds_read_b64_tr_b16 a[180:181], v20 offset:25600
    s_lshl_b32 s36, s56, 10
    v_mfma_f32_16x16x32_bf16 v[212:215], a[160:163], a[36:39], v[212:215]
    ds_read_b64_tr_b16 a[182:183], v20 offset:26880
    s_add_u32 s36, s36, s85
    s_waitcnt lgkmcnt(8)
    v_mfma_f32_16x16x32_bf16 v[216:219], a[164:167], a[32:35], v[216:219]
    ds_read_b64_tr_b16 a[184:185], v20 offset:25632
    buffer_load_dwordx4 a[80:83], v125, s[24:27], s36 offen sc1
    v_mfma_f32_16x16x32_bf16 v[220:223], a[164:167], a[36:39], v[220:223]
    ds_read_b64_tr_b16 a[186:187], v20 offset:26912
    buffer_load_dwordx4 a[84:87], v126, s[24:27], s36 offen sc1
    s_waitcnt lgkmcnt(8)
    v_mfma_f32_16x16x32_bf16 v[224:227], a[168:171], a[32:35], v[224:227]
    ds_read_b64_tr_b16 a[188:189], v20 offset:25664
    v_mfma_f32_16x16x32_bf16 v[228:231], a[168:171], a[36:39], v[228:231]
    ds_read_b64_tr_b16 a[190:191], v20 offset:26944
    s_add_u32 s56, s56, 1
    s_waitcnt lgkmcnt(8)
    v_mfma_f32_16x16x32_bf16 v[232:235], a[172:175], a[32:35], v[232:235]
    ds_read_b64_tr_b16 a[192:193], v20 offset:25696
    s_cmp_eq_u32 s56, 20
    v_mfma_f32_16x16x32_bf16 v[236:239], a[172:175], a[36:39], v[236:239]
    ds_read_b64_tr_b16 a[194:195], v20 offset:26976
    s_cselect_b32 s56, 0, s56
    s_waitcnt lgkmcnt(8)
    v_mfma_f32_16x16x32_bf16 v[240:243], a[176:179], a[32:35], v[240:243]
    ds_read_b64_tr_b16 a[196:197], v20 offset:25728
    v_mfma_f32_16x16x32_bf16 v[244:247], a[176:179], a[36:39], v[244:247]
    ds_read_b64_tr_b16 a[198:199], v20 offset:27008
    s_waitcnt vmcnt(10)
    s_waitcnt lgkmcnt(8)
    v_mfma_f32_16x16x32_bf16 v[208:211], a[180:183], a[40:43], v[208:211]
    ds_read_b64_tr_b16 a[160:161], v20 offset:30720
    s_lshl_b32 s36, s56, 10
    v_mfma_f32_16x16x32_bf16 v[212:215], a[180:183], a[44:47], v[212:215]
    ds_read_b64_tr_b16 a[162:163], v20 offset:32000
    s_add_u32 s36, s36, s85
    s_waitcnt lgkmcnt(8)
    v_mfma_f32_16x16x32_bf16 v[216:219], a[184:187], a[40:43], v[216:219]
    ds_read_b64_tr_b16 a[164:165], v20 offset:30752
    buffer_load_dwordx4 a[88:91], v125, s[24:27], s36 offen sc1
    v_mfma_f32_16x16x32_bf16 v[220:223], a[184:187], a[44:47], v[220:223]
    ds_read_b64_tr_b16 a[166:167], v20 offset:32032
    buffer_load_dwordx4 a[92:95], v126, s[24:27], s36 offen sc1
    s_waitcnt lgkmcnt(8)
    v_mfma_f32_16x16x32_bf16 v[224:227], a[188:191], a[40:43], v[224:227]
    ds_read_b64_tr_b16 a[168:169], v20 offset:30784
    v_mfma_f32_16x16x32_bf16 v[228:231], a[188:191], a[44:47], v[228:231]
    ds_read_b64_tr_b16 a[170:171], v20 offset:32064
    s_add_u32 s56, s56, 1
    s_waitcnt lgkmcnt(8)
    v_mfma_f32_16x16x32_bf16 v[232:235], a[192:195], a[40:43], v[232:235]
    ds_read_b64_tr_b16 a[172:173], v20 offset:30816
    s_cmp_eq_u32 s56, 20
    v_mfma_f32_16x16x32_bf16 v[236:239], a[192:195], a[44:47], v[236:239]
    ds_read_b64_tr_b16 a[174:175], v20 offset:32096
    s_cselect_b32 s56, 0, s56
    s_waitcnt lgkmcnt(8)
    v_mfma_f32_16x16x32_bf16 v[240:243], a[196:199], a[40:43], v[240:243]
    ds_read_b64_tr_b16 a[176:177], v20 offset:30848
    v_mfma_f32_16x16x32_bf16 v[244:247], a[196:199], a[44:47], v[244:247]
    ds_read_b64_tr_b16 a[178:179], v20 offset:32128
    s_waitcnt vmcnt(10)
    s_waitcnt lgkmcnt(8)
    v_mfma_f32_16x16x32_bf16 v[208:211], a[160:163], a[48:51], v[208:211]
    ds_read_b64_tr_b16 a[180:181], v20 offset:35840
    s_lshl_b32 s36, s56, 10
    v_mfma_f32_16x16x32_bf16 v[212:215], a[160:163], a[52:55], v[212:215]
    ds_read_b64_tr_b16 a[182:183], v20 offset:37120
    s_add_u32 s36, s36, s85
    s_waitcnt lgkmcnt(8)
    v_mfma_f32_16x16x32_bf16 v[216:219], a[164:167], a[48:51], v[216:219]
    ds_read_b64_tr_b16 a[184:185], v20 offset:35872
    buffer_load_dwordx4 a[96:99], v125, s[24:27], s36 offen sc1
    v_mfma_f32_16x16x32_bf16 v[220:223], a[164:167], a[52:55], v[220:223]
    ds_read_b64_tr_b16 a[186:187], v20 offset:37152
    buffer_load_dwordx4 a[100:103], v126, s[24:27], s36 offen sc1
    s_waitcnt lgkmcnt(8)
    v_mfma_f32_16x16x32_bf16 v[224:227], a[168:171], a[48:51], v[224:227]
    ds_read_b64_tr_b16 a[188:189], v20 offset:35904
    v_mfma_f32_16x16x32_bf16 v[228:231], a[168:171], a[52:55], v[228:231]
    ds_read_b64_tr_b16 a[190:191], v20 offset:37184
    s_add_u32 s56, s56, 1
    s_waitcnt lgkmcnt(8)
    v_mfma_f32_16x16x32_bf16 v[232:235], a[172:175], a[48:51], v[232:235]
    ds_read_b64_tr_b16 a[192:193], v20 offset:35936
    s_cmp_eq_u32 s56, 20
    v_mfma_f32_16x16x32_bf16 v[236:239], a[172:175], a[52:55], v[236:239]
    ds_read_b64_tr_b16 a[194:195], v20 offset:37216
    s_cselect_b32 s56, 0, s56
    s_waitcnt lgkmcnt(8)
    v_mfma_f32_16x16x32_bf16 v[240:243], a[176:179], a[48:51], v[240:243]
    ds_read_b64_tr_b16 a[196:197], v20 offset:35968
    v_mfma_f32_16x16x32_bf16 v[244:247], a[176:179], a[52:55], v[244:247]
    ds_read_b64_tr_b16 a[198:199], v20 offset:37248
    s_waitcnt vmcnt(10)
    s_waitcnt lgkmcnt(8)
    v_mfma_f32_16x16x32_bf16 v[208:211], a[180:183], a[56:59], v[208:211]
    ds_read_b64_tr_b16 a[160:161], v20 offset:40960
    s_lshl_b32 s36, s56, 10
    v_mfma_f32_16x16x32_bf16 v[212:215], a[180:183], a[60:63], v[212:215]
    ds_read_b64_tr_b16 a[162:163], v20 offset:42240
    s_add_u32 s36, s36, s85
    s_waitcnt lgkmcnt(8)
    v_mfma_f32_16x16x32_bf16 v[216:219], a[184:187], a[56:59], v[216:219]
    ds_read_b64_tr_b16 a[164:165], v20 offset:40992
    buffer_load_dwordx4 a[104:107], v125, s[24:27], s36 offen sc1
    v_mfma_f32_16x16x32_bf16 v[220:223], a[184:187], a[60:63], v[220:223]
    ds_read_b64_tr_b16 a[166:167], v20 offset:42272
    buffer_load_dwordx4 a[108:111], v126, s[24:27], s36 offen sc1
    s_waitcnt lgkmcnt(8)
    v_mfma_f32_16x16x32_bf16 v[224:227], a[188:191], a[56:59], v[224:227]
    ds_read_b64_tr_b16 a[168:169], v20 offset:41024
    v_mfma_f32_16x16x32_bf16 v[228:231], a[188:191], a[60:63], v[228:231]
    ds_read_b64_tr_b16 a[170:171], v20 offset:42304
    s_add_u32 s56, s56, 1
    s_waitcnt lgkmcnt(8)
    v_mfma_f32_16x16x32_bf16 v[232:235], a[192:195], a[56:59], v[232:235]
    ds_read_b64_tr_b16 a[172:173], v20 offset:41056
    s_cmp_eq_u32 s56, 20
    v_mfma_f32_16x16x32_bf16 v[236:239], a[192:195], a[60:63], v[236:239]
    ds_read_b64_tr_b16 a[174:175], v20 offset:42336
    s_cselect_b32 s56, 0, s56
    s_waitcnt lgkmcnt(8)
    v_mfma_f32_16x16x32_bf16 v[240:243], a[196:199], a[56:59], v[240:243]
    ds_read_b64_tr_b16 a[176:177], v20 offset:41088
    v_mfma_f32_16x16x32_bf16 v[244:247], a[196:199], a[60:63], v[244:247]
    ds_read_b64_tr_b16 a[178:179], v20 offset:42368
    s_waitcnt vmcnt(10)
    s_waitcnt lgkmcnt(8)
    v_mfma_f32_16x16x32_bf16 v[208:211], a[160:163], a[64:67], v[208:211]
    ds_read_b64_tr_b16 a[180:181], v20 offset:46080
    s_lshl_b32 s36, s56, 10
    v_mfma_f32_16x16x32_bf16 v[212:215], a[160:163], a[68:71], v[212:215]
    ds_read_b64_tr_b16 a[182:183], v20 offset:47360
    s_add_u32 s36, s36, s85
    s_waitcnt lgkmcnt(8)
    v_mfma_f32_16x16x32_bf16 v[216:219], a[164:167], a[64:67], v[216:219]
    ds_read_b64_tr_b16 a[184:185], v20 offset:46112
    buffer_load_dwordx4 a[112:115], v125, s[24:27], s36 offen sc1
    v_mfma_f32_16x16x32_bf16 v[220:223], a[164:167], a[68:71], v[220:223]
    ds_read_b64_tr_b16 a[186:187], v20 offset:47392
    buffer_load_dwordx4 a[116:119], v126, s[24:27], s36 offen sc1
    s_waitcnt lgkmcnt(8)
    v_mfma_f32_16x16x32_bf16 v[224:227], a[168:171], a[64:67], v[224:227]
    ds_read_b64_tr_b16 a[188:189], v20 offset:46144
    v_mfma_f32_16x16x32_bf16 v[228:231], a[168:171], a[68:71], v[228:231]
    ds_read_b64_tr_b16 a[190:191], v20 offset:47424
    s_add_u32 s56, s56, 1
    s_waitcnt lgkmcnt(8)
    v_mfma_f32_16x16x32_bf16 v[232:235], a[172:175], a[64:67], v[232:235]
    ds_read_b64_tr_b16 a[192:193], v20 offset:46176
    s_cmp_eq_u32 s56, 20
    v_mfma_f32_16x16x32_bf16 v[236:239], a[172:175], a[68:71], v[236:239]
    ds_read_b64_tr_b16 a[194:195], v20 offset:47456
    s_cselect_b32 s56, 0, s56
    s_waitcnt lgkmcnt(8)
    v_mfma_f32_16x16x32_bf16 v[240:243], a[176:179], a[64:67], v[240:243]
    ds_read_b64_tr_b16 a[196:197], v20 offset:46208
    v_mfma_f32_16x16x32_bf16 v[244:247], a[176:179], a[68:71], v[244:247]
    ds_read_b64_tr_b16 a[198:199], v20 offset:47488
    s_waitcnt vmcnt(10)
    s_waitcnt lgkmcnt(8)
    v_mfma_f32_16x16x32_bf16 v[208:211], a[180:183], a[72:75], v[208:211]
    ds_read_b64_tr_b16 a[160:161], v20 offset:51200
    s_lshl_b32 s36, s56, 10
    v_mfma_f32_16x16x32_bf16 v[212:215], a[180:183], a[76:79], v[212:215]
    ds_read_b64_tr_b16 a[162:163], v20 offset:52480
    s_add_u32 s36, s36, s85
    s_waitcnt lgkmcnt(8)
    v_mfma_f32_16x16x32_bf16 v[216:219], a[184:187], a[72:75], v[216:219]
    ds_read_b64_tr_b16 a[164:165], v20 offset:51232
    buffer_load_dwordx4 a[120:123], v125, s[24:27], s36 offen sc1
    v_mfma_f32_16x16x32_bf16 v[220:223], a[184:187], a[76:79], v[220:223]
    ds_read_b64_tr_b16 a[166:167], v20 offset:52512
    buffer_load_dwordx4 a[124:127], v126, s[24:27], s36 offen sc1
    s_waitcnt lgkmcnt(8)
    v_mfma_f32_16x16x32_bf16 v[224:227], a[188:191], a[72:75], v[224:227]
    ds_read_b64_tr_b16 a[168:169], v20 offset:51264
    v_mfma_f32_16x16x32_bf16 v[228:231], a[188:191], a[76:79], v[228:231]
    ds_read_b64_tr_b16 a[170:171], v20 offset:52544
    s_add_u32 s56, s56, 1
    s_waitcnt lgkmcnt(8)
    v_mfma_f32_16x16x32_bf16 v[232:235], a[192:195], a[72:75], v[232:235]
    ds_read_b64_tr_b16 a[172:173], v20 offset:51296
    s_cmp_eq_u32 s56, 20
    v_mfma_f32_16x16x32_bf16 v[236:239], a[192:195], a[76:79], v[236:239]
    ds_read_b64_tr_b16 a[174:175], v20 offset:52576
    s_cselect_b32 s56, 0, s56
    s_waitcnt lgkmcnt(8)
    v_mfma_f32_16x16x32_bf16 v[240:243], a[196:199], a[72:75], v[240:243]
    ds_read_b64_tr_b16 a[176:177], v20 offset:51328
    v_mfma_f32_16x16x32_bf16 v[244:247], a[196:199], a[76:79], v[244:247]
    ds_read_b64_tr_b16 a[178:179], v20 offset:52608
    s_waitcnt vmcnt(10)
    s_waitcnt lgkmcnt(8)
    v_mfma_f32_16x16x32_bf16 v[208:211], a[160:163], a[80:83], v[208:211]
    ds_read_b64_tr_b16 a[180:181], v20 offset:56320
    s_lshl_b32 s36, s56, 10
    v_mfma_f32_16x16x32_bf16 v[212:215], a[160:163], a[84:87], v[212:215]
    ds_read_b64_tr_b16 a[182:183], v20 offset:57600
    s_add_u32 s36, s36, s85
    s_waitcnt lgkmcnt(8)
    v_mfma_f32_16x16x32_bf16 v[216:219], a[164:167], a[80:83], v[216:219]
    ds_read_b64_tr_b16 a[184:185], v20 offset:56352
    buffer_load_dwordx4 a[128:131], v125, s[24:27], s36 offen sc1
    v_mfma_f32_16x16x32_bf16 v[220:223], a[164:167], a[84:87], v[220:223]
    ds_read_b64_tr_b16 a[186:187], v20 offset:57632
    buffer_load_dwordx4 a[132:135], v126, s[24:27], s36 offen sc1
    s_waitcnt lgkmcnt(8)
    v_mfma_f32_16x16x32_bf16 v[224:227], a[168:171], a[80:83], v[224:227]
    ds_read_b64_tr_b16 a[188:189], v20 offset:56384
    v_mfma_f32_16x16x32_bf16 v[228:231], a[168:171], a[84:87], v[228:231]
    ds_read_b64_tr_b16 a[190:191], v20 offset:57664
    s_add_u32 s56, s56, 1
    s_waitcnt lgkmcnt(8)
    v_mfma_f32_16x16x32_bf16 v[232:235], a[172:175], a[80:83], v[232:235]
    ds_read_b64_tr_b16 a[192:193], v20 offset:56416
    s_cmp_eq_u32 s56, 20
    v_mfma_f32_16x16x32_bf16 v[236:239], a[172:175], a[84:87], v[236:239]
    ds_read_b64_tr_b16 a[194:195], v20 offset:57696
    s_cselect_b32 s56, 0, s56
    s_waitcnt lgkmcnt(8)
    v_mfma_f32_16x16x32_bf16 v[240:243], a[176:179], a[80:83], v[240:243]
    ds_read_b64_tr_b16 a[196:197], v20 offset:56448
    v_mfma_f32_16x16x32_bf16 v[244:247], a[176:179], a[84:87], v[244:247]
    ds_read_b64_tr_b16 a[198:199], v20 offset:57728
    s_waitcnt vmcnt(10)
    s_waitcnt lgkmcnt(8)
    v_mfma_f32_16x16x32_bf16 v[208:211], a[180:183], a[88:91], v[208:211]
    ds_read_b64_tr_b16 a[160:161], v21 offset:0
    s_lshl_b32 s36, s56, 10
    v_mfma_f32_16x16x32_bf16 v[212:215], a[180:183], a[92:95], v[212:215]
    ds_read_b64_tr_b16 a[162:163], v21 offset:1280
    s_add_u32 s36, s36, s85
    s_waitcnt lgkmcnt(8)
    v_mfma_f32_16x16x32_bf16 v[216:219], a[184:187], a[88:91], v[216:219]
    ds_read_b64_tr_b16 a[164:165], v21 offset:32
    buffer_load_dwordx4 a[136:139], v125, s[24:27], s36 offen sc1
    v_mfma_f32_16x16x32_bf16 v[220:223], a[184:187], a[92:95], v[220:223]
    ds_read_b64_tr_b16 a[166:167], v21 offset:1312
    buffer_load_dwordx4 a[140:143], v126, s[24:27], s36 offen sc1
    s_waitcnt lgkmcnt(8)
    v_mfma_f32_16x16x32_bf16 v[224:227], a[188:191], a[88:91], v[224:227]
    ds_read_b64_tr_b16 a[168:169], v21 offset:64
    v_mfma_f32_16x16x32_bf16 v[228:231], a[188:191], a[92:95], v[228:231]
    ds_read_b64_tr_b16 a[170:171], v21 offset:1344
    s_add_u32 s56, s56, 1
    s_waitcnt lgkmcnt(8)
    v_mfma_f32_16x16x32_bf16 v[232:235], a[192:195], a[88:91], v[232:235]
    ds_read_b64_tr_b16 a[172:173], v21 offset:96
    s_cmp_eq_u32 s56, 20
    v_mfma_f32_16x16x32_bf16 v[236:239], a[192:195], a[92:95], v[236:239]
    ds_read_b64_tr_b16 a[174:175], v21 offset:1376
    s_cselect_b32 s56, 0, s56
    s_waitcnt lgkmcnt(8)
    v_mfma_f32_16x16x32_bf16 v[240:243], a[196:199], a[88:91], v[240:243]
    ds_read_b64_tr_b16 a[176:177], v21 offset:128
    v_mfma_f32_16x16x32_bf16 v[244:247], a[196:199], a[92:95], v[244:247]
    ds_read_b64_tr_b16 a[178:179], v21 offset:1408
    s_waitcnt vmcnt(10)
    s_waitcnt lgkmcnt(8)
    v_mfma_f32_16x16x32_bf16 v[208:211], a[160:163], a[96:99], v[208:211]
    ds_read_b64_tr_b16 a[180:181], v21 offset:5120
    s_lshl_b32 s36, s56, 10
    v_mfma_f32_16x16x32_bf16 v[212:215], a[160:163], a[100:103], v[212:215]
    ds_read_b64_tr_b16 a[182:183], v21 offset:6400
    s_add_u32 s36, s36, s85
    s_waitcnt lgkmcnt(8)
    v_mfma_f32_16x16x32_bf16 v[216:219], a[164:167], a[96:99], v[216:219]
    ds_read_b64_tr_b16 a[184:185], v21 offset:5152
    buffer_load_dwordx4 a[144:147], v125, s[24:27], s36 offen sc1
    v_mfma_f32_16x16x32_bf16 v[220:223], a[164:167], a[100:103], v[220:223]
    ds_read_b64_tr_b16 a[186:187], v21 offset:6432
    buffer_load_dwordx4 a[148:151], v126, s[24:27], s36 offen sc1
    s_waitcnt lgkmcnt(8)
    v_mfma_f32_16x16x32_bf16 v[224:227], a[168:171], a[96:99], v[224:227]
    ds_read_b64_tr_b16 a[188:189], v21 offset:5184
    v_mfma_f32_16x16x32_bf16 v[228:231], a[168:171], a[100:103], v[228:231]
    ds_read_b64_tr_b16 a[190:191], v21 offset:6464
    s_add_u32 s56, s56, 1
    s_waitcnt lgkmcnt(8)
    v_mfma_f32_16x16x32_bf16 v[232:235], a[172:175], a[96:99], v[232:235]
    ds_read_b64_tr_b16 a[192:193], v21 offset:5216
    s_cmp_eq_u32 s56, 20
    v_mfma_f32_16x16x32_bf16 v[236:239], a[172:175], a[100:103], v[236:239]
    ds_read_b64_tr_b16 a[194:195], v21 offset:6496
    s_cselect_b32 s56, 0, s56
    s_waitcnt lgkmcnt(8)
    v_mfma_f32_16x16x32_bf16 v[240:243], a[176:179], a[96:99], v[240:243]
    ds_read_b64_tr_b16 a[196:197], v21 offset:5248
    v_mfma_f32_16x16x32_bf16 v[244:247], a[176:179], a[100:103], v[244:247]
    ds_read_b64_tr_b16 a[198:199], v21 offset:6528
    s_waitcnt vmcnt(10)
    s_waitcnt lgkmcnt(8)
    v_mfma_f32_16x16x32_bf16 v[208:211], a[180:183], a[104:107], v[208:211]
    ds_read_b64_tr_b16 a[160:161], v21 offset:10240
    s_lshl_b32 s36, s56, 10
    v_mfma_f32_16x16x32_bf16 v[212:215], a[180:183], a[108:111], v[212:215]
    ds_read_b64_tr_b16 a[162:163], v21 offset:11520
    s_add_u32 s36, s36, s85
    s_waitcnt lgkmcnt(8)
    v_mfma_f32_16x16x32_bf16 v[216:219], a[184:187], a[104:107], v[216:219]
    ds_read_b64_tr_b16 a[164:165], v21 offset:10272
    buffer_load_dwordx4 a[152:155], v125, s[24:27], s36 offen sc1
    v_mfma_f32_16x16x32_bf16 v[220:223], a[184:187], a[108:111], v[220:223]
    ds_read_b64_tr_b16 a[166:167], v21 offset:11552
    buffer_load_dwordx4 a[156:159], v126, s[24:27], s36 offen sc1
    s_waitcnt lgkmcnt(8)
    v_mfma_f32_16x16x32_bf16 v[224:227], a[188:191], a[104:107], v[224:227]
    ds_read_b64_tr_b16 a[168:169], v21 offset:10304
    v_mfma_f32_16x16x32_bf16 v[228:231], a[188:191], a[108:111], v[228:231]
    ds_read_b64_tr_b16 a[170:171], v21 offset:11584
    s_add_u32 s56, s56, 1
    s_waitcnt lgkmcnt(8)
    v_mfma_f32_16x16x32_bf16 v[232:235], a[192:195], a[104:107], v[232:235]
    ds_read_b64_tr_b16 a[172:173], v21 offset:10336
    s_cmp_eq_u32 s56, 20
    v_mfma_f32_16x16x32_bf16 v[236:239], a[192:195], a[108:111], v[236:239]
    ds_read_b64_tr_b16 a[174:175], v21 offset:11616
    s_cselect_b32 s56, 0, s56
    s_waitcnt lgkmcnt(8)
    v_mfma_f32_16x16x32_bf16 v[240:243], a[196:199], a[104:107], v[240:243]
    ds_read_b64_tr_b16 a[176:177], v21 offset:10368
    v_mfma_f32_16x16x32_bf16 v[244:247], a[196:199], a[108:111], v[244:247]
    ds_read_b64_tr_b16 a[178:179], v21 offset:11648
    s_waitcnt vmcnt(10)
    s_waitcnt lgkmcnt(8)
    v_mfma_f32_16x16x32_bf16 v[208:211], a[160:163], a[112:115], v[208:211]
    ds_read_b64_tr_b16 a[180:181], v21 offset:15360
    v_mfma_f32_16x16x32_bf16 v[212:215], a[160:163], a[116:119], v[212:215]
    ds_read_b64_tr_b16 a[182:183], v21 offset:16640
    s_waitcnt lgkmcnt(8)
    v_mfma_f32_16x16x32_bf16 v[216:219], a[164:167], a[112:115], v[216:219]
    ds_read_b64_tr_b16 a[184:185], v21 offset:15392
    v_mfma_f32_16x16x32_bf16 v[220:223], a[164:167], a[116:119], v[220:223]
    ds_read_b64_tr_b16 a[186:187], v21 offset:16672
    s_waitcnt lgkmcnt(8)
    v_mfma_f32_16x16x32_bf16 v[224:227], a[168:171], a[112:115], v[224:227]
    ds_read_b64_tr_b16 a[188:189], v21 offset:15424
    v_mfma_f32_16x16x32_bf16 v[228:231], a[168:171], a[116:119], v[228:231]
    ds_read_b64_tr_b16 a[190:191], v21 offset:16704
    s_waitcnt lgkmcnt(8)
    v_mfma_f32_16x16x32_bf16 v[232:235], a[172:175], a[112:115], v[232:235]
    ds_read_b64_tr_b16 a[192:193], v21 offset:15456
    v_mfma_f32_16x16x32_bf16 v[236:239], a[172:175], a[116:119], v[236:239]
    ds_read_b64_tr_b16 a[194:195], v21 offset:16736
    s_waitcnt lgkmcnt(8)
    v_mfma_f32_16x16x32_bf16 v[240:243], a[176:179], a[112:115], v[240:243]
    ds_read_b64_tr_b16 a[196:197], v21 offset:15488
    v_mfma_f32_16x16x32_bf16 v[244:247], a[176:179], a[116:119], v[244:247]
    ds_read_b64_tr_b16 a[198:199], v21 offset:16768
    s_waitcnt vmcnt(8)
    s_waitcnt lgkmcnt(8)
    v_mfma_f32_16x16x32_bf16 v[208:211], a[180:183], a[120:123], v[208:211]
    ds_read_b64_tr_b16 a[160:161], v21 offset:20480
    v_mfma_f32_16x16x32_bf16 v[212:215], a[180:183], a[124:127], v[212:215]
    ds_read_b64_tr_b16 a[162:163], v21 offset:21760
    s_waitcnt lgkmcnt(8)
    v_mfma_f32_16x16x32_bf16 v[216:219], a[184:187], a[120:123], v[216:219]
    ds_read_b64_tr_b16 a[164:165], v21 offset:20512
    v_mfma_f32_16x16x32_bf16 v[220:223], a[184:187], a[124:127], v[220:223]
    ds_read_b64_tr_b16 a[166:167], v21 offset:21792
    s_waitcnt lgkmcnt(8)
    v_mfma_f32_16x16x32_bf16 v[224:227], a[188:191], a[120:123], v[224:227]
    ds_read_b64_tr_b16 a[168:169], v21 offset:20544
    v_mfma_f32_16x16x32_bf16 v[228:231], a[188:191], a[124:127], v[228:231]
    ds_read_b64_tr_b16 a[170:171], v21 offset:21824
    s_waitcnt lgkmcnt(8)
    v_mfma_f32_16x16x32_bf16 v[232:235], a[192:195], a[120:123], v[232:235]
    ds_read_b64_tr_b16 a[172:173], v21 offset:20576
    v_mfma_f32_16x16x32_bf16 v[236:239], a[192:195], a[124:127], v[236:239]
    ds_read_b64_tr_b16 a[174:175], v21 offset:21856
    s_waitcnt lgkmcnt(8)
    v_mfma_f32_16x16x32_bf16 v[240:243], a[196:199], a[120:123], v[240:243]
    ds_read_b64_tr_b16 a[176:177], v21 offset:20608
    v_mfma_f32_16x16x32_bf16 v[244:247], a[196:199], a[124:127], v[244:247]
    ds_read_b64_tr_b16 a[178:179], v21 offset:21888
    s_waitcnt vmcnt(6)
    s_waitcnt lgkmcnt(8)
    v_mfma_f32_16x16x32_bf16 v[208:211], a[160:163], a[128:131], v[208:211]
    ds_read_b64_tr_b16 a[180:181], v21 offset:25600
    v_mfma_f32_16x16x32_bf16 v[212:215], a[160:163], a[132:135], v[212:215]
    ds_read_b64_tr_b16 a[182:183], v21 offset:26880
    s_waitcnt lgkmcnt(8)
    v_mfma_f32_16x16x32_bf16 v[216:219], a[164:167], a[128:131], v[216:219]
    ds_read_b64_tr_b16 a[184:185], v21 offset:25632
    v_mfma_f32_16x16x32_bf16 v[220:223], a[164:167], a[132:135], v[220:223]
    ds_read_b64_tr_b16 a[186:187], v21 offset:26912
    s_waitcnt lgkmcnt(8)
    v_mfma_f32_16x16x32_bf16 v[224:227], a[168:171], a[128:131], v[224:227]
    ds_read_b64_tr_b16 a[188:189], v21 offset:25664
    v_mfma_f32_16x16x32_bf16 v[228:231], a[168:171], a[132:135], v[228:231]
    ds_read_b64_tr_b16 a[190:191], v21 offset:26944
    s_waitcnt lgkmcnt(8)
    v_mfma_f32_16x16x32_bf16 v[232:235], a[172:175], a[128:131], v[232:235]
    ds_read_b64_tr_b16 a[192:193], v21 offset:25696
    v_mfma_f32_16x16x32_bf16 v[236:239], a[172:175], a[132:135], v[236:239]
    ds_read_b64_tr_b16 a[194:195], v21 offset:26976
    s_waitcnt lgkmcnt(8)
    v_mfma_f32_16x16x32_bf16 v[240:243], a[176:179], a[128:131], v[240:243]
    ds_read_b64_tr_b16 a[196:197], v21 offset:25728
    v_mfma_f32_16x16x32_bf16 v[244:247], a[176:179], a[132:135], v[244:247]
    ds_read_b64_tr_b16 a[198:199], v21 offset:27008
    s_waitcnt vmcnt(4)
    s_waitcnt lgkmcnt(8)
    v_mfma_f32_16x16x32_bf16 v[208:211], a[180:183], a[136:139], v[208:211]
    ds_read_b64_tr_b16 a[160:161], v21 offset:30720
    v_mfma_f32_16x16x32_bf16 v[212:215], a[180:183], a[140:143], v[212:215]
    ds_read_b64_tr_b16 a[162:163], v21 offset:32000
    s_waitcnt lgkmcnt(8)
    v_mfma_f32_16x16x32_bf16 v[216:219], a[184:187], a[136:139], v[216:219]
    ds_read_b64_tr_b16 a[164:165], v21 offset:30752
    v_mfma_f32_16x16x32_bf16 v[220:223], a[184:187], a[140:143], v[220:223]
    ds_read_b64_tr_b16 a[166:167], v21 offset:32032
    s_waitcnt lgkmcnt(8)
    v_mfma_f32_16x16x32_bf16 v[224:227], a[188:191], a[136:139], v[224:227]
    ds_read_b64_tr_b16 a[168:169], v21 offset:30784
    v_mfma_f32_16x16x32_bf16 v[228:231], a[188:191], a[140:143], v[228:231]
    ds_read_b64_tr_b16 a[170:171], v21 offset:32064
    s_waitcnt lgkmcnt(8)
    v_mfma_f32_16x16x32_bf16 v[232:235], a[192:195], a[136:139], v[232:235]
    ds_read_b64_tr_b16 a[172:173], v21 offset:30816
    v_mfma_f32_16x16x32_bf16 v[236:239], a[192:195], a[140:143], v[236:239]
    ds_read_b64_tr_b16 a[174:175], v21 offset:32096
    s_waitcnt lgkmcnt(8)
    v_mfma_f32_16x16x32_bf16 v[240:243], a[196:199], a[136:139], v[240:243]
    ds_read_b64_tr_b16 a[176:177], v21 offset:30848
    v_mfma_f32_16x16x32_bf16 v[244:247], a[196:199], a[140:143], v[244:247]
    ds_read_b64_tr_b16 a[178:179], v21 offset:32128
    s_waitcnt vmcnt(2)
    s_waitcnt lgkmcnt(8)
    v_mfma_f32_16x16x32_bf16 v[208:211], a[160:163], a[144:147], v[208:211]
    ds_read_b64_tr_b16 a[180:181], v21 offset:35840
    v_mfma_f32_16x16x32_bf16 v[212:215], a[160:163], a[148:151], v[212:215]
    ds_read_b64_tr_b16 a[182:183], v21 offset:37120
    s_waitcnt lgkmcnt(8)
    v_mfma_f32_16x16x32_bf16 v[216:219], a[164:167], a[144:147], v[216:219]
    ds_read_b64_tr_b16 a[184:185], v21 offset:35872
    v_mfma_f32_16x16x32_bf16 v[220:223], a[164:167], a[148:151], v[220:223]
    ds_read_b64_tr_b16 a[186:187], v21 offset:37152
    s_waitcnt lgkmcnt(8)
    v_mfma_f32_16x16x32_bf16 v[224:227], a[168:171], a[144:147], v[224:227]
    ds_read_b64_tr_b16 a[188:189], v21 offset:35904
    v_mfma_f32_16x16x32_bf16 v[228:231], a[168:171], a[148:151], v[228:231]
    ds_read_b64_tr_b16 a[190:191], v21 offset:37184
    s_waitcnt lgkmcnt(8)
    v_mfma_f32_16x16x32_bf16 v[232:235], a[172:175], a[144:147], v[232:235]
    ds_read_b64_tr_b16 a[192:193], v21 offset:35936
    v_mfma_f32_16x16x32_bf16 v[236:239], a[172:175], a[148:151], v[236:239]
    ds_read_b64_tr_b16 a[194:195], v21 offset:37216
    s_waitcnt lgkmcnt(8)
    v_mfma_f32_16x16x32_bf16 v[240:243], a[176:179], a[144:147], v[240:243]
    ds_read_b64_tr_b16 a[196:197], v21 offset:35968
    v_mfma_f32_16x16x32_bf16 v[244:247], a[176:179], a[148:151], v[244:247]
    ds_read_b64_tr_b16 a[198:199], v21 offset:37248
    s_waitcnt vmcnt(0)
    s_waitcnt lgkmcnt(8)
    v_mfma_f32_16x16x32_bf16 v[208:211], a[180:183], a[152:155], v[208:211]
    v_mfma_f32_16x16x32_bf16 v[212:215], a[180:183], a[156:159], v[212:215]
    s_waitcnt lgkmcnt(6)
    v_mfma_f32_16x16x32_bf16 v[216:219], a[184:187], a[152:155], v[216:219]
    v_mfma_f32_16x16x32_bf16 v[220:223], a[184:187], a[156:159], v[220:223]
    s_waitcnt lgkmcnt(4)
    v_mfma_f32_16x16x32_bf16 v[224:227], a[188:191], a[152:155], v[224:227]
    v_mfma_f32_16x16x32_bf16 v[228:231], a[188:191], a[156:159], v[228:231]
    s_waitcnt lgkmcnt(2)
    v_mfma_f32_16x16x32_bf16 v[232:235], a[192:195], a[152:155], v[232:235]
    v_mfma_f32_16x16x32_bf16 v[236:239], a[192:195], a[156:159], v[236:239]
    s_waitcnt lgkmcnt(0)
    v_mfma_f32_16x16x32_bf16 v[240:243], a[196:199], a[152:155], v[240:243]
    v_mfma_f32_16x16x32_bf16 v[244:247], a[196:199], a[156:159], v[244:247]
    s_nop 7
    v_cvt_pk_bf16_f32 v40, v208, v209
    v_cvt_pk_bf16_f32 v41, v210, v211
    ds_write_b64 v26, v[40:41] offset:0
    v_cvt_pk_bf16_f32 v42, v216, v217
    v_cvt_pk_bf16_f32 v43, v218, v219
    ds_write_b64 v26, v[42:43] offset:32
    v_cvt_pk_bf16_f32 v44, v224, v225
    v_cvt_pk_bf16_f32 v45, v226, v227
    ds_write_b64 v26, v[44:45] offset:64
    v_cvt_pk_bf16_f32 v46, v232, v233
    v_cvt_pk_bf16_f32 v47, v234, v235
    ds_write_b64 v26, v[46:47] offset:96
    v_cvt_pk_bf16_f32 v48, v240, v241
    v_cvt_pk_bf16_f32 v49, v242, v243
    ds_write_b64 v26, v[48:49] offset:128
    v_cvt_pk_bf16_f32 v50, v212, v213
    v_cvt_pk_bf16_f32 v51, v214, v215
    ds_write_b64 v26, v[50:51] offset:2560
    v_cvt_pk_bf16_f32 v52, v220, v221
    v_cvt_pk_bf16_f32 v53, v222, v223
    ds_write_b64 v26, v[52:53] offset:2592
    v_cvt_pk_bf16_f32 v54, v228, v229
    v_cvt_pk_bf16_f32 v55, v230, v231
    ds_write_b64 v26, v[54:55] offset:2624
    v_cvt_pk_bf16_f32 v56, v236, v237
    v_cvt_pk_bf16_f32 v57, v238, v239
    ds_write_b64 v26, v[56:57] offset:2656
    v_cvt_pk_bf16_f32 v58, v244, v245
    v_cvt_pk_bf16_f32 v59, v246, v247
    ds_write_b64 v26, v[58:59] offset:2688
    s_waitcnt lgkmcnt(0)
    ds_read_b128 v[60:63], v27 offset:0
    ds_read_b128 v[64:67], v27 offset:1024
    ds_read_b128 v[68:71], v27 offset:2048
    ds_read_b128 v[72:75], v27 offset:3072
    ds_read_b128 v[76:79], v27 offset:4096
    s_waitcnt lgkmcnt(4)
    buffer_store_dwordx4 v[60:63], v28, s[20:23], s88 offen nt
    s_waitcnt lgkmcnt(3)
    buffer_store_dwordx4 v[64:67], v29, s[20:23], s88 offen nt
    s_waitcnt lgkmcnt(2)
    buffer_store_dwordx4 v[68:71], v30, s[20:23], s88 offen nt
    s_waitcnt lgkmcnt(1)
    buffer_store_dwordx4 v[72:75], v31, s[20:23], s88 offen nt
    s_waitcnt lgkmcnt(0)
    buffer_store_dwordx4 v[76:79], v32, s[20:23], s88 offen nt
    s_branch L_end
L_slow:
    s_nop 7
    v_lshlrev_b32 v100, 2, v116
    v_sub_u32 v100, v100, v117
    v_mov_b32 v101, 0xf149f2ca
    v_mov_b32 v96, v101
    v_mov_b32 v97, v101
    v_mov_b32 v98, v101
    v_mov_b32 v99, v101
    v_mov_b32 v168, 0
    v_mov_b32 v169, 0
    v_mov_b32 v170, 0
    v_mov_b32 v171, 0
    v_mov_b32 v172, 0
    v_mov_b32 v173, 0
    v_mov_b32 v174, 0
    v_mov_b32 v175, 0
    v_mov_b32 v176, 0
    v_mov_b32 v177, 0
    v_mov_b32 v178, 0
    v_mov_b32 v179, 0
    v_mov_b32 v180, 0
    v_mov_b32 v181, 0
    v_mov_b32 v182, 0
    v_mov_b32 v183, 0
    v_mov_b32 v184, 0
    v_mov_b32 v185, 0
    v_mov_b32 v186, 0
    v_mov_b32 v187, 0
    v_mov_b32 v188, 0
    v_mov_b32 v189, 0
    v_mov_b32 v190, 0
    v_mov_b32 v191, 0
    v_mov_b32 v192, 0
    v_mov_b32 v193, 0
    v_mov_b32 v194, 0
    v_mov_b32 v195, 0
    v_mov_b32 v196, 0
    v_mov_b32 v197, 0
    v_mov_b32 v198, 0
    v_mov_b32 v199, 0
    v_mov_b32 v200, 0
    v_mov_b32 v201, 0
    v_mov_b32 v202, 0
    v_mov_b32 v203, 0
    v_mov_b32 v204, 0
    v_mov_b32 v205, 0
    v_mov_b32 v206, 0
    v_mov_b32 v207, 0
    v_mov_b32 v208, 0
    v_mov_b32 v209, 0
    v_mov_b32 v210, 0
    v_mov_b32 v211, 0
    v_mov_b32 v212, 0
    v_mov_b32 v213, 0
    v_mov_b32 v214, 0
    v_mov_b32 v215, 0
    v_mov_b32 v216, 0
    v_mov_b32 v217, 0
    v_mov_b32 v218, 0
    v_mov_b32 v219, 0
    v_mov_b32 v220, 0
    v_mov_b32 v221, 0
    v_mov_b32 v222, 0
    v_mov_b32 v223, 0
    v_mov_b32 v224, 0
    v_mov_b32 v225, 0
    v_mov_b32 v226, 0
    v_mov_b32 v227, 0
    v_mov_b32 v228, 0
    v_mov_b32 v229, 0
    v_mov_b32 v230, 0
    v_mov_b32 v231, 0
    s_min_u32 s42, s33, 2
    s_lshl_b32 s42, s42, 2
    s_sub_u32 s42, 8, s42
    s_mov_b32 s43, 0
slm_35:
    s_mov_b32 s61, 0
slb_36:
    s_mul_i32 s46, s61, 41216
    s_lshl_b32 s44, s61, 2
    s_add_u32 s44, s44, 0
    s_cmp_lt_u32 s44, s42
    s_cbranch_scc1 slt_38
    v_add_u32 v102, s46, v112
    v_add_u32 v103, s46, v80
    v_add_u32 v104, s46, v81
    ds_read_b64_tr_b16 a[100:101], v102
    ds_read_b64_tr_b16 a[102:103], v102 offset:1024
    ds_read_b64_tr_b16 a[104:105], v102 offset:4096
    ds_read_b128 a[124:127], v103
    ds_read_b128 a[128:131], v104
    s_waitcnt lgkmcnt(0)
    s_sub_u32 s45, s44, 0
    s_cmp_gt_u32 s45, 8
    s_cbranch_scc1 slk_39
    v_mfma_f32_32x32x16_bf16 v[40:55], a[100:103], v[136:139], 0
    v_mfma_f32_32x32x16_bf16 v[40:55], a[104:107], v[140:143], v[40:55]
    s_nop 15
    s_cmp_eq_u32 s45, 0
    s_cbranch_scc0 sln_41
    v_cmp_lt_i32 vcc, 0, v100
    s_nop 1
    v_cndmask_b32 v40, v101, v40, vcc
    v_cmp_lt_i32 vcc, -1, v100
    s_nop 1
    v_cndmask_b32 v41, v101, v41, vcc
    v_cmp_lt_i32 vcc, -2, v100
    s_nop 1
    v_cndmask_b32 v42, v101, v42, vcc
    v_cmp_lt_i32 vcc, -3, v100
    s_nop 1
    v_cndmask_b32 v43, v101, v43, vcc
    v_cmp_lt_i32 vcc, -8, v100
    s_nop 1
    v_cndmask_b32 v44, v101, v44, vcc
    v_cmp_lt_i32 vcc, -9, v100
    s_nop 1
    v_cndmask_b32 v45, v101, v45, vcc
    v_cmp_lt_i32 vcc, -10, v100
    s_nop 1
    v_cndmask_b32 v46, v101, v46, vcc
    v_cmp_lt_i32 vcc, -11, v100
    s_nop 1
    v_cndmask_b32 v47, v101, v47, vcc
    v_cmp_lt_i32 vcc, -16, v100
    s_nop 1
    v_cndmask_b32 v48, v101, v48, vcc
    v_cmp_lt_i32 vcc, -17, v100
    s_nop 1
    v_cndmask_b32 v49, v101, v49, vcc
    v_cmp_lt_i32 vcc, -18, v100
    s_nop 1
    v_cndmask_b32 v50, v101, v50, vcc
    v_cmp_lt_i32 vcc, -19, v100
    s_nop 1
    v_cndmask_b32 v51, v101, v51, vcc
    v_cmp_lt_i32 vcc, -24, v100
    s_nop 1
    v_cndmask_b32 v52, v101, v52, vcc
    v_cmp_lt_i32 vcc, -25, v100
    s_nop 1
    v_cndmask_b32 v53, v101, v53, vcc
    v_cmp_lt_i32 vcc, -26, v100
    s_nop 1
    v_cndmask_b32 v54, v101, v54, vcc
    v_cmp_lt_i32 vcc, -27, v100
    s_nop 1
    v_cndmask_b32 v55, v101, v55, vcc
sln_41:
    s_cmp_eq_u32 s45, 8
    s_cbranch_scc0 sln_42
    v_cmp_ge_i32 vcc, 0, v100
    s_nop 1
    v_cndmask_b32 v40, v101, v40, vcc
    v_cmp_ge_i32 vcc, -1, v100
    s_nop 1
    v_cndmask_b32 v41, v101, v41, vcc
    v_cmp_ge_i32 vcc, -2, v100
    s_nop 1
    v_cndmask_b32 v42, v101, v42, vcc
    v_cmp_ge_i32 vcc, -3, v100
    s_nop 1
    v_cndmask_b32 v43, v101, v43, vcc
    v_cmp_ge_i32 vcc, -8, v100
    s_nop 1
    v_cndmask_b32 v44, v101, v44, vcc
    v_cmp_ge_i32 vcc, -9, v100
    s_nop 1
    v_cndmask_b32 v45, v101, v45, vcc
    v_cmp_ge_i32 vcc, -10, v100
    s_nop 1
    v_cndmask_b32 v46, v101, v46, vcc
    v_cmp_ge_i32 vcc, -11, v100
    s_nop 1
    v_cndmask_b32 v47, v101, v47, vcc
    v_cmp_ge_i32 vcc, -16, v100
    s_nop 1
    v_cndmask_b32 v48, v101, v48, vcc
    v_cmp_ge_i32 vcc, -17, v100
    s_nop 1
    v_cndmask_b32 v49, v101, v49, vcc
    v_cmp_ge_i32 vcc, -18, v100
    s_nop 1
    v_cndmask_b32 v50, v101, v50, vcc
    v_cmp_ge_i32 vcc, -19, v100
    s_nop 1
    v_cndmask_b32 v51, v101, v51, vcc
    v_cmp_ge_i32 vcc, -24, v100
    s_nop 1
    v_cndmask_b32 v52, v101, v52, vcc
    v_cmp_ge_i32 vcc, -25, v100
    s_nop 1
    v_cndmask_b32 v53, v101, v53, vcc
    v_cmp_ge_i32 vcc, -26, v100
    s_nop 1
    v_cndmask_b32 v54, v101, v54, vcc
    v_cmp_ge_i32 vcc, -27, v100
    s_nop 1
    v_cndmask_b32 v55, v101, v55, vcc
sln_42:
    s_cmp_eq_u32 s43, 0
    s_cbranch_scc0 slf_40
    v_max_f32 v96, v96, v40
    v_max_f32 v96, v96, v41
    v_max_f32 v96, v96, v42
    v_max_f32 v96, v96, v43
    v_max_f32 v96, v96, v44
    v_max_f32 v96, v96, v45
    v_max_f32 v96, v96, v46
    v_max_f32 v96, v96, v47
    v_max_f32 v96, v96, v48
    v_max_f32 v96, v96, v49
    v_max_f32 v96, v96, v50
    v_max_f32 v96, v96, v51
    v_max_f32 v96, v96, v52
    v_max_f32 v96, v96, v53
    v_max_f32 v96, v96, v54
    v_max_f32 v96, v96, v55
    s_branch slk_39
slf_40:
    v_sub_f32 v40, v40, v96
    v_sub_f32 v41, v41, v96
    v_sub_f32 v42, v42, v96
    v_sub_f32 v43, v43, v96
    v_sub_f32 v44, v44, v96
    v_sub_f32 v45, v45, v96
    v_sub_f32 v46, v46, v96
    v_sub_f32 v47, v47, v96
    v_sub_f32 v48, v48, v96
    v_sub_f32 v49, v49, v96
    v_sub_f32 v50, v50, v96
    v_sub_f32 v51, v51, v96
    v_sub_f32 v52, v52, v96
    v_sub_f32 v53, v53, v96
    v_sub_f32 v54, v54, v96
    v_sub_f32 v55, v55, v96
    v_exp_f32 v40, v40
    v_exp_f32 v41, v41
    v_exp_f32 v42, v42
    v_exp_f32 v43, v43
    v_exp_f32 v44, v44
    v_exp_f32 v45, v45
    v_exp_f32 v46, v46
    v_exp_f32 v47, v47
    v_exp_f32 v48, v48
    v_exp_f32 v49, v49
    v_exp_f32 v50, v50
    v_exp_f32 v51, v51
    v_exp_f32 v52, v52
    v_exp_f32 v53, v53
    v_exp_f32 v54, v54
    v_exp_f32 v55, v55
    s_nop 1
    v_cvt_pk_bf16_f32 v72, v40, v41
    v_cvt_pk_bf16_f32 v73, v42, v43
    v_cvt_pk_bf16_f32 v74, v44, v45
    v_cvt_pk_bf16_f32 v75, v46, v47
    v_cvt_pk_bf16_f32 v76, v48, v49
    v_cvt_pk_bf16_f32 v77, v50, v51
    v_cvt_pk_bf16_f32 v78, v52, v53
    v_cvt_pk_bf16_f32 v79, v54, v55
    s_nop 1
    v_mfma_f32_32x32x16_bf16 v[168:183], a[124:127], v[72:75], v[168:183]
    v_mfma_f32_32x32x16_bf16 v[168:183], a[128:131], v[76:79], v[168:183]
    s_nop 15
slk_39:
    s_sub_u32 s45, s44, 1
    s_cmp_gt_u32 s45, 8
    s_cbranch_scc1 slk_43
    v_mfma_f32_32x32x16_bf16 v[40:55], a[100:103], v[144:147], 0
    v_mfma_f32_32x32x16_bf16 v[40:55], a[104:107], v[148:151], v[40:55]
    s_nop 15
    s_cmp_eq_u32 s45, 0
    s_cbranch_scc0 sln_45
    v_cmp_lt_i32 vcc, 0, v100
    s_nop 1
    v_cndmask_b32 v40, v101, v40, vcc
    v_cmp_lt_i32 vcc, -1, v100
    s_nop 1
    v_cndmask_b32 v41, v101, v41, vcc
    v_cmp_lt_i32 vcc, -2, v100
    s_nop 1
    v_cndmask_b32 v42, v101, v42, vcc
    v_cmp_lt_i32 vcc, -3, v100
    s_nop 1
    v_cndmask_b32 v43, v101, v43, vcc
    v_cmp_lt_i32 vcc, -8, v100
    s_nop 1
    v_cndmask_b32 v44, v101, v44, vcc
    v_cmp_lt_i32 vcc, -9, v100
    s_nop 1
    v_cndmask_b32 v45, v101, v45, vcc
    v_cmp_lt_i32 vcc, -10, v100
    s_nop 1
    v_cndmask_b32 v46, v101, v46, vcc
    v_cmp_lt_i32 vcc, -11, v100
    s_nop 1
    v_cndmask_b32 v47, v101, v47, vcc
    v_cmp_lt_i32 vcc, -16, v100
    s_nop 1
    v_cndmask_b32 v48, v101, v48, vcc
    v_cmp_lt_i32 vcc, -17, v100
    s_nop 1
    v_cndmask_b32 v49, v101, v49, vcc
    v_cmp_lt_i32 vcc, -18, v100
    s_nop 1
    v_cndmask_b32 v50, v101, v50, vcc
    v_cmp_lt_i32 vcc, -19, v100
    s_nop 1
    v_cndmask_b32 v51, v101, v51, vcc
    v_cmp_lt_i32 vcc, -24, v100
    s_nop 1
    v_cndmask_b32 v52, v101, v52, vcc
    v_cmp_lt_i32 vcc, -25, v100
    s_nop 1
    v_cndmask_b32 v53, v101, v53, vcc
    v_cmp_lt_i32 vcc, -26, v100
    s_nop 1
    v_cndmask_b32 v54, v101, v54, vcc
    v_cmp_lt_i32 vcc, -27, v100
    s_nop 1
    v_cndmask_b32 v55, v101, v55, vcc
sln_45:
    s_cmp_eq_u32 s45, 8
    s_cbranch_scc0 sln_46
    v_cmp_ge_i32 vcc, 0, v100
    s_nop 1
    v_cndmask_b32 v40, v101, v40, vcc
    v_cmp_ge_i32 vcc, -1, v100
    s_nop 1
    v_cndmask_b32 v41, v101, v41, vcc
    v_cmp_ge_i32 vcc, -2, v100
    s_nop 1
    v_cndmask_b32 v42, v101, v42, vcc
    v_cmp_ge_i32 vcc, -3, v100
    s_nop 1
    v_cndmask_b32 v43, v101, v43, vcc
    v_cmp_ge_i32 vcc, -8, v100
    s_nop 1
    v_cndmask_b32 v44, v101, v44, vcc
    v_cmp_ge_i32 vcc, -9, v100
    s_nop 1
    v_cndmask_b32 v45, v101, v45, vcc
    v_cmp_ge_i32 vcc, -10, v100
    s_nop 1
    v_cndmask_b32 v46, v101, v46, vcc
    v_cmp_ge_i32 vcc, -11, v100
    s_nop 1
    v_cndmask_b32 v47, v101, v47, vcc
    v_cmp_ge_i32 vcc, -16, v100
    s_nop 1
    v_cndmask_b32 v48, v101, v48, vcc
    v_cmp_ge_i32 vcc, -17, v100
    s_nop 1
    v_cndmask_b32 v49, v101, v49, vcc
    v_cmp_ge_i32 vcc, -18, v100
    s_nop 1
    v_cndmask_b32 v50, v101, v50, vcc
    v_cmp_ge_i32 vcc, -19, v100
    s_nop 1
    v_cndmask_b32 v51, v101, v51, vcc
    v_cmp_ge_i32 vcc, -24, v100
    s_nop 1
    v_cndmask_b32 v52, v101, v52, vcc
    v_cmp_ge_i32 vcc, -25, v100
    s_nop 1
    v_cndmask_b32 v53, v101, v53, vcc
    v_cmp_ge_i32 vcc, -26, v100
    s_nop 1
    v_cndmask_b32 v54, v101, v54, vcc
    v_cmp_ge_i32 vcc, -27, v100
    s_nop 1
    v_cndmask_b32 v55, v101, v55, vcc
sln_46:
    s_cmp_eq_u32 s43, 0
    s_cbranch_scc0 slf_44
    v_max_f32 v97, v97, v40
    v_max_f32 v97, v97, v41
    v_max_f32 v97, v97, v42
    v_max_f32 v97, v97, v43
    v_max_f32 v97, v97, v44
    v_max_f32 v97, v97, v45
    v_max_f32 v97, v97, v46
    v_max_f32 v97, v97, v47
    v_max_f32 v97, v97, v48
    v_max_f32 v97, v97, v49
    v_max_f32 v97, v97, v50
    v_max_f32 v97, v97, v51
    v_max_f32 v97, v97, v52
    v_max_f32 v97, v97, v53
    v_max_f32 v97, v97, v54
    v_max_f32 v97, v97, v55
    s_branch slk_43
slf_44:
    v_sub_f32 v40, v40, v97
    v_sub_f32 v41, v41, v97
    v_sub_f32 v42, v42, v97
    v_sub_f32 v43, v43, v97
    v_sub_f32 v44, v44, v97
    v_sub_f32 v45, v45, v97
    v_sub_f32 v46, v46, v97
    v_sub_f32 v47, v47, v97
    v_sub_f32 v48, v48, v97
    v_sub_f32 v49, v49, v97
    v_sub_f32 v50, v50, v97
    v_sub_f32 v51, v51, v97
    v_sub_f32 v52, v52, v97
    v_sub_f32 v53, v53, v97
    v_sub_f32 v54, v54, v97
    v_sub_f32 v55, v55, v97
    v_exp_f32 v40, v40
    v_exp_f32 v41, v41
    v_exp_f32 v42, v42
    v_exp_f32 v43, v43
    v_exp_f32 v44, v44
    v_exp_f32 v45, v45
    v_exp_f32 v46, v46
    v_exp_f32 v47, v47
    v_exp_f32 v48, v48
    v_exp_f32 v49, v49
    v_exp_f32 v50, v50
    v_exp_f32 v51, v51
    v_exp_f32 v52, v52
    v_exp_f32 v53, v53
    v_exp_f32 v54, v54
    v_exp_f32 v55, v55
    s_nop 1
    v_cvt_pk_bf16_f32 v72, v40, v41
    v_cvt_pk_bf16_f32 v73, v42, v43
    v_cvt_pk_bf16_f32 v74, v44, v45
    v_cvt_pk_bf16_f32 v75, v46, v47
    v_cvt_pk_bf16_f32 v76, v48, v49
    v_cvt_pk_bf16_f32 v77, v50, v51
    v_cvt_pk_bf16_f32 v78, v52, v53
    v_cvt_pk_bf16_f32 v79, v54, v55
    s_nop 1
    v_mfma_f32_32x32x16_bf16 v[184:199], a[124:127], v[72:75], v[184:199]
    v_mfma_f32_32x32x16_bf16 v[184:199], a[128:131], v[76:79], v[184:199]
    s_nop 15
slk_43:
    s_sub_u32 s45, s44, 2
    s_cmp_gt_u32 s45, 8
    s_cbranch_scc1 slk_47
    v_mfma_f32_32x32x16_bf16 v[40:55], a[100:103], v[152:155], 0
    v_mfma_f32_32x32x16_bf16 v[40:55], a[104:107], v[156:159], v[40:55]
    s_nop 15
    s_cmp_eq_u32 s45, 0
    s_cbranch_scc0 sln_49
    v_cmp_lt_i32 vcc, 0, v100
    s_nop 1
    v_cndmask_b32 v40, v101, v40, vcc
    v_cmp_lt_i32 vcc, -1, v100
    s_nop 1
    v_cndmask_b32 v41, v101, v41, vcc
    v_cmp_lt_i32 vcc, -2, v100
    s_nop 1
    v_cndmask_b32 v42, v101, v42, vcc
    v_cmp_lt_i32 vcc, -3, v100
    s_nop 1
    v_cndmask_b32 v43, v101, v43, vcc
    v_cmp_lt_i32 vcc, -8, v100
    s_nop 1
    v_cndmask_b32 v44, v101, v44, vcc
    v_cmp_lt_i32 vcc, -9, v100
    s_nop 1
    v_cndmask_b32 v45, v101, v45, vcc
    v_cmp_lt_i32 vcc, -10, v100
    s_nop 1
    v_cndmask_b32 v46, v101, v46, vcc
    v_cmp_lt_i32 vcc, -11, v100
    s_nop 1
    v_cndmask_b32 v47, v101, v47, vcc
    v_cmp_lt_i32 vcc, -16, v100
    s_nop 1
    v_cndmask_b32 v48, v101, v48, vcc
    v_cmp_lt_i32 vcc, -17, v100
    s_nop 1
    v_cndmask_b32 v49, v101, v49, vcc
    v_cmp_lt_i32 vcc, -18, v100
    s_nop 1
    v_cndmask_b32 v50, v101, v50, vcc
    v_cmp_lt_i32 vcc, -19, v100
    s_nop 1
    v_cndmask_b32 v51, v101, v51, vcc
    v_cmp_lt_i32 vcc, -24, v100
    s_nop 1
    v_cndmask_b32 v52, v101, v52, vcc
    v_cmp_lt_i32 vcc, -25, v100
    s_nop 1
    v_cndmask_b32 v53, v101, v53, vcc
    v_cmp_lt_i32 vcc, -26, v100
    s_nop 1
    v_cndmask_b32 v54, v101, v54, vcc
    v_cmp_lt_i32 vcc, -27, v100
    s_nop 1
    v_cndmask_b32 v55, v101, v55, vcc
sln_49:
    s_cmp_eq_u32 s45, 8
    s_cbranch_scc0 sln_50
    v_cmp_ge_i32 vcc, 0, v100
    s_nop 1
    v_cndmask_b32 v40, v101, v40, vcc
    v_cmp_ge_i32 vcc, -1, v100
    s_nop 1
    v_cndmask_b32 v41, v101, v41, vcc
    v_cmp_ge_i32 vcc, -2, v100
    s_nop 1
    v_cndmask_b32 v42, v101, v42, vcc
    v_cmp_ge_i32 vcc, -3, v100
    s_nop 1
    v_cndmask_b32 v43, v101, v43, vcc
    v_cmp_ge_i32 vcc, -8, v100
    s_nop 1
    v_cndmask_b32 v44, v101, v44, vcc
    v_cmp_ge_i32 vcc, -9, v100
    s_nop 1
    v_cndmask_b32 v45, v101, v45, vcc
    v_cmp_ge_i32 vcc, -10, v100
    s_nop 1
    v_cndmask_b32 v46, v101, v46, vcc
    v_cmp_ge_i32 vcc, -11, v100
    s_nop 1
    v_cndmask_b32 v47, v101, v47, vcc
    v_cmp_ge_i32 vcc, -16, v100
    s_nop 1
    v_cndmask_b32 v48, v101, v48, vcc
    v_cmp_ge_i32 vcc, -17, v100
    s_nop 1
    v_cndmask_b32 v49, v101, v49, vcc
    v_cmp_ge_i32 vcc, -18, v100
    s_nop 1
    v_cndmask_b32 v50, v101, v50, vcc
    v_cmp_ge_i32 vcc, -19, v100
    s_nop 1
    v_cndmask_b32 v51, v101, v51, vcc
    v_cmp_ge_i32 vcc, -24, v100
    s_nop 1
    v_cndmask_b32 v52, v101, v52, vcc
    v_cmp_ge_i32 vcc, -25, v100
    s_nop 1
    v_cndmask_b32 v53, v101, v53, vcc
    v_cmp_ge_i32 vcc, -26, v100
    s_nop 1
    v_cndmask_b32 v54, v101, v54, vcc
    v_cmp_ge_i32 vcc, -27, v100
    s_nop 1
    v_cndmask_b32 v55, v101, v55, vcc
sln_50:
    s_cmp_eq_u32 s43, 0
    s_cbranch_scc0 slf_48
    v_max_f32 v98, v98, v40
    v_max_f32 v98, v98, v41
    v_max_f32 v98, v98, v42
    v_max_f32 v98, v98, v43
    v_max_f32 v98, v98, v44
    v_max_f32 v98, v98, v45
    v_max_f32 v98, v98, v46
    v_max_f32 v98, v98, v47
    v_max_f32 v98, v98, v48
    v_max_f32 v98, v98, v49
    v_max_f32 v98, v98, v50
    v_max_f32 v98, v98, v51
    v_max_f32 v98, v98, v52
    v_max_f32 v98, v98, v53
    v_max_f32 v98, v98, v54
    v_max_f32 v98, v98, v55
    s_branch slk_47
slf_48:
    v_sub_f32 v40, v40, v98
    v_sub_f32 v41, v41, v98
    v_sub_f32 v42, v42, v98
    v_sub_f32 v43, v43, v98
    v_sub_f32 v44, v44, v98
    v_sub_f32 v45, v45, v98
    v_sub_f32 v46, v46, v98
    v_sub_f32 v47, v47, v98
    v_sub_f32 v48, v48, v98
    v_sub_f32 v49, v49, v98
    v_sub_f32 v50, v50, v98
    v_sub_f32 v51, v51, v98
    v_sub_f32 v52, v52, v98
    v_sub_f32 v53, v53, v98
    v_sub_f32 v54, v54, v98
    v_sub_f32 v55, v55, v98
    v_exp_f32 v40, v40
    v_exp_f32 v41, v41
    v_exp_f32 v42, v42
    v_exp_f32 v43, v43
    v_exp_f32 v44, v44
    v_exp_f32 v45, v45
    v_exp_f32 v46, v46
    v_exp_f32 v47, v47
    v_exp_f32 v48, v48
    v_exp_f32 v49, v49
    v_exp_f32 v50, v50
    v_exp_f32 v51, v51
    v_exp_f32 v52, v52
    v_exp_f32 v53, v53
    v_exp_f32 v54, v54
    v_exp_f32 v55, v55
    s_nop 1
    v_cvt_pk_bf16_f32 v72, v40, v41
    v_cvt_pk_bf16_f32 v73, v42, v43
    v_cvt_pk_bf16_f32 v74, v44, v45
    v_cvt_pk_bf16_f32 v75, v46, v47
    v_cvt_pk_bf16_f32 v76, v48, v49
    v_cvt_pk_bf16_f32 v77, v50, v51
    v_cvt_pk_bf16_f32 v78, v52, v53
    v_cvt_pk_bf16_f32 v79, v54, v55
    s_nop 1
    v_mfma_f32_32x32x16_bf16 v[200:215], a[124:127], v[72:75], v[200:215]
    v_mfma_f32_32x32x16_bf16 v[200:215], a[128:131], v[76:79], v[200:215]
    s_nop 15
slk_47:
    s_sub_u32 s45, s44, 3
    s_cmp_gt_u32 s45, 8
    s_cbranch_scc1 slk_51
    v_mfma_f32_32x32x16_bf16 v[40:55], a[100:103], v[160:163], 0
    v_mfma_f32_32x32x16_bf16 v[40:55], a[104:107], v[164:167], v[40:55]
    s_nop 15
    s_cmp_eq_u32 s45, 0
    s_cbranch_scc0 sln_53
    v_cmp_lt_i32 vcc, 0, v100
    s_nop 1
    v_cndmask_b32 v40, v101, v40, vcc
    v_cmp_lt_i32 vcc, -1, v100
    s_nop 1
    v_cndmask_b32 v41, v101, v41, vcc
    v_cmp_lt_i32 vcc, -2, v100
    s_nop 1
    v_cndmask_b32 v42, v101, v42, vcc
    v_cmp_lt_i32 vcc, -3, v100
    s_nop 1
    v_cndmask_b32 v43, v101, v43, vcc
    v_cmp_lt_i32 vcc, -8, v100
    s_nop 1
    v_cndmask_b32 v44, v101, v44, vcc
    v_cmp_lt_i32 vcc, -9, v100
    s_nop 1
    v_cndmask_b32 v45, v101, v45, vcc
    v_cmp_lt_i32 vcc, -10, v100
    s_nop 1
    v_cndmask_b32 v46, v101, v46, vcc
    v_cmp_lt_i32 vcc, -11, v100
    s_nop 1
    v_cndmask_b32 v47, v101, v47, vcc
    v_cmp_lt_i32 vcc, -16, v100
    s_nop 1
    v_cndmask_b32 v48, v101, v48, vcc
    v_cmp_lt_i32 vcc, -17, v100
    s_nop 1
    v_cndmask_b32 v49, v101, v49, vcc
    v_cmp_lt_i32 vcc, -18, v100
    s_nop 1
    v_cndmask_b32 v50, v101, v50, vcc
    v_cmp_lt_i32 vcc, -19, v100
    s_nop 1
    v_cndmask_b32 v51, v101, v51, vcc
    v_cmp_lt_i32 vcc, -24, v100
    s_nop 1
    v_cndmask_b32 v52, v101, v52, vcc
    v_cmp_lt_i32 vcc, -25, v100
    s_nop 1
    v_cndmask_b32 v53, v101, v53, vcc
    v_cmp_lt_i32 vcc, -26, v100
    s_nop 1
    v_cndmask_b32 v54, v101, v54, vcc
    v_cmp_lt_i32 vcc, -27, v100
    s_nop 1
    v_cndmask_b32 v55, v101, v55, vcc
sln_53:
    s_cmp_eq_u32 s45, 8
    s_cbranch_scc0 sln_54
    v_cmp_ge_i32 vcc, 0, v100
    s_nop 1
    v_cndmask_b32 v40, v101, v40, vcc
    v_cmp_ge_i32 vcc, -1, v100
    s_nop 1
    v_cndmask_b32 v41, v101, v41, vcc
    v_cmp_ge_i32 vcc, -2, v100
    s_nop 1
    v_cndmask_b32 v42, v101, v42, vcc
    v_cmp_ge_i32 vcc, -3, v100
    s_nop 1
    v_cndmask_b32 v43, v101, v43, vcc
    v_cmp_ge_i32 vcc, -8, v100
    s_nop 1
    v_cndmask_b32 v44, v101, v44, vcc
    v_cmp_ge_i32 vcc, -9, v100
    s_nop 1
    v_cndmask_b32 v45, v101, v45, vcc
    v_cmp_ge_i32 vcc, -10, v100
    s_nop 1
    v_cndmask_b32 v46, v101, v46, vcc
    v_cmp_ge_i32 vcc, -11, v100
    s_nop 1
    v_cndmask_b32 v47, v101, v47, vcc
    v_cmp_ge_i32 vcc, -16, v100
    s_nop 1
    v_cndmask_b32 v48, v101, v48, vcc
    v_cmp_ge_i32 vcc, -17, v100
    s_nop 1
    v_cndmask_b32 v49, v101, v49, vcc
    v_cmp_ge_i32 vcc, -18, v100
    s_nop 1
    v_cndmask_b32 v50, v101, v50, vcc
    v_cmp_ge_i32 vcc, -19, v100
    s_nop 1
    v_cndmask_b32 v51, v101, v51, vcc
    v_cmp_ge_i32 vcc, -24, v100
    s_nop 1
    v_cndmask_b32 v52, v101, v52, vcc
    v_cmp_ge_i32 vcc, -25, v100
    s_nop 1
    v_cndmask_b32 v53, v101, v53, vcc
    v_cmp_ge_i32 vcc, -26, v100
    s_nop 1
    v_cndmask_b32 v54, v101, v54, vcc
    v_cmp_ge_i32 vcc, -27, v100
    s_nop 1
    v_cndmask_b32 v55, v101, v55, vcc
sln_54:
    s_cmp_eq_u32 s43, 0
    s_cbranch_scc0 slf_52
    v_max_f32 v99, v99, v40
    v_max_f32 v99, v99, v41
    v_max_f32 v99, v99, v42
    v_max_f32 v99, v99, v43
    v_max_f32 v99, v99, v44
    v_max_f32 v99, v99, v45
    v_max_f32 v99, v99, v46
    v_max_f32 v99, v99, v47
    v_max_f32 v99, v99, v48
    v_max_f32 v99, v99, v49
    v_max_f32 v99, v99, v50
    v_max_f32 v99, v99, v51
    v_max_f32 v99, v99, v52
    v_max_f32 v99, v99, v53
    v_max_f32 v99, v99, v54
    v_max_f32 v99, v99, v55
    s_branch slk_51
slf_52:
    v_sub_f32 v40, v40, v99
    v_sub_f32 v41, v41, v99
    v_sub_f32 v42, v42, v99
    v_sub_f32 v43, v43, v99
    v_sub_f32 v44, v44, v99
    v_sub_f32 v45, v45, v99
    v_sub_f32 v46, v46, v99
    v_sub_f32 v47, v47, v99
    v_sub_f32 v48, v48, v99
    v_sub_f32 v49, v49, v99
    v_sub_f32 v50, v50, v99
    v_sub_f32 v51, v51, v99
    v_sub_f32 v52, v52, v99
    v_sub_f32 v53, v53, v99
    v_sub_f32 v54, v54, v99
    v_sub_f32 v55, v55, v99
    v_exp_f32 v40, v40
    v_exp_f32 v41, v41
    v_exp_f32 v42, v42
    v_exp_f32 v43, v43
    v_exp_f32 v44, v44
    v_exp_f32 v45, v45
    v_exp_f32 v46, v46
    v_exp_f32 v47, v47
    v_exp_f32 v48, v48
    v_exp_f32 v49, v49
    v_exp_f32 v50, v50
    v_exp_f32 v51, v51
    v_exp_f32 v52, v52
    v_exp_f32 v53, v53
    v_exp_f32 v54, v54
    v_exp_f32 v55, v55
    s_nop 1
    v_cvt_pk_bf16_f32 v72, v40, v41
    v_cvt_pk_bf16_f32 v73, v42, v43
    v_cvt_pk_bf16_f32 v74, v44, v45
    v_cvt_pk_bf16_f32 v75, v46, v47
    v_cvt_pk_bf16_f32 v76, v48, v49
    v_cvt_pk_bf16_f32 v77, v50, v51
    v_cvt_pk_bf16_f32 v78, v52, v53
    v_cvt_pk_bf16_f32 v79, v54, v55
    s_nop 1
    v_mfma_f32_32x32x16_bf16 v[216:231], a[124:127], v[72:75], v[216:231]
    v_mfma_f32_32x32x16_bf16 v[216:231], a[128:131], v[76:79], v[216:231]
    s_nop 15
slk_51:
slt_38:
    s_lshl_b32 s44, s61, 2
    s_add_u32 s44, s44, 1
    s_cmp_lt_u32 s44, s42
    s_cbranch_scc1 slt_55
    v_add_u32 v102, s46, v113
    v_add_u32 v103, s46, v82
    v_add_u32 v104, s46, v83
    ds_read_b64_tr_b16 a[100:101], v102
    ds_read_b64_tr_b16 a[102:103], v102 offset:1024
    ds_read_b64_tr_b16 a[104:105], v102 offset:4096
    ds_read_b128 a[124:127], v103
    ds_read_b128 a[128:131], v104
    s_waitcnt lgkmcnt(0)
    s_sub_u32 s45, s44, 0
    s_cmp_gt_u32 s45, 8
    s_cbranch_scc1 slk_56
    v_mfma_f32_32x32x16_bf16 v[40:55], a[100:103], v[136:139], 0
    v_mfma_f32_32x32x16_bf16 v[40:55], a[104:107], v[140:143], v[40:55]
    s_nop 15
    s_cmp_eq_u32 s45, 0
    s_cbranch_scc0 sln_58
    v_cmp_lt_i32 vcc, 0, v100
    s_nop 1
    v_cndmask_b32 v40, v101, v40, vcc
    v_cmp_lt_i32 vcc, -1, v100
    s_nop 1
    v_cndmask_b32 v41, v101, v41, vcc
    v_cmp_lt_i32 vcc, -2, v100
    s_nop 1
    v_cndmask_b32 v42, v101, v42, vcc
    v_cmp_lt_i32 vcc, -3, v100
    s_nop 1
    v_cndmask_b32 v43, v101, v43, vcc
    v_cmp_lt_i32 vcc, -8, v100
    s_nop 1
    v_cndmask_b32 v44, v101, v44, vcc
    v_cmp_lt_i32 vcc, -9, v100
    s_nop 1
    v_cndmask_b32 v45, v101, v45, vcc
    v_cmp_lt_i32 vcc, -10, v100
    s_nop 1
    v_cndmask_b32 v46, v101, v46, vcc
    v_cmp_lt_i32 vcc, -11, v100
    s_nop 1
    v_cndmask_b32 v47, v101, v47, vcc
    v_cmp_lt_i32 vcc, -16, v100
    s_nop 1
    v_cndmask_b32 v48, v101, v48, vcc
    v_cmp_lt_i32 vcc, -17, v100
    s_nop 1
    v_cndmask_b32 v49, v101, v49, vcc
    v_cmp_lt_i32 vcc, -18, v100
    s_nop 1
    v_cndmask_b32 v50, v101, v50, vcc
    v_cmp_lt_i32 vcc, -19, v100
    s_nop 1
    v_cndmask_b32 v51, v101, v51, vcc
    v_cmp_lt_i32 vcc, -24, v100
    s_nop 1
    v_cndmask_b32 v52, v101, v52, vcc
    v_cmp_lt_i32 vcc, -25, v100
    s_nop 1
    v_cndmask_b32 v53, v101, v53, vcc
    v_cmp_lt_i32 vcc, -26, v100
    s_nop 1
    v_cndmask_b32 v54, v101, v54, vcc
    v_cmp_lt_i32 vcc, -27, v100
    s_nop 1
    v_cndmask_b32 v55, v101, v55, vcc
sln_58:
    s_cmp_eq_u32 s45, 8
    s_cbranch_scc0 sln_59
    v_cmp_ge_i32 vcc, 0, v100
    s_nop 1
    v_cndmask_b32 v40, v101, v40, vcc
    v_cmp_ge_i32 vcc, -1, v100
    s_nop 1
    v_cndmask_b32 v41, v101, v41, vcc
    v_cmp_ge_i32 vcc, -2, v100
    s_nop 1
    v_cndmask_b32 v42, v101, v42, vcc
    v_cmp_ge_i32 vcc, -3, v100
    s_nop 1
    v_cndmask_b32 v43, v101, v43, vcc
    v_cmp_ge_i32 vcc, -8, v100
    s_nop 1
    v_cndmask_b32 v44, v101, v44, vcc
    v_cmp_ge_i32 vcc, -9, v100
    s_nop 1
    v_cndmask_b32 v45, v101, v45, vcc
    v_cmp_ge_i32 vcc, -10, v100
    s_nop 1
    v_cndmask_b32 v46, v101, v46, vcc
    v_cmp_ge_i32 vcc, -11, v100
    s_nop 1
    v_cndmask_b32 v47, v101, v47, vcc
    v_cmp_ge_i32 vcc, -16, v100
    s_nop 1
    v_cndmask_b32 v48, v101, v48, vcc
    v_cmp_ge_i32 vcc, -17, v100
    s_nop 1
    v_cndmask_b32 v49, v101, v49, vcc
    v_cmp_ge_i32 vcc, -18, v100
    s_nop 1
    v_cndmask_b32 v50, v101, v50, vcc
    v_cmp_ge_i32 vcc, -19, v100
    s_nop 1
    v_cndmask_b32 v51, v101, v51, vcc
    v_cmp_ge_i32 vcc, -24, v100
    s_nop 1
    v_cndmask_b32 v52, v101, v52, vcc
    v_cmp_ge_i32 vcc, -25, v100
    s_nop 1
    v_cndmask_b32 v53, v101, v53, vcc
    v_cmp_ge_i32 vcc, -26, v100
    s_nop 1
    v_cndmask_b32 v54, v101, v54, vcc
    v_cmp_ge_i32 vcc, -27, v100
    s_nop 1
    v_cndmask_b32 v55, v101, v55, vcc
sln_59:
    s_cmp_eq_u32 s43, 0
    s_cbranch_scc0 slf_57
    v_max_f32 v96, v96, v40
    v_max_f32 v96, v96, v41
    v_max_f32 v96, v96, v42
    v_max_f32 v96, v96, v43
    v_max_f32 v96, v96, v44
    v_max_f32 v96, v96, v45
    v_max_f32 v96, v96, v46
    v_max_f32 v96, v96, v47
    v_max_f32 v96, v96, v48
    v_max_f32 v96, v96, v49
    v_max_f32 v96, v96, v50
    v_max_f32 v96, v96, v51
    v_max_f32 v96, v96, v52
    v_max_f32 v96, v96, v53
    v_max_f32 v96, v96, v54
    v_max_f32 v96, v96, v55
    s_branch slk_56
slf_57:
    v_sub_f32 v40, v40, v96
    v_sub_f32 v41, v41, v96
    v_sub_f32 v42, v42, v96
    v_sub_f32 v43, v43, v96
    v_sub_f32 v44, v44, v96
    v_sub_f32 v45, v45, v96
    v_sub_f32 v46, v46, v96
    v_sub_f32 v47, v47, v96
    v_sub_f32 v48, v48, v96
    v_sub_f32 v49, v49, v96
    v_sub_f32 v50, v50, v96
    v_sub_f32 v51, v51, v96
    v_sub_f32 v52, v52, v96
    v_sub_f32 v53, v53, v96
    v_sub_f32 v54, v54, v96
    v_sub_f32 v55, v55, v96
    v_exp_f32 v40, v40
    v_exp_f32 v41, v41
    v_exp_f32 v42, v42
    v_exp_f32 v43, v43
    v_exp_f32 v44, v44
    v_exp_f32 v45, v45
    v_exp_f32 v46, v46
    v_exp_f32 v47, v47
    v_exp_f32 v48, v48
    v_exp_f32 v49, v49
    v_exp_f32 v50, v50
    v_exp_f32 v51, v51
    v_exp_f32 v52, v52
    v_exp_f32 v53, v53
    v_exp_f32 v54, v54
    v_exp_f32 v55, v55
    s_nop 1
    v_cvt_pk_bf16_f32 v72, v40, v41
    v_cvt_pk_bf16_f32 v73, v42, v43
    v_cvt_pk_bf16_f32 v74, v44, v45
    v_cvt_pk_bf16_f32 v75, v46, v47
    v_cvt_pk_bf16_f32 v76, v48, v49
    v_cvt_pk_bf16_f32 v77, v50, v51
    v_cvt_pk_bf16_f32 v78, v52, v53
    v_cvt_pk_bf16_f32 v79, v54, v55
    s_nop 1
    v_mfma_f32_32x32x16_bf16 v[168:183], a[124:127], v[72:75], v[168:183]
    v_mfma_f32_32x32x16_bf16 v[168:183], a[128:131], v[76:79], v[168:183]
    s_nop 15
slk_56:
    s_sub_u32 s45, s44, 1
    s_cmp_gt_u32 s45, 8
    s_cbranch_scc1 slk_60
    v_mfma_f32_32x32x16_bf16 v[40:55], a[100:103], v[144:147], 0
    v_mfma_f32_32x32x16_bf16 v[40:55], a[104:107], v[148:151], v[40:55]
    s_nop 15
    s_cmp_eq_u32 s45, 0
    s_cbranch_scc0 sln_62
    v_cmp_lt_i32 vcc, 0, v100
    s_nop 1
    v_cndmask_b32 v40, v101, v40, vcc
    v_cmp_lt_i32 vcc, -1, v100
    s_nop 1
    v_cndmask_b32 v41, v101, v41, vcc
    v_cmp_lt_i32 vcc, -2, v100
    s_nop 1
    v_cndmask_b32 v42, v101, v42, vcc
    v_cmp_lt_i32 vcc, -3, v100
    s_nop 1
    v_cndmask_b32 v43, v101, v43, vcc
    v_cmp_lt_i32 vcc, -8, v100
    s_nop 1
    v_cndmask_b32 v44, v101, v44, vcc
    v_cmp_lt_i32 vcc, -9, v100
    s_nop 1
    v_cndmask_b32 v45, v101, v45, vcc
    v_cmp_lt_i32 vcc, -10, v100
    s_nop 1
    v_cndmask_b32 v46, v101, v46, vcc
    v_cmp_lt_i32 vcc, -11, v100
    s_nop 1
    v_cndmask_b32 v47, v101, v47, vcc
    v_cmp_lt_i32 vcc, -16, v100
    s_nop 1
    v_cndmask_b32 v48, v101, v48, vcc
    v_cmp_lt_i32 vcc, -17, v100
    s_nop 1
    v_cndmask_b32 v49, v101, v49, vcc
    v_cmp_lt_i32 vcc, -18, v100
    s_nop 1
    v_cndmask_b32 v50, v101, v50, vcc
    v_cmp_lt_i32 vcc, -19, v100
    s_nop 1
    v_cndmask_b32 v51, v101, v51, vcc
    v_cmp_lt_i32 vcc, -24, v100
    s_nop 1
    v_cndmask_b32 v52, v101, v52, vcc
    v_cmp_lt_i32 vcc, -25, v100
    s_nop 1
    v_cndmask_b32 v53, v101, v53, vcc
    v_cmp_lt_i32 vcc, -26, v100
    s_nop 1
    v_cndmask_b32 v54, v101, v54, vcc
    v_cmp_lt_i32 vcc, -27, v100
    s_nop 1
    v_cndmask_b32 v55, v101, v55, vcc
sln_62:
    s_cmp_eq_u32 s45, 8
    s_cbranch_scc0 sln_63
    v_cmp_ge_i32 vcc, 0, v100
    s_nop 1
    v_cndmask_b32 v40, v101, v40, vcc
    v_cmp_ge_i32 vcc, -1, v100
    s_nop 1
    v_cndmask_b32 v41, v101, v41, vcc
    v_cmp_ge_i32 vcc, -2, v100
    s_nop 1
    v_cndmask_b32 v42, v101, v42, vcc
    v_cmp_ge_i32 vcc, -3, v100
    s_nop 1
    v_cndmask_b32 v43, v101, v43, vcc
    v_cmp_ge_i32 vcc, -8, v100
    s_nop 1
    v_cndmask_b32 v44, v101, v44, vcc
    v_cmp_ge_i32 vcc, -9, v100
    s_nop 1
    v_cndmask_b32 v45, v101, v45, vcc
    v_cmp_ge_i32 vcc, -10, v100
    s_nop 1
    v_cndmask_b32 v46, v101, v46, vcc
    v_cmp_ge_i32 vcc, -11, v100
    s_nop 1
    v_cndmask_b32 v47, v101, v47, vcc
    v_cmp_ge_i32 vcc, -16, v100
    s_nop 1
    v_cndmask_b32 v48, v101, v48, vcc
    v_cmp_ge_i32 vcc, -17, v100
    s_nop 1
    v_cndmask_b32 v49, v101, v49, vcc
    v_cmp_ge_i32 vcc, -18, v100
    s_nop 1
    v_cndmask_b32 v50, v101, v50, vcc
    v_cmp_ge_i32 vcc, -19, v100
    s_nop 1
    v_cndmask_b32 v51, v101, v51, vcc
    v_cmp_ge_i32 vcc, -24, v100
    s_nop 1
    v_cndmask_b32 v52, v101, v52, vcc
    v_cmp_ge_i32 vcc, -25, v100
    s_nop 1
    v_cndmask_b32 v53, v101, v53, vcc
    v_cmp_ge_i32 vcc, -26, v100
    s_nop 1
    v_cndmask_b32 v54, v101, v54, vcc
    v_cmp_ge_i32 vcc, -27, v100
    s_nop 1
    v_cndmask_b32 v55, v101, v55, vcc
sln_63:
    s_cmp_eq_u32 s43, 0
    s_cbranch_scc0 slf_61
    v_max_f32 v97, v97, v40
    v_max_f32 v97, v97, v41
    v_max_f32 v97, v97, v42
    v_max_f32 v97, v97, v43
    v_max_f32 v97, v97, v44
    v_max_f32 v97, v97, v45
    v_max_f32 v97, v97, v46
    v_max_f32 v97, v97, v47
    v_max_f32 v97, v97, v48
    v_max_f32 v97, v97, v49
    v_max_f32 v97, v97, v50
    v_max_f32 v97, v97, v51
    v_max_f32 v97, v97, v52
    v_max_f32 v97, v97, v53
    v_max_f32 v97, v97, v54
    v_max_f32 v97, v97, v55
    s_branch slk_60
slf_61:
    v_sub_f32 v40, v40, v97
    v_sub_f32 v41, v41, v97
    v_sub_f32 v42, v42, v97
    v_sub_f32 v43, v43, v97
    v_sub_f32 v44, v44, v97
    v_sub_f32 v45, v45, v97
    v_sub_f32 v46, v46, v97
    v_sub_f32 v47, v47, v97
    v_sub_f32 v48, v48, v97
    v_sub_f32 v49, v49, v97
    v_sub_f32 v50, v50, v97
    v_sub_f32 v51, v51, v97
    v_sub_f32 v52, v52, v97
    v_sub_f32 v53, v53, v97
    v_sub_f32 v54, v54, v97
    v_sub_f32 v55, v55, v97
    v_exp_f32 v40, v40
    v_exp_f32 v41, v41
    v_exp_f32 v42, v42
    v_exp_f32 v43, v43
    v_exp_f32 v44, v44
    v_exp_f32 v45, v45
    v_exp_f32 v46, v46
    v_exp_f32 v47, v47
    v_exp_f32 v48, v48
    v_exp_f32 v49, v49
    v_exp_f32 v50, v50
    v_exp_f32 v51, v51
    v_exp_f32 v52, v52
    v_exp_f32 v53, v53
    v_exp_f32 v54, v54
    v_exp_f32 v55, v55
    s_nop 1
    v_cvt_pk_bf16_f32 v72, v40, v41
    v_cvt_pk_bf16_f32 v73, v42, v43
    v_cvt_pk_bf16_f32 v74, v44, v45
    v_cvt_pk_bf16_f32 v75, v46, v47
    v_cvt_pk_bf16_f32 v76, v48, v49
    v_cvt_pk_bf16_f32 v77, v50, v51
    v_cvt_pk_bf16_f32 v78, v52, v53
    v_cvt_pk_bf16_f32 v79, v54, v55
    s_nop 1
    v_mfma_f32_32x32x16_bf16 v[184:199], a[124:127], v[72:75], v[184:199]
    v_mfma_f32_32x32x16_bf16 v[184:199], a[128:131], v[76:79], v[184:199]
    s_nop 15
slk_60:
    s_sub_u32 s45, s44, 2
    s_cmp_gt_u32 s45, 8
    s_cbranch_scc1 slk_64
    v_mfma_f32_32x32x16_bf16 v[40:55], a[100:103], v[152:155], 0
    v_mfma_f32_32x32x16_bf16 v[40:55], a[104:107], v[156:159], v[40:55]
    s_nop 15
    s_cmp_eq_u32 s45, 0
    s_cbranch_scc0 sln_66
    v_cmp_lt_i32 vcc, 0, v100
    s_nop 1
    v_cndmask_b32 v40, v101, v40, vcc
    v_cmp_lt_i32 vcc, -1, v100
    s_nop 1
    v_cndmask_b32 v41, v101, v41, vcc
    v_cmp_lt_i32 vcc, -2, v100
    s_nop 1
    v_cndmask_b32 v42, v101, v42, vcc
    v_cmp_lt_i32 vcc, -3, v100
    s_nop 1
    v_cndmask_b32 v43, v101, v43, vcc
    v_cmp_lt_i32 vcc, -8, v100
    s_nop 1
    v_cndmask_b32 v44, v101, v44, vcc
    v_cmp_lt_i32 vcc, -9, v100
    s_nop 1
    v_cndmask_b32 v45, v101, v45, vcc
    v_cmp_lt_i32 vcc, -10, v100
    s_nop 1
    v_cndmask_b32 v46, v101, v46, vcc
    v_cmp_lt_i32 vcc, -11, v100
    s_nop 1
    v_cndmask_b32 v47, v101, v47, vcc
    v_cmp_lt_i32 vcc, -16, v100
    s_nop 1
    v_cndmask_b32 v48, v101, v48, vcc
    v_cmp_lt_i32 vcc, -17, v100
    s_nop 1
    v_cndmask_b32 v49, v101, v49, vcc
    v_cmp_lt_i32 vcc, -18, v100
    s_nop 1
    v_cndmask_b32 v50, v101, v50, vcc
    v_cmp_lt_i32 vcc, -19, v100
    s_nop 1
    v_cndmask_b32 v51, v101, v51, vcc
    v_cmp_lt_i32 vcc, -24, v100
    s_nop 1
    v_cndmask_b32 v52, v101, v52, vcc
    v_cmp_lt_i32 vcc, -25, v100
    s_nop 1
    v_cndmask_b32 v53, v101, v53, vcc
    v_cmp_lt_i32 vcc, -26, v100
    s_nop 1
    v_cndmask_b32 v54, v101, v54, vcc
    v_cmp_lt_i32 vcc, -27, v100
    s_nop 1
    v_cndmask_b32 v55, v101, v55, vcc
sln_66:
    s_cmp_eq_u32 s45, 8
    s_cbranch_scc0 sln_67
    v_cmp_ge_i32 vcc, 0, v100
    s_nop 1
    v_cndmask_b32 v40, v101, v40, vcc
    v_cmp_ge_i32 vcc, -1, v100
    s_nop 1
    v_cndmask_b32 v41, v101, v41, vcc
    v_cmp_ge_i32 vcc, -2, v100
    s_nop 1
    v_cndmask_b32 v42, v101, v42, vcc
    v_cmp_ge_i32 vcc, -3, v100
    s_nop 1
    v_cndmask_b32 v43, v101, v43, vcc
    v_cmp_ge_i32 vcc, -8, v100
    s_nop 1
    v_cndmask_b32 v44, v101, v44, vcc
    v_cmp_ge_i32 vcc, -9, v100
    s_nop 1
    v_cndmask_b32 v45, v101, v45, vcc
    v_cmp_ge_i32 vcc, -10, v100
    s_nop 1
    v_cndmask_b32 v46, v101, v46, vcc
    v_cmp_ge_i32 vcc, -11, v100
    s_nop 1
    v_cndmask_b32 v47, v101, v47, vcc
    v_cmp_ge_i32 vcc, -16, v100
    s_nop 1
    v_cndmask_b32 v48, v101, v48, vcc
    v_cmp_ge_i32 vcc, -17, v100
    s_nop 1
    v_cndmask_b32 v49, v101, v49, vcc
    v_cmp_ge_i32 vcc, -18, v100
    s_nop 1
    v_cndmask_b32 v50, v101, v50, vcc
    v_cmp_ge_i32 vcc, -19, v100
    s_nop 1
    v_cndmask_b32 v51, v101, v51, vcc
    v_cmp_ge_i32 vcc, -24, v100
    s_nop 1
    v_cndmask_b32 v52, v101, v52, vcc
    v_cmp_ge_i32 vcc, -25, v100
    s_nop 1
    v_cndmask_b32 v53, v101, v53, vcc
    v_cmp_ge_i32 vcc, -26, v100
    s_nop 1
    v_cndmask_b32 v54, v101, v54, vcc
    v_cmp_ge_i32 vcc, -27, v100
    s_nop 1
    v_cndmask_b32 v55, v101, v55, vcc
sln_67:
    s_cmp_eq_u32 s43, 0
    s_cbranch_scc0 slf_65
    v_max_f32 v98, v98, v40
    v_max_f32 v98, v98, v41
    v_max_f32 v98, v98, v42
    v_max_f32 v98, v98, v43
    v_max_f32 v98, v98, v44
    v_max_f32 v98, v98, v45
    v_max_f32 v98, v98, v46
    v_max_f32 v98, v98, v47
    v_max_f32 v98, v98, v48
    v_max_f32 v98, v98, v49
    v_max_f32 v98, v98, v50
    v_max_f32 v98, v98, v51
    v_max_f32 v98, v98, v52
    v_max_f32 v98, v98, v53
    v_max_f32 v98, v98, v54
    v_max_f32 v98, v98, v55
    s_branch slk_64
slf_65:
    v_sub_f32 v40, v40, v98
    v_sub_f32 v41, v41, v98
    v_sub_f32 v42, v42, v98
    v_sub_f32 v43, v43, v98
    v_sub_f32 v44, v44, v98
    v_sub_f32 v45, v45, v98
    v_sub_f32 v46, v46, v98
    v_sub_f32 v47, v47, v98
    v_sub_f32 v48, v48, v98
    v_sub_f32 v49, v49, v98
    v_sub_f32 v50, v50, v98
    v_sub_f32 v51, v51, v98
    v_sub_f32 v52, v52, v98
    v_sub_f32 v53, v53, v98
    v_sub_f32 v54, v54, v98
    v_sub_f32 v55, v55, v98
    v_exp_f32 v40, v40
    v_exp_f32 v41, v41
    v_exp_f32 v42, v42
    v_exp_f32 v43, v43
    v_exp_f32 v44, v44
    v_exp_f32 v45, v45
    v_exp_f32 v46, v46
    v_exp_f32 v47, v47
    v_exp_f32 v48, v48
    v_exp_f32 v49, v49
    v_exp_f32 v50, v50
    v_exp_f32 v51, v51
    v_exp_f32 v52, v52
    v_exp_f32 v53, v53
    v_exp_f32 v54, v54
    v_exp_f32 v55, v55
    s_nop 1
    v_cvt_pk_bf16_f32 v72, v40, v41
    v_cvt_pk_bf16_f32 v73, v42, v43
    v_cvt_pk_bf16_f32 v74, v44, v45
    v_cvt_pk_bf16_f32 v75, v46, v47
    v_cvt_pk_bf16_f32 v76, v48, v49
    v_cvt_pk_bf16_f32 v77, v50, v51
    v_cvt_pk_bf16_f32 v78, v52, v53
    v_cvt_pk_bf16_f32 v79, v54, v55
    s_nop 1
    v_mfma_f32_32x32x16_bf16 v[200:215], a[124:127], v[72:75], v[200:215]
    v_mfma_f32_32x32x16_bf16 v[200:215], a[128:131], v[76:79], v[200:215]
    s_nop 15
slk_64:
    s_sub_u32 s45, s44, 3
    s_cmp_gt_u32 s45, 8
    s_cbranch_scc1 slk_68
    v_mfma_f32_32x32x16_bf16 v[40:55], a[100:103], v[160:163], 0
    v_mfma_f32_32x32x16_bf16 v[40:55], a[104:107], v[164:167], v[40:55]
    s_nop 15
    s_cmp_eq_u32 s45, 0
    s_cbranch_scc0 sln_70
    v_cmp_lt_i32 vcc, 0, v100
    s_nop 1
    v_cndmask_b32 v40, v101, v40, vcc
    v_cmp_lt_i32 vcc, -1, v100
    s_nop 1
    v_cndmask_b32 v41, v101, v41, vcc
    v_cmp_lt_i32 vcc, -2, v100
    s_nop 1
    v_cndmask_b32 v42, v101, v42, vcc
    v_cmp_lt_i32 vcc, -3, v100
    s_nop 1
    v_cndmask_b32 v43, v101, v43, vcc
    v_cmp_lt_i32 vcc, -8, v100
    s_nop 1
    v_cndmask_b32 v44, v101, v44, vcc
    v_cmp_lt_i32 vcc, -9, v100
    s_nop 1
    v_cndmask_b32 v45, v101, v45, vcc
    v_cmp_lt_i32 vcc, -10, v100
    s_nop 1
    v_cndmask_b32 v46, v101, v46, vcc
    v_cmp_lt_i32 vcc, -11, v100
    s_nop 1
    v_cndmask_b32 v47, v101, v47, vcc
    v_cmp_lt_i32 vcc, -16, v100
    s_nop 1
    v_cndmask_b32 v48, v101, v48, vcc
    v_cmp_lt_i32 vcc, -17, v100
    s_nop 1
    v_cndmask_b32 v49, v101, v49, vcc
    v_cmp_lt_i32 vcc, -18, v100
    s_nop 1
    v_cndmask_b32 v50, v101, v50, vcc
    v_cmp_lt_i32 vcc, -19, v100
    s_nop 1
    v_cndmask_b32 v51, v101, v51, vcc
    v_cmp_lt_i32 vcc, -24, v100
    s_nop 1
    v_cndmask_b32 v52, v101, v52, vcc
    v_cmp_lt_i32 vcc, -25, v100
    s_nop 1
    v_cndmask_b32 v53, v101, v53, vcc
    v_cmp_lt_i32 vcc, -26, v100
    s_nop 1
    v_cndmask_b32 v54, v101, v54, vcc
    v_cmp_lt_i32 vcc, -27, v100
    s_nop 1
    v_cndmask_b32 v55, v101, v55, vcc
sln_70:
    s_cmp_eq_u32 s45, 8
    s_cbranch_scc0 sln_71
    v_cmp_ge_i32 vcc, 0, v100
    s_nop 1
    v_cndmask_b32 v40, v101, v40, vcc
    v_cmp_ge_i32 vcc, -1, v100
    s_nop 1
    v_cndmask_b32 v41, v101, v41, vcc
    v_cmp_ge_i32 vcc, -2, v100
    s_nop 1
    v_cndmask_b32 v42, v101, v42, vcc
    v_cmp_ge_i32 vcc, -3, v100
    s_nop 1
    v_cndmask_b32 v43, v101, v43, vcc
    v_cmp_ge_i32 vcc, -8, v100
    s_nop 1
    v_cndmask_b32 v44, v101, v44, vcc
    v_cmp_ge_i32 vcc, -9, v100
    s_nop 1
    v_cndmask_b32 v45, v101, v45, vcc
    v_cmp_ge_i32 vcc, -10, v100
    s_nop 1
    v_cndmask_b32 v46, v101, v46, vcc
    v_cmp_ge_i32 vcc, -11, v100
    s_nop 1
    v_cndmask_b32 v47, v101, v47, vcc
    v_cmp_ge_i32 vcc, -16, v100
    s_nop 1
    v_cndmask_b32 v48, v101, v48, vcc
    v_cmp_ge_i32 vcc, -17, v100
    s_nop 1
    v_cndmask_b32 v49, v101, v49, vcc
    v_cmp_ge_i32 vcc, -18, v100
    s_nop 1
    v_cndmask_b32 v50, v101, v50, vcc
    v_cmp_ge_i32 vcc, -19, v100
    s_nop 1
    v_cndmask_b32 v51, v101, v51, vcc
    v_cmp_ge_i32 vcc, -24, v100
    s_nop 1
    v_cndmask_b32 v52, v101, v52, vcc
    v_cmp_ge_i32 vcc, -25, v100
    s_nop 1
    v_cndmask_b32 v53, v101, v53, vcc
    v_cmp_ge_i32 vcc, -26, v100
    s_nop 1
    v_cndmask_b32 v54, v101, v54, vcc
    v_cmp_ge_i32 vcc, -27, v100
    s_nop 1
    v_cndmask_b32 v55, v101, v55, vcc
sln_71:
    s_cmp_eq_u32 s43, 0
    s_cbranch_scc0 slf_69
    v_max_f32 v99, v99, v40
    v_max_f32 v99, v99, v41
    v_max_f32 v99, v99, v42
    v_max_f32 v99, v99, v43
    v_max_f32 v99, v99, v44
    v_max_f32 v99, v99, v45
    v_max_f32 v99, v99, v46
    v_max_f32 v99, v99, v47
    v_max_f32 v99, v99, v48
    v_max_f32 v99, v99, v49
    v_max_f32 v99, v99, v50
    v_max_f32 v99, v99, v51
    v_max_f32 v99, v99, v52
    v_max_f32 v99, v99, v53
    v_max_f32 v99, v99, v54
    v_max_f32 v99, v99, v55
    s_branch slk_68
slf_69:
    v_sub_f32 v40, v40, v99
    v_sub_f32 v41, v41, v99
    v_sub_f32 v42, v42, v99
    v_sub_f32 v43, v43, v99
    v_sub_f32 v44, v44, v99
    v_sub_f32 v45, v45, v99
    v_sub_f32 v46, v46, v99
    v_sub_f32 v47, v47, v99
    v_sub_f32 v48, v48, v99
    v_sub_f32 v49, v49, v99
    v_sub_f32 v50, v50, v99
    v_sub_f32 v51, v51, v99
    v_sub_f32 v52, v52, v99
    v_sub_f32 v53, v53, v99
    v_sub_f32 v54, v54, v99
    v_sub_f32 v55, v55, v99
    v_exp_f32 v40, v40
    v_exp_f32 v41, v41
    v_exp_f32 v42, v42
    v_exp_f32 v43, v43
    v_exp_f32 v44, v44
    v_exp_f32 v45, v45
    v_exp_f32 v46, v46
    v_exp_f32 v47, v47
    v_exp_f32 v48, v48
    v_exp_f32 v49, v49
    v_exp_f32 v50, v50
    v_exp_f32 v51, v51
    v_exp_f32 v52, v52
    v_exp_f32 v53, v53
    v_exp_f32 v54, v54
    v_exp_f32 v55, v55
    s_nop 1
    v_cvt_pk_bf16_f32 v72, v40, v41
    v_cvt_pk_bf16_f32 v73, v42, v43
    v_cvt_pk_bf16_f32 v74, v44, v45
    v_cvt_pk_bf16_f32 v75, v46, v47
    v_cvt_pk_bf16_f32 v76, v48, v49
    v_cvt_pk_bf16_f32 v77, v50, v51
    v_cvt_pk_bf16_f32 v78, v52, v53
    v_cvt_pk_bf16_f32 v79, v54, v55
    s_nop 1
    v_mfma_f32_32x32x16_bf16 v[216:231], a[124:127], v[72:75], v[216:231]
    v_mfma_f32_32x32x16_bf16 v[216:231], a[128:131], v[76:79], v[216:231]
    s_nop 15
slk_68:
slt_55:
    s_lshl_b32 s44, s61, 2
    s_add_u32 s44, s44, 2
    s_cmp_lt_u32 s44, s42
    s_cbranch_scc1 slt_72
    v_add_u32 v102, s46, v114
    v_add_u32 v103, s46, v84
    v_add_u32 v104, s46, v85
    ds_read_b64_tr_b16 a[100:101], v102
    ds_read_b64_tr_b16 a[102:103], v102 offset:1024
    ds_read_b64_tr_b16 a[104:105], v102 offset:4096
    ds_read_b128 a[124:127], v103
    ds_read_b128 a[128:131], v104
    s_waitcnt lgkmcnt(0)
    s_sub_u32 s45, s44, 0
    s_cmp_gt_u32 s45, 8
    s_cbranch_scc1 slk_73
    v_mfma_f32_32x32x16_bf16 v[40:55], a[100:103], v[136:139], 0
    v_mfma_f32_32x32x16_bf16 v[40:55], a[104:107], v[140:143], v[40:55]
    s_nop 15
    s_cmp_eq_u32 s45, 0
    s_cbranch_scc0 sln_75
    v_cmp_lt_i32 vcc, 0, v100
    s_nop 1
    v_cndmask_b32 v40, v101, v40, vcc
    v_cmp_lt_i32 vcc, -1, v100
    s_nop 1
    v_cndmask_b32 v41, v101, v41, vcc
    v_cmp_lt_i32 vcc, -2, v100
    s_nop 1
    v_cndmask_b32 v42, v101, v42, vcc
    v_cmp_lt_i32 vcc, -3, v100
    s_nop 1
    v_cndmask_b32 v43, v101, v43, vcc
    v_cmp_lt_i32 vcc, -8, v100
    s_nop 1
    v_cndmask_b32 v44, v101, v44, vcc
    v_cmp_lt_i32 vcc, -9, v100
    s_nop 1
    v_cndmask_b32 v45, v101, v45, vcc
    v_cmp_lt_i32 vcc, -10, v100
    s_nop 1
    v_cndmask_b32 v46, v101, v46, vcc
    v_cmp_lt_i32 vcc, -11, v100
    s_nop 1
    v_cndmask_b32 v47, v101, v47, vcc
    v_cmp_lt_i32 vcc, -16, v100
    s_nop 1
    v_cndmask_b32 v48, v101, v48, vcc
    v_cmp_lt_i32 vcc, -17, v100
    s_nop 1
    v_cndmask_b32 v49, v101, v49, vcc
    v_cmp_lt_i32 vcc, -18, v100
    s_nop 1
    v_cndmask_b32 v50, v101, v50, vcc
    v_cmp_lt_i32 vcc, -19, v100
    s_nop 1
    v_cndmask_b32 v51, v101, v51, vcc
    v_cmp_lt_i32 vcc, -24, v100
    s_nop 1
    v_cndmask_b32 v52, v101, v52, vcc
    v_cmp_lt_i32 vcc, -25, v100
    s_nop 1
    v_cndmask_b32 v53, v101, v53, vcc
    v_cmp_lt_i32 vcc, -26, v100
    s_nop 1
    v_cndmask_b32 v54, v101, v54, vcc
    v_cmp_lt_i32 vcc, -27, v100
    s_nop 1
    v_cndmask_b32 v55, v101, v55, vcc
sln_75:
    s_cmp_eq_u32 s45, 8
    s_cbranch_scc0 sln_76
    v_cmp_ge_i32 vcc, 0, v100
    s_nop 1
    v_cndmask_b32 v40, v101, v40, vcc
    v_cmp_ge_i32 vcc, -1, v100
    s_nop 1
    v_cndmask_b32 v41, v101, v41, vcc
    v_cmp_ge_i32 vcc, -2, v100
    s_nop 1
    v_cndmask_b32 v42, v101, v42, vcc
    v_cmp_ge_i32 vcc, -3, v100
    s_nop 1
    v_cndmask_b32 v43, v101, v43, vcc
    v_cmp_ge_i32 vcc, -8, v100
    s_nop 1
    v_cndmask_b32 v44, v101, v44, vcc
    v_cmp_ge_i32 vcc, -9, v100
    s_nop 1
    v_cndmask_b32 v45, v101, v45, vcc
    v_cmp_ge_i32 vcc, -10, v100
    s_nop 1
    v_cndmask_b32 v46, v101, v46, vcc
    v_cmp_ge_i32 vcc, -11, v100
    s_nop 1
    v_cndmask_b32 v47, v101, v47, vcc
    v_cmp_ge_i32 vcc, -16, v100
    s_nop 1
    v_cndmask_b32 v48, v101, v48, vcc
    v_cmp_ge_i32 vcc, -17, v100
    s_nop 1
    v_cndmask_b32 v49, v101, v49, vcc
    v_cmp_ge_i32 vcc, -18, v100
    s_nop 1
    v_cndmask_b32 v50, v101, v50, vcc
    v_cmp_ge_i32 vcc, -19, v100
    s_nop 1
    v_cndmask_b32 v51, v101, v51, vcc
    v_cmp_ge_i32 vcc, -24, v100
    s_nop 1
    v_cndmask_b32 v52, v101, v52, vcc
    v_cmp_ge_i32 vcc, -25, v100
    s_nop 1
    v_cndmask_b32 v53, v101, v53, vcc
    v_cmp_ge_i32 vcc, -26, v100
    s_nop 1
    v_cndmask_b32 v54, v101, v54, vcc
    v_cmp_ge_i32 vcc, -27, v100
    s_nop 1
    v_cndmask_b32 v55, v101, v55, vcc
sln_76:
    s_cmp_eq_u32 s43, 0
    s_cbranch_scc0 slf_74
    v_max_f32 v96, v96, v40
    v_max_f32 v96, v96, v41
    v_max_f32 v96, v96, v42
    v_max_f32 v96, v96, v43
    v_max_f32 v96, v96, v44
    v_max_f32 v96, v96, v45
    v_max_f32 v96, v96, v46
    v_max_f32 v96, v96, v47
    v_max_f32 v96, v96, v48
    v_max_f32 v96, v96, v49
    v_max_f32 v96, v96, v50
    v_max_f32 v96, v96, v51
    v_max_f32 v96, v96, v52
    v_max_f32 v96, v96, v53
    v_max_f32 v96, v96, v54
    v_max_f32 v96, v96, v55
    s_branch slk_73
slf_74:
    v_sub_f32 v40, v40, v96
    v_sub_f32 v41, v41, v96
    v_sub_f32 v42, v42, v96
    v_sub_f32 v43, v43, v96
    v_sub_f32 v44, v44, v96
    v_sub_f32 v45, v45, v96
    v_sub_f32 v46, v46, v96
    v_sub_f32 v47, v47, v96
    v_sub_f32 v48, v48, v96
    v_sub_f32 v49, v49, v96
    v_sub_f32 v50, v50, v96
    v_sub_f32 v51, v51, v96
    v_sub_f32 v52, v52, v96
    v_sub_f32 v53, v53, v96
    v_sub_f32 v54, v54, v96
    v_sub_f32 v55, v55, v96
    v_exp_f32 v40, v40
    v_exp_f32 v41, v41
    v_exp_f32 v42, v42
    v_exp_f32 v43, v43
    v_exp_f32 v44, v44
    v_exp_f32 v45, v45
    v_exp_f32 v46, v46
    v_exp_f32 v47, v47
    v_exp_f32 v48, v48
    v_exp_f32 v49, v49
    v_exp_f32 v50, v50
    v_exp_f32 v51, v51
    v_exp_f32 v52, v52
    v_exp_f32 v53, v53
    v_exp_f32 v54, v54
    v_exp_f32 v55, v55
    s_nop 1
    v_cvt_pk_bf16_f32 v72, v40, v41
    v_cvt_pk_bf16_f32 v73, v42, v43
    v_cvt_pk_bf16_f32 v74, v44, v45
    v_cvt_pk_bf16_f32 v75, v46, v47
    v_cvt_pk_bf16_f32 v76, v48, v49
    v_cvt_pk_bf16_f32 v77, v50, v51
    v_cvt_pk_bf16_f32 v78, v52, v53
    v_cvt_pk_bf16_f32 v79, v54, v55
    s_nop 1
    v_mfma_f32_32x32x16_bf16 v[168:183], a[124:127], v[72:75], v[168:183]
    v_mfma_f32_32x32x16_bf16 v[168:183], a[128:131], v[76:79], v[168:183]
    s_nop 15
slk_73:
    s_sub_u32 s45, s44, 1
    s_cmp_gt_u32 s45, 8
    s_cbranch_scc1 slk_77
    v_mfma_f32_32x32x16_bf16 v[40:55], a[100:103], v[144:147], 0
    v_mfma_f32_32x32x16_bf16 v[40:55], a[104:107], v[148:151], v[40:55]
    s_nop 15
    s_cmp_eq_u32 s45, 0
    s_cbranch_scc0 sln_79
    v_cmp_lt_i32 vcc, 0, v100
    s_nop 1
    v_cndmask_b32 v40, v101, v40, vcc
    v_cmp_lt_i32 vcc, -1, v100
    s_nop 1
    v_cndmask_b32 v41, v101, v41, vcc
    v_cmp_lt_i32 vcc, -2, v100
    s_nop 1
    v_cndmask_b32 v42, v101, v42, vcc
    v_cmp_lt_i32 vcc, -3, v100
    s_nop 1
    v_cndmask_b32 v43, v101, v43, vcc
    v_cmp_lt_i32 vcc, -8, v100
    s_nop 1
    v_cndmask_b32 v44, v101, v44, vcc
    v_cmp_lt_i32 vcc, -9, v100
    s_nop 1
    v_cndmask_b32 v45, v101, v45, vcc
    v_cmp_lt_i32 vcc, -10, v100
    s_nop 1
    v_cndmask_b32 v46, v101, v46, vcc
    v_cmp_lt_i32 vcc, -11, v100
    s_nop 1
    v_cndmask_b32 v47, v101, v47, vcc
    v_cmp_lt_i32 vcc, -16, v100
    s_nop 1
    v_cndmask_b32 v48, v101, v48, vcc
    v_cmp_lt_i32 vcc, -17, v100
    s_nop 1
    v_cndmask_b32 v49, v101, v49, vcc
    v_cmp_lt_i32 vcc, -18, v100
    s_nop 1
    v_cndmask_b32 v50, v101, v50, vcc
    v_cmp_lt_i32 vcc, -19, v100
    s_nop 1
    v_cndmask_b32 v51, v101, v51, vcc
    v_cmp_lt_i32 vcc, -24, v100
    s_nop 1
    v_cndmask_b32 v52, v101, v52, vcc
    v_cmp_lt_i32 vcc, -25, v100
    s_nop 1
    v_cndmask_b32 v53, v101, v53, vcc
    v_cmp_lt_i32 vcc, -26, v100
    s_nop 1
    v_cndmask_b32 v54, v101, v54, vcc
    v_cmp_lt_i32 vcc, -27, v100
    s_nop 1
    v_cndmask_b32 v55, v101, v55, vcc
sln_79:
    s_cmp_eq_u32 s45, 8
    s_cbranch_scc0 sln_80
    v_cmp_ge_i32 vcc, 0, v100
    s_nop 1
    v_cndmask_b32 v40, v101, v40, vcc
    v_cmp_ge_i32 vcc, -1, v100
    s_nop 1
    v_cndmask_b32 v41, v101, v41, vcc
    v_cmp_ge_i32 vcc, -2, v100
    s_nop 1
    v_cndmask_b32 v42, v101, v42, vcc
    v_cmp_ge_i32 vcc, -3, v100
    s_nop 1
    v_cndmask_b32 v43, v101, v43, vcc
    v_cmp_ge_i32 vcc, -8, v100
    s_nop 1
    v_cndmask_b32 v44, v101, v44, vcc
    v_cmp_ge_i32 vcc, -9, v100
    s_nop 1
    v_cndmask_b32 v45, v101, v45, vcc
    v_cmp_ge_i32 vcc, -10, v100
    s_nop 1
    v_cndmask_b32 v46, v101, v46, vcc
    v_cmp_ge_i32 vcc, -11, v100
    s_nop 1
    v_cndmask_b32 v47, v101, v47, vcc
    v_cmp_ge_i32 vcc, -16, v100
    s_nop 1
    v_cndmask_b32 v48, v101, v48, vcc
    v_cmp_ge_i32 vcc, -17, v100
    s_nop 1
    v_cndmask_b32 v49, v101, v49, vcc
    v_cmp_ge_i32 vcc, -18, v100
    s_nop 1
    v_cndmask_b32 v50, v101, v50, vcc
    v_cmp_ge_i32 vcc, -19, v100
    s_nop 1
    v_cndmask_b32 v51, v101, v51, vcc
    v_cmp_ge_i32 vcc, -24, v100
    s_nop 1
    v_cndmask_b32 v52, v101, v52, vcc
    v_cmp_ge_i32 vcc, -25, v100
    s_nop 1
    v_cndmask_b32 v53, v101, v53, vcc
    v_cmp_ge_i32 vcc, -26, v100
    s_nop 1
    v_cndmask_b32 v54, v101, v54, vcc
    v_cmp_ge_i32 vcc, -27, v100
    s_nop 1
    v_cndmask_b32 v55, v101, v55, vcc
sln_80:
    s_cmp_eq_u32 s43, 0
    s_cbranch_scc0 slf_78
    v_max_f32 v97, v97, v40
    v_max_f32 v97, v97, v41
    v_max_f32 v97, v97, v42
    v_max_f32 v97, v97, v43
    v_max_f32 v97, v97, v44
    v_max_f32 v97, v97, v45
    v_max_f32 v97, v97, v46
    v_max_f32 v97, v97, v47
    v_max_f32 v97, v97, v48
    v_max_f32 v97, v97, v49
    v_max_f32 v97, v97, v50
    v_max_f32 v97, v97, v51
    v_max_f32 v97, v97, v52
    v_max_f32 v97, v97, v53
    v_max_f32 v97, v97, v54
    v_max_f32 v97, v97, v55
    s_branch slk_77
slf_78:
    v_sub_f32 v40, v40, v97
    v_sub_f32 v41, v41, v97
    v_sub_f32 v42, v42, v97
    v_sub_f32 v43, v43, v97
    v_sub_f32 v44, v44, v97
    v_sub_f32 v45, v45, v97
    v_sub_f32 v46, v46, v97
    v_sub_f32 v47, v47, v97
    v_sub_f32 v48, v48, v97
    v_sub_f32 v49, v49, v97
    v_sub_f32 v50, v50, v97
    v_sub_f32 v51, v51, v97
    v_sub_f32 v52, v52, v97
    v_sub_f32 v53, v53, v97
    v_sub_f32 v54, v54, v97
    v_sub_f32 v55, v55, v97
    v_exp_f32 v40, v40
    v_exp_f32 v41, v41
    v_exp_f32 v42, v42
    v_exp_f32 v43, v43
    v_exp_f32 v44, v44
    v_exp_f32 v45, v45
    v_exp_f32 v46, v46
    v_exp_f32 v47, v47
    v_exp_f32 v48, v48
    v_exp_f32 v49, v49
    v_exp_f32 v50, v50
    v_exp_f32 v51, v51
    v_exp_f32 v52, v52
    v_exp_f32 v53, v53
    v_exp_f32 v54, v54
    v_exp_f32 v55, v55
    s_nop 1
    v_cvt_pk_bf16_f32 v72, v40, v41
    v_cvt_pk_bf16_f32 v73, v42, v43
    v_cvt_pk_bf16_f32 v74, v44, v45
    v_cvt_pk_bf16_f32 v75, v46, v47
    v_cvt_pk_bf16_f32 v76, v48, v49
    v_cvt_pk_bf16_f32 v77, v50, v51
    v_cvt_pk_bf16_f32 v78, v52, v53
    v_cvt_pk_bf16_f32 v79, v54, v55
    s_nop 1
    v_mfma_f32_32x32x16_bf16 v[184:199], a[124:127], v[72:75], v[184:199]
    v_mfma_f32_32x32x16_bf16 v[184:199], a[128:131], v[76:79], v[184:199]
    s_nop 15
slk_77:
    s_sub_u32 s45, s44, 2
    s_cmp_gt_u32 s45, 8
    s_cbranch_scc1 slk_81
    v_mfma_f32_32x32x16_bf16 v[40:55], a[100:103], v[152:155], 0
    v_mfma_f32_32x32x16_bf16 v[40:55], a[104:107], v[156:159], v[40:55]
    s_nop 15
    s_cmp_eq_u32 s45, 0
    s_cbranch_scc0 sln_83
    v_cmp_lt_i32 vcc, 0, v100
    s_nop 1
    v_cndmask_b32 v40, v101, v40, vcc
    v_cmp_lt_i32 vcc, -1, v100
    s_nop 1
    v_cndmask_b32 v41, v101, v41, vcc
    v_cmp_lt_i32 vcc, -2, v100
    s_nop 1
    v_cndmask_b32 v42, v101, v42, vcc
    v_cmp_lt_i32 vcc, -3, v100
    s_nop 1
    v_cndmask_b32 v43, v101, v43, vcc
    v_cmp_lt_i32 vcc, -8, v100
    s_nop 1
    v_cndmask_b32 v44, v101, v44, vcc
    v_cmp_lt_i32 vcc, -9, v100
    s_nop 1
    v_cndmask_b32 v45, v101, v45, vcc
    v_cmp_lt_i32 vcc, -10, v100
    s_nop 1
    v_cndmask_b32 v46, v101, v46, vcc
    v_cmp_lt_i32 vcc, -11, v100
    s_nop 1
    v_cndmask_b32 v47, v101, v47, vcc
    v_cmp_lt_i32 vcc, -16, v100
    s_nop 1
    v_cndmask_b32 v48, v101, v48, vcc
    v_cmp_lt_i32 vcc, -17, v100
    s_nop 1
    v_cndmask_b32 v49, v101, v49, vcc
    v_cmp_lt_i32 vcc, -18, v100
    s_nop 1
    v_cndmask_b32 v50, v101, v50, vcc
    v_cmp_lt_i32 vcc, -19, v100
    s_nop 1
    v_cndmask_b32 v51, v101, v51, vcc
    v_cmp_lt_i32 vcc, -24, v100
    s_nop 1
    v_cndmask_b32 v52, v101, v52, vcc
    v_cmp_lt_i32 vcc, -25, v100
    s_nop 1
    v_cndmask_b32 v53, v101, v53, vcc
    v_cmp_lt_i32 vcc, -26, v100
    s_nop 1
    v_cndmask_b32 v54, v101, v54, vcc
    v_cmp_lt_i32 vcc, -27, v100
    s_nop 1
    v_cndmask_b32 v55, v101, v55, vcc
sln_83:
    s_cmp_eq_u32 s45, 8
    s_cbranch_scc0 sln_84
    v_cmp_ge_i32 vcc, 0, v100
    s_nop 1
    v_cndmask_b32 v40, v101, v40, vcc
    v_cmp_ge_i32 vcc, -1, v100
    s_nop 1
    v_cndmask_b32 v41, v101, v41, vcc
    v_cmp_ge_i32 vcc, -2, v100
    s_nop 1
    v_cndmask_b32 v42, v101, v42, vcc
    v_cmp_ge_i32 vcc, -3, v100
    s_nop 1
    v_cndmask_b32 v43, v101, v43, vcc
    v_cmp_ge_i32 vcc, -8, v100
    s_nop 1
    v_cndmask_b32 v44, v101, v44, vcc
    v_cmp_ge_i32 vcc, -9, v100
    s_nop 1
    v_cndmask_b32 v45, v101, v45, vcc
    v_cmp_ge_i32 vcc, -10, v100
    s_nop 1
    v_cndmask_b32 v46, v101, v46, vcc
    v_cmp_ge_i32 vcc, -11, v100
    s_nop 1
    v_cndmask_b32 v47, v101, v47, vcc
    v_cmp_ge_i32 vcc, -16, v100
    s_nop 1
    v_cndmask_b32 v48, v101, v48, vcc
    v_cmp_ge_i32 vcc, -17, v100
    s_nop 1
    v_cndmask_b32 v49, v101, v49, vcc
    v_cmp_ge_i32 vcc, -18, v100
    s_nop 1
    v_cndmask_b32 v50, v101, v50, vcc
    v_cmp_ge_i32 vcc, -19, v100
    s_nop 1
    v_cndmask_b32 v51, v101, v51, vcc
    v_cmp_ge_i32 vcc, -24, v100
    s_nop 1
    v_cndmask_b32 v52, v101, v52, vcc
    v_cmp_ge_i32 vcc, -25, v100
    s_nop 1
    v_cndmask_b32 v53, v101, v53, vcc
    v_cmp_ge_i32 vcc, -26, v100
    s_nop 1
    v_cndmask_b32 v54, v101, v54, vcc
    v_cmp_ge_i32 vcc, -27, v100
    s_nop 1
    v_cndmask_b32 v55, v101, v55, vcc
sln_84:
    s_cmp_eq_u32 s43, 0
    s_cbranch_scc0 slf_82
    v_max_f32 v98, v98, v40
    v_max_f32 v98, v98, v41
    v_max_f32 v98, v98, v42
    v_max_f32 v98, v98, v43
    v_max_f32 v98, v98, v44
    v_max_f32 v98, v98, v45
    v_max_f32 v98, v98, v46
    v_max_f32 v98, v98, v47
    v_max_f32 v98, v98, v48
    v_max_f32 v98, v98, v49
    v_max_f32 v98, v98, v50
    v_max_f32 v98, v98, v51
    v_max_f32 v98, v98, v52
    v_max_f32 v98, v98, v53
    v_max_f32 v98, v98, v54
    v_max_f32 v98, v98, v55
    s_branch slk_81
slf_82:
    v_sub_f32 v40, v40, v98
    v_sub_f32 v41, v41, v98
    v_sub_f32 v42, v42, v98
    v_sub_f32 v43, v43, v98
    v_sub_f32 v44, v44, v98
    v_sub_f32 v45, v45, v98
    v_sub_f32 v46, v46, v98
    v_sub_f32 v47, v47, v98
    v_sub_f32 v48, v48, v98
    v_sub_f32 v49, v49, v98
    v_sub_f32 v50, v50, v98
    v_sub_f32 v51, v51, v98
    v_sub_f32 v52, v52, v98
    v_sub_f32 v53, v53, v98
    v_sub_f32 v54, v54, v98
    v_sub_f32 v55, v55, v98
    v_exp_f32 v40, v40
    v_exp_f32 v41, v41
    v_exp_f32 v42, v42
    v_exp_f32 v43, v43
    v_exp_f32 v44, v44
    v_exp_f32 v45, v45
    v_exp_f32 v46, v46
    v_exp_f32 v47, v47
    v_exp_f32 v48, v48
    v_exp_f32 v49, v49
    v_exp_f32 v50, v50
    v_exp_f32 v51, v51
    v_exp_f32 v52, v52
    v_exp_f32 v53, v53
    v_exp_f32 v54, v54
    v_exp_f32 v55, v55
    s_nop 1
    v_cvt_pk_bf16_f32 v72, v40, v41
    v_cvt_pk_bf16_f32 v73, v42, v43
    v_cvt_pk_bf16_f32 v74, v44, v45
    v_cvt_pk_bf16_f32 v75, v46, v47
    v_cvt_pk_bf16_f32 v76, v48, v49
    v_cvt_pk_bf16_f32 v77, v50, v51
    v_cvt_pk_bf16_f32 v78, v52, v53
    v_cvt_pk_bf16_f32 v79, v54, v55
    s_nop 1
    v_mfma_f32_32x32x16_bf16 v[200:215], a[124:127], v[72:75], v[200:215]
    v_mfma_f32_32x32x16_bf16 v[200:215], a[128:131], v[76:79], v[200:215]
    s_nop 15
slk_81:
    s_sub_u32 s45, s44, 3
    s_cmp_gt_u32 s45, 8
    s_cbranch_scc1 slk_85
    v_mfma_f32_32x32x16_bf16 v[40:55], a[100:103], v[160:163], 0
    v_mfma_f32_32x32x16_bf16 v[40:55], a[104:107], v[164:167], v[40:55]
    s_nop 15
    s_cmp_eq_u32 s45, 0
    s_cbranch_scc0 sln_87
    v_cmp_lt_i32 vcc, 0, v100
    s_nop 1
    v_cndmask_b32 v40, v101, v40, vcc
    v_cmp_lt_i32 vcc, -1, v100
    s_nop 1
    v_cndmask_b32 v41, v101, v41, vcc
    v_cmp_lt_i32 vcc, -2, v100
    s_nop 1
    v_cndmask_b32 v42, v101, v42, vcc
    v_cmp_lt_i32 vcc, -3, v100
    s_nop 1
    v_cndmask_b32 v43, v101, v43, vcc
    v_cmp_lt_i32 vcc, -8, v100
    s_nop 1
    v_cndmask_b32 v44, v101, v44, vcc
    v_cmp_lt_i32 vcc, -9, v100
    s_nop 1
    v_cndmask_b32 v45, v101, v45, vcc
    v_cmp_lt_i32 vcc, -10, v100
    s_nop 1
    v_cndmask_b32 v46, v101, v46, vcc
    v_cmp_lt_i32 vcc, -11, v100
    s_nop 1
    v_cndmask_b32 v47, v101, v47, vcc
    v_cmp_lt_i32 vcc, -16, v100
    s_nop 1
    v_cndmask_b32 v48, v101, v48, vcc
    v_cmp_lt_i32 vcc, -17, v100
    s_nop 1
    v_cndmask_b32 v49, v101, v49, vcc
    v_cmp_lt_i32 vcc, -18, v100
    s_nop 1
    v_cndmask_b32 v50, v101, v50, vcc
    v_cmp_lt_i32 vcc, -19, v100
    s_nop 1
    v_cndmask_b32 v51, v101, v51, vcc
    v_cmp_lt_i32 vcc, -24, v100
    s_nop 1
    v_cndmask_b32 v52, v101, v52, vcc
    v_cmp_lt_i32 vcc, -25, v100
    s_nop 1
    v_cndmask_b32 v53, v101, v53, vcc
    v_cmp_lt_i32 vcc, -26, v100
    s_nop 1
    v_cndmask_b32 v54, v101, v54, vcc
    v_cmp_lt_i32 vcc, -27, v100
    s_nop 1
    v_cndmask_b32 v55, v101, v55, vcc
sln_87:
    s_cmp_eq_u32 s45, 8
    s_cbranch_scc0 sln_88
    v_cmp_ge_i32 vcc, 0, v100
    s_nop 1
    v_cndmask_b32 v40, v101, v40, vcc
    v_cmp_ge_i32 vcc, -1, v100
    s_nop 1
    v_cndmask_b32 v41, v101, v41, vcc
    v_cmp_ge_i32 vcc, -2, v100
    s_nop 1
    v_cndmask_b32 v42, v101, v42, vcc
    v_cmp_ge_i32 vcc, -3, v100
    s_nop 1
    v_cndmask_b32 v43, v101, v43, vcc
    v_cmp_ge_i32 vcc, -8, v100
    s_nop 1
    v_cndmask_b32 v44, v101, v44, vcc
    v_cmp_ge_i32 vcc, -9, v100
    s_nop 1
    v_cndmask_b32 v45, v101, v45, vcc
    v_cmp_ge_i32 vcc, -10, v100
    s_nop 1
    v_cndmask_b32 v46, v101, v46, vcc
    v_cmp_ge_i32 vcc, -11, v100
    s_nop 1
    v_cndmask_b32 v47, v101, v47, vcc
    v_cmp_ge_i32 vcc, -16, v100
    s_nop 1
    v_cndmask_b32 v48, v101, v48, vcc
    v_cmp_ge_i32 vcc, -17, v100
    s_nop 1
    v_cndmask_b32 v49, v101, v49, vcc
    v_cmp_ge_i32 vcc, -18, v100
    s_nop 1
    v_cndmask_b32 v50, v101, v50, vcc
    v_cmp_ge_i32 vcc, -19, v100
    s_nop 1
    v_cndmask_b32 v51, v101, v51, vcc
    v_cmp_ge_i32 vcc, -24, v100
    s_nop 1
    v_cndmask_b32 v52, v101, v52, vcc
    v_cmp_ge_i32 vcc, -25, v100
    s_nop 1
    v_cndmask_b32 v53, v101, v53, vcc
    v_cmp_ge_i32 vcc, -26, v100
    s_nop 1
    v_cndmask_b32 v54, v101, v54, vcc
    v_cmp_ge_i32 vcc, -27, v100
    s_nop 1
    v_cndmask_b32 v55, v101, v55, vcc
sln_88:
    s_cmp_eq_u32 s43, 0
    s_cbranch_scc0 slf_86
    v_max_f32 v99, v99, v40
    v_max_f32 v99, v99, v41
    v_max_f32 v99, v99, v42
    v_max_f32 v99, v99, v43
    v_max_f32 v99, v99, v44
    v_max_f32 v99, v99, v45
    v_max_f32 v99, v99, v46
    v_max_f32 v99, v99, v47
    v_max_f32 v99, v99, v48
    v_max_f32 v99, v99, v49
    v_max_f32 v99, v99, v50
    v_max_f32 v99, v99, v51
    v_max_f32 v99, v99, v52
    v_max_f32 v99, v99, v53
    v_max_f32 v99, v99, v54
    v_max_f32 v99, v99, v55
    s_branch slk_85
slf_86:
    v_sub_f32 v40, v40, v99
    v_sub_f32 v41, v41, v99
    v_sub_f32 v42, v42, v99
    v_sub_f32 v43, v43, v99
    v_sub_f32 v44, v44, v99
    v_sub_f32 v45, v45, v99
    v_sub_f32 v46, v46, v99
    v_sub_f32 v47, v47, v99
    v_sub_f32 v48, v48, v99
    v_sub_f32 v49, v49, v99
    v_sub_f32 v50, v50, v99
    v_sub_f32 v51, v51, v99
    v_sub_f32 v52, v52, v99
    v_sub_f32 v53, v53, v99
    v_sub_f32 v54, v54, v99
    v_sub_f32 v55, v55, v99
    v_exp_f32 v40, v40
    v_exp_f32 v41, v41
    v_exp_f32 v42, v42
    v_exp_f32 v43, v43
    v_exp_f32 v44, v44
    v_exp_f32 v45, v45
    v_exp_f32 v46, v46
    v_exp_f32 v47, v47
    v_exp_f32 v48, v48
    v_exp_f32 v49, v49
    v_exp_f32 v50, v50
    v_exp_f32 v51, v51
    v_exp_f32 v52, v52
    v_exp_f32 v53, v53
    v_exp_f32 v54, v54
    v_exp_f32 v55, v55
    s_nop 1
    v_cvt_pk_bf16_f32 v72, v40, v41
    v_cvt_pk_bf16_f32 v73, v42, v43
    v_cvt_pk_bf16_f32 v74, v44, v45
    v_cvt_pk_bf16_f32 v75, v46, v47
    v_cvt_pk_bf16_f32 v76, v48, v49
    v_cvt_pk_bf16_f32 v77, v50, v51
    v_cvt_pk_bf16_f32 v78, v52, v53
    v_cvt_pk_bf16_f32 v79, v54, v55
    s_nop 1
    v_mfma_f32_32x32x16_bf16 v[216:231], a[124:127], v[72:75], v[216:231]
    v_mfma_f32_32x32x16_bf16 v[216:231], a[128:131], v[76:79], v[216:231]
    s_nop 15
slk_85:
slt_72:
    s_lshl_b32 s44, s61, 2
    s_add_u32 s44, s44, 3
    s_cmp_lt_u32 s44, s42
    s_cbranch_scc1 slt_89
    v_add_u32 v102, s46, v115
    v_add_u32 v103, s46, v86
    v_add_u32 v104, s46, v87
    ds_read_b64_tr_b16 a[100:101], v102
    ds_read_b64_tr_b16 a[102:103], v102 offset:1024
    ds_read_b64_tr_b16 a[104:105], v102 offset:4096
    ds_read_b128 a[124:127], v103
    ds_read_b128 a[128:131], v104
    s_waitcnt lgkmcnt(0)
    s_sub_u32 s45, s44, 0
    s_cmp_gt_u32 s45, 8
    s_cbranch_scc1 slk_90
    v_mfma_f32_32x32x16_bf16 v[40:55], a[100:103], v[136:139], 0
    v_mfma_f32_32x32x16_bf16 v[40:55], a[104:107], v[140:143], v[40:55]
    s_nop 15
    s_cmp_eq_u32 s45, 0
    s_cbranch_scc0 sln_92
    v_cmp_lt_i32 vcc, 0, v100
    s_nop 1
    v_cndmask_b32 v40, v101, v40, vcc
    v_cmp_lt_i32 vcc, -1, v100
    s_nop 1
    v_cndmask_b32 v41, v101, v41, vcc
    v_cmp_lt_i32 vcc, -2, v100
    s_nop 1
    v_cndmask_b32 v42, v101, v42, vcc
    v_cmp_lt_i32 vcc, -3, v100
    s_nop 1
    v_cndmask_b32 v43, v101, v43, vcc
    v_cmp_lt_i32 vcc, -8, v100
    s_nop 1
    v_cndmask_b32 v44, v101, v44, vcc
    v_cmp_lt_i32 vcc, -9, v100
    s_nop 1
    v_cndmask_b32 v45, v101, v45, vcc
    v_cmp_lt_i32 vcc, -10, v100
    s_nop 1
    v_cndmask_b32 v46, v101, v46, vcc
    v_cmp_lt_i32 vcc, -11, v100
    s_nop 1
    v_cndmask_b32 v47, v101, v47, vcc
    v_cmp_lt_i32 vcc, -16, v100
    s_nop 1
    v_cndmask_b32 v48, v101, v48, vcc
    v_cmp_lt_i32 vcc, -17, v100
    s_nop 1
    v_cndmask_b32 v49, v101, v49, vcc
    v_cmp_lt_i32 vcc, -18, v100
    s_nop 1
    v_cndmask_b32 v50, v101, v50, vcc
    v_cmp_lt_i32 vcc, -19, v100
    s_nop 1
    v_cndmask_b32 v51, v101, v51, vcc
    v_cmp_lt_i32 vcc, -24, v100
    s_nop 1
    v_cndmask_b32 v52, v101, v52, vcc
    v_cmp_lt_i32 vcc, -25, v100
    s_nop 1
    v_cndmask_b32 v53, v101, v53, vcc
    v_cmp_lt_i32 vcc, -26, v100
    s_nop 1
    v_cndmask_b32 v54, v101, v54, vcc
    v_cmp_lt_i32 vcc, -27, v100
    s_nop 1
    v_cndmask_b32 v55, v101, v55, vcc
sln_92:
    s_cmp_eq_u32 s45, 8
    s_cbranch_scc0 sln_93
    v_cmp_ge_i32 vcc, 0, v100
    s_nop 1
    v_cndmask_b32 v40, v101, v40, vcc
    v_cmp_ge_i32 vcc, -1, v100
    s_nop 1
    v_cndmask_b32 v41, v101, v41, vcc
    v_cmp_ge_i32 vcc, -2, v100
    s_nop 1
    v_cndmask_b32 v42, v101, v42, vcc
    v_cmp_ge_i32 vcc, -3, v100
    s_nop 1
    v_cndmask_b32 v43, v101, v43, vcc
    v_cmp_ge_i32 vcc, -8, v100
    s_nop 1
    v_cndmask_b32 v44, v101, v44, vcc
    v_cmp_ge_i32 vcc, -9, v100
    s_nop 1
    v_cndmask_b32 v45, v101, v45, vcc
    v_cmp_ge_i32 vcc, -10, v100
    s_nop 1
    v_cndmask_b32 v46, v101, v46, vcc
    v_cmp_ge_i32 vcc, -11, v100
    s_nop 1
    v_cndmask_b32 v47, v101, v47, vcc
    v_cmp_ge_i32 vcc, -16, v100
    s_nop 1
    v_cndmask_b32 v48, v101, v48, vcc
    v_cmp_ge_i32 vcc, -17, v100
    s_nop 1
    v_cndmask_b32 v49, v101, v49, vcc
    v_cmp_ge_i32 vcc, -18, v100
    s_nop 1
    v_cndmask_b32 v50, v101, v50, vcc
    v_cmp_ge_i32 vcc, -19, v100
    s_nop 1
    v_cndmask_b32 v51, v101, v51, vcc
    v_cmp_ge_i32 vcc, -24, v100
    s_nop 1
    v_cndmask_b32 v52, v101, v52, vcc
    v_cmp_ge_i32 vcc, -25, v100
    s_nop 1
    v_cndmask_b32 v53, v101, v53, vcc
    v_cmp_ge_i32 vcc, -26, v100
    s_nop 1
    v_cndmask_b32 v54, v101, v54, vcc
    v_cmp_ge_i32 vcc, -27, v100
    s_nop 1
    v_cndmask_b32 v55, v101, v55, vcc
sln_93:
    s_cmp_eq_u32 s43, 0
    s_cbranch_scc0 slf_91
    v_max_f32 v96, v96, v40
    v_max_f32 v96, v96, v41
    v_max_f32 v96, v96, v42
    v_max_f32 v96, v96, v43
    v_max_f32 v96, v96, v44
    v_max_f32 v96, v96, v45
    v_max_f32 v96, v96, v46
    v_max_f32 v96, v96, v47
    v_max_f32 v96, v96, v48
    v_max_f32 v96, v96, v49
    v_max_f32 v96, v96, v50
    v_max_f32 v96, v96, v51
    v_max_f32 v96, v96, v52
    v_max_f32 v96, v96, v53
    v_max_f32 v96, v96, v54
    v_max_f32 v96, v96, v55
    s_branch slk_90
slf_91:
    v_sub_f32 v40, v40, v96
    v_sub_f32 v41, v41, v96
    v_sub_f32 v42, v42, v96
    v_sub_f32 v43, v43, v96
    v_sub_f32 v44, v44, v96
    v_sub_f32 v45, v45, v96
    v_sub_f32 v46, v46, v96
    v_sub_f32 v47, v47, v96
    v_sub_f32 v48, v48, v96
    v_sub_f32 v49, v49, v96
    v_sub_f32 v50, v50, v96
    v_sub_f32 v51, v51, v96
    v_sub_f32 v52, v52, v96
    v_sub_f32 v53, v53, v96
    v_sub_f32 v54, v54, v96
    v_sub_f32 v55, v55, v96
    v_exp_f32 v40, v40
    v_exp_f32 v41, v41
    v_exp_f32 v42, v42
    v_exp_f32 v43, v43
    v_exp_f32 v44, v44
    v_exp_f32 v45, v45
    v_exp_f32 v46, v46
    v_exp_f32 v47, v47
    v_exp_f32 v48, v48
    v_exp_f32 v49, v49
    v_exp_f32 v50, v50
    v_exp_f32 v51, v51
    v_exp_f32 v52, v52
    v_exp_f32 v53, v53
    v_exp_f32 v54, v54
    v_exp_f32 v55, v55
    s_nop 1
    v_cvt_pk_bf16_f32 v72, v40, v41
    v_cvt_pk_bf16_f32 v73, v42, v43
    v_cvt_pk_bf16_f32 v74, v44, v45
    v_cvt_pk_bf16_f32 v75, v46, v47
    v_cvt_pk_bf16_f32 v76, v48, v49
    v_cvt_pk_bf16_f32 v77, v50, v51
    v_cvt_pk_bf16_f32 v78, v52, v53
    v_cvt_pk_bf16_f32 v79, v54, v55
    s_nop 1
    v_mfma_f32_32x32x16_bf16 v[168:183], a[124:127], v[72:75], v[168:183]
    v_mfma_f32_32x32x16_bf16 v[168:183], a[128:131], v[76:79], v[168:183]
    s_nop 15
slk_90:
    s_sub_u32 s45, s44, 1
    s_cmp_gt_u32 s45, 8
    s_cbranch_scc1 slk_94
    v_mfma_f32_32x32x16_bf16 v[40:55], a[100:103], v[144:147], 0
    v_mfma_f32_32x32x16_bf16 v[40:55], a[104:107], v[148:151], v[40:55]
    s_nop 15
    s_cmp_eq_u32 s45, 0
    s_cbranch_scc0 sln_96
    v_cmp_lt_i32 vcc, 0, v100
    s_nop 1
    v_cndmask_b32 v40, v101, v40, vcc
    v_cmp_lt_i32 vcc, -1, v100
    s_nop 1
    v_cndmask_b32 v41, v101, v41, vcc
    v_cmp_lt_i32 vcc, -2, v100
    s_nop 1
    v_cndmask_b32 v42, v101, v42, vcc
    v_cmp_lt_i32 vcc, -3, v100
    s_nop 1
    v_cndmask_b32 v43, v101, v43, vcc
    v_cmp_lt_i32 vcc, -8, v100
    s_nop 1
    v_cndmask_b32 v44, v101, v44, vcc
    v_cmp_lt_i32 vcc, -9, v100
    s_nop 1
    v_cndmask_b32 v45, v101, v45, vcc
    v_cmp_lt_i32 vcc, -10, v100
    s_nop 1
    v_cndmask_b32 v46, v101, v46, vcc
    v_cmp_lt_i32 vcc, -11, v100
    s_nop 1
    v_cndmask_b32 v47, v101, v47, vcc
    v_cmp_lt_i32 vcc, -16, v100
    s_nop 1
    v_cndmask_b32 v48, v101, v48, vcc
    v_cmp_lt_i32 vcc, -17, v100
    s_nop 1
    v_cndmask_b32 v49, v101, v49, vcc
    v_cmp_lt_i32 vcc, -18, v100
    s_nop 1
    v_cndmask_b32 v50, v101, v50, vcc
    v_cmp_lt_i32 vcc, -19, v100
    s_nop 1
    v_cndmask_b32 v51, v101, v51, vcc
    v_cmp_lt_i32 vcc, -24, v100
    s_nop 1
    v_cndmask_b32 v52, v101, v52, vcc
    v_cmp_lt_i32 vcc, -25, v100
    s_nop 1
    v_cndmask_b32 v53, v101, v53, vcc
    v_cmp_lt_i32 vcc, -26, v100
    s_nop 1
    v_cndmask_b32 v54, v101, v54, vcc
    v_cmp_lt_i32 vcc, -27, v100
    s_nop 1
    v_cndmask_b32 v55, v101, v55, vcc
sln_96:
    s_cmp_eq_u32 s45, 8
    s_cbranch_scc0 sln_97
    v_cmp_ge_i32 vcc, 0, v100
    s_nop 1
    v_cndmask_b32 v40, v101, v40, vcc
    v_cmp_ge_i32 vcc, -1, v100
    s_nop 1
    v_cndmask_b32 v41, v101, v41, vcc
    v_cmp_ge_i32 vcc, -2, v100
    s_nop 1
    v_cndmask_b32 v42, v101, v42, vcc
    v_cmp_ge_i32 vcc, -3, v100
    s_nop 1
    v_cndmask_b32 v43, v101, v43, vcc
    v_cmp_ge_i32 vcc, -8, v100
    s_nop 1
    v_cndmask_b32 v44, v101, v44, vcc
    v_cmp_ge_i32 vcc, -9, v100
    s_nop 1
    v_cndmask_b32 v45, v101, v45, vcc
    v_cmp_ge_i32 vcc, -10, v100
    s_nop 1
    v_cndmask_b32 v46, v101, v46, vcc
    v_cmp_ge_i32 vcc, -11, v100
    s_nop 1
    v_cndmask_b32 v47, v101, v47, vcc
    v_cmp_ge_i32 vcc, -16, v100
    s_nop 1
    v_cndmask_b32 v48, v101, v48, vcc
    v_cmp_ge_i32 vcc, -17, v100
    s_nop 1
    v_cndmask_b32 v49, v101, v49, vcc
    v_cmp_ge_i32 vcc, -18, v100
    s_nop 1
    v_cndmask_b32 v50, v101, v50, vcc
    v_cmp_ge_i32 vcc, -19, v100
    s_nop 1
    v_cndmask_b32 v51, v101, v51, vcc
    v_cmp_ge_i32 vcc, -24, v100
    s_nop 1
    v_cndmask_b32 v52, v101, v52, vcc
    v_cmp_ge_i32 vcc, -25, v100
    s_nop 1
    v_cndmask_b32 v53, v101, v53, vcc
    v_cmp_ge_i32 vcc, -26, v100
    s_nop 1
    v_cndmask_b32 v54, v101, v54, vcc
    v_cmp_ge_i32 vcc, -27, v100
    s_nop 1
    v_cndmask_b32 v55, v101, v55, vcc
sln_97:
    s_cmp_eq_u32 s43, 0
    s_cbranch_scc0 slf_95
    v_max_f32 v97, v97, v40
    v_max_f32 v97, v97, v41
    v_max_f32 v97, v97, v42
    v_max_f32 v97, v97, v43
    v_max_f32 v97, v97, v44
    v_max_f32 v97, v97, v45
    v_max_f32 v97, v97, v46
    v_max_f32 v97, v97, v47
    v_max_f32 v97, v97, v48
    v_max_f32 v97, v97, v49
    v_max_f32 v97, v97, v50
    v_max_f32 v97, v97, v51
    v_max_f32 v97, v97, v52
    v_max_f32 v97, v97, v53
    v_max_f32 v97, v97, v54
    v_max_f32 v97, v97, v55
    s_branch slk_94
slf_95:
    v_sub_f32 v40, v40, v97
    v_sub_f32 v41, v41, v97
    v_sub_f32 v42, v42, v97
    v_sub_f32 v43, v43, v97
    v_sub_f32 v44, v44, v97
    v_sub_f32 v45, v45, v97
    v_sub_f32 v46, v46, v97
    v_sub_f32 v47, v47, v97
    v_sub_f32 v48, v48, v97
    v_sub_f32 v49, v49, v97
    v_sub_f32 v50, v50, v97
    v_sub_f32 v51, v51, v97
    v_sub_f32 v52, v52, v97
    v_sub_f32 v53, v53, v97
    v_sub_f32 v54, v54, v97
    v_sub_f32 v55, v55, v97
    v_exp_f32 v40, v40
    v_exp_f32 v41, v41
    v_exp_f32 v42, v42
    v_exp_f32 v43, v43
    v_exp_f32 v44, v44
    v_exp_f32 v45, v45
    v_exp_f32 v46, v46
    v_exp_f32 v47, v47
    v_exp_f32 v48, v48
    v_exp_f32 v49, v49
    v_exp_f32 v50, v50
    v_exp_f32 v51, v51
    v_exp_f32 v52, v52
    v_exp_f32 v53, v53
    v_exp_f32 v54, v54
    v_exp_f32 v55, v55
    s_nop 1
    v_cvt_pk_bf16_f32 v72, v40, v41
    v_cvt_pk_bf16_f32 v73, v42, v43
    v_cvt_pk_bf16_f32 v74, v44, v45
    v_cvt_pk_bf16_f32 v75, v46, v47
    v_cvt_pk_bf16_f32 v76, v48, v49
    v_cvt_pk_bf16_f32 v77, v50, v51
    v_cvt_pk_bf16_f32 v78, v52, v53
    v_cvt_pk_bf16_f32 v79, v54, v55
    s_nop 1
    v_mfma_f32_32x32x16_bf16 v[184:199], a[124:127], v[72:75], v[184:199]
    v_mfma_f32_32x32x16_bf16 v[184:199], a[128:131], v[76:79], v[184:199]
    s_nop 15
slk_94:
    s_sub_u32 s45, s44, 2
    s_cmp_gt_u32 s45, 8
    s_cbranch_scc1 slk_98
    v_mfma_f32_32x32x16_bf16 v[40:55], a[100:103], v[152:155], 0
    v_mfma_f32_32x32x16_bf16 v[40:55], a[104:107], v[156:159], v[40:55]
    s_nop 15
    s_cmp_eq_u32 s45, 0
    s_cbranch_scc0 sln_100
    v_cmp_lt_i32 vcc, 0, v100
    s_nop 1
    v_cndmask_b32 v40, v101, v40, vcc
    v_cmp_lt_i32 vcc, -1, v100
    s_nop 1
    v_cndmask_b32 v41, v101, v41, vcc
    v_cmp_lt_i32 vcc, -2, v100
    s_nop 1
    v_cndmask_b32 v42, v101, v42, vcc
    v_cmp_lt_i32 vcc, -3, v100
    s_nop 1
    v_cndmask_b32 v43, v101, v43, vcc
    v_cmp_lt_i32 vcc, -8, v100
    s_nop 1
    v_cndmask_b32 v44, v101, v44, vcc
    v_cmp_lt_i32 vcc, -9, v100
    s_nop 1
    v_cndmask_b32 v45, v101, v45, vcc
    v_cmp_lt_i32 vcc, -10, v100
    s_nop 1
    v_cndmask_b32 v46, v101, v46, vcc
    v_cmp_lt_i32 vcc, -11, v100
    s_nop 1
    v_cndmask_b32 v47, v101, v47, vcc
    v_cmp_lt_i32 vcc, -16, v100
    s_nop 1
    v_cndmask_b32 v48, v101, v48, vcc
    v_cmp_lt_i32 vcc, -17, v100
    s_nop 1
    v_cndmask_b32 v49, v101, v49, vcc
    v_cmp_lt_i32 vcc, -18, v100
    s_nop 1
    v_cndmask_b32 v50, v101, v50, vcc
    v_cmp_lt_i32 vcc, -19, v100
    s_nop 1
    v_cndmask_b32 v51, v101, v51, vcc
    v_cmp_lt_i32 vcc, -24, v100
    s_nop 1
    v_cndmask_b32 v52, v101, v52, vcc
    v_cmp_lt_i32 vcc, -25, v100
    s_nop 1
    v_cndmask_b32 v53, v101, v53, vcc
    v_cmp_lt_i32 vcc, -26, v100
    s_nop 1
    v_cndmask_b32 v54, v101, v54, vcc
    v_cmp_lt_i32 vcc, -27, v100
    s_nop 1
    v_cndmask_b32 v55, v101, v55, vcc
sln_100:
    s_cmp_eq_u32 s45, 8
    s_cbranch_scc0 sln_101
    v_cmp_ge_i32 vcc, 0, v100
    s_nop 1
    v_cndmask_b32 v40, v101, v40, vcc
    v_cmp_ge_i32 vcc, -1, v100
    s_nop 1
    v_cndmask_b32 v41, v101, v41, vcc
    v_cmp_ge_i32 vcc, -2, v100
    s_nop 1
    v_cndmask_b32 v42, v101, v42, vcc
    v_cmp_ge_i32 vcc, -3, v100
    s_nop 1
    v_cndmask_b32 v43, v101, v43, vcc
    v_cmp_ge_i32 vcc, -8, v100
    s_nop 1
    v_cndmask_b32 v44, v101, v44, vcc
    v_cmp_ge_i32 vcc, -9, v100
    s_nop 1
    v_cndmask_b32 v45, v101, v45, vcc
    v_cmp_ge_i32 vcc, -10, v100
    s_nop 1
    v_cndmask_b32 v46, v101, v46, vcc
    v_cmp_ge_i32 vcc, -11, v100
    s_nop 1
    v_cndmask_b32 v47, v101, v47, vcc
    v_cmp_ge_i32 vcc, -16, v100
    s_nop 1
    v_cndmask_b32 v48, v101, v48, vcc
    v_cmp_ge_i32 vcc, -17, v100
    s_nop 1
    v_cndmask_b32 v49, v101, v49, vcc
    v_cmp_ge_i32 vcc, -18, v100
    s_nop 1
    v_cndmask_b32 v50, v101, v50, vcc
    v_cmp_ge_i32 vcc, -19, v100
    s_nop 1
    v_cndmask_b32 v51, v101, v51, vcc
    v_cmp_ge_i32 vcc, -24, v100
    s_nop 1
    v_cndmask_b32 v52, v101, v52, vcc
    v_cmp_ge_i32 vcc, -25, v100
    s_nop 1
    v_cndmask_b32 v53, v101, v53, vcc
    v_cmp_ge_i32 vcc, -26, v100
    s_nop 1
    v_cndmask_b32 v54, v101, v54, vcc
    v_cmp_ge_i32 vcc, -27, v100
    s_nop 1
    v_cndmask_b32 v55, v101, v55, vcc
sln_101:
    s_cmp_eq_u32 s43, 0
    s_cbranch_scc0 slf_99
    v_max_f32 v98, v98, v40
    v_max_f32 v98, v98, v41
    v_max_f32 v98, v98, v42
    v_max_f32 v98, v98, v43
    v_max_f32 v98, v98, v44
    v_max_f32 v98, v98, v45
    v_max_f32 v98, v98, v46
    v_max_f32 v98, v98, v47
    v_max_f32 v98, v98, v48
    v_max_f32 v98, v98, v49
    v_max_f32 v98, v98, v50
    v_max_f32 v98, v98, v51
    v_max_f32 v98, v98, v52
    v_max_f32 v98, v98, v53
    v_max_f32 v98, v98, v54
    v_max_f32 v98, v98, v55
    s_branch slk_98
slf_99:
    v_sub_f32 v40, v40, v98
    v_sub_f32 v41, v41, v98
    v_sub_f32 v42, v42, v98
    v_sub_f32 v43, v43, v98
    v_sub_f32 v44, v44, v98
    v_sub_f32 v45, v45, v98
    v_sub_f32 v46, v46, v98
    v_sub_f32 v47, v47, v98
    v_sub_f32 v48, v48, v98
    v_sub_f32 v49, v49, v98
    v_sub_f32 v50, v50, v98
    v_sub_f32 v51, v51, v98
    v_sub_f32 v52, v52, v98
    v_sub_f32 v53, v53, v98
    v_sub_f32 v54, v54, v98
    v_sub_f32 v55, v55, v98
    v_exp_f32 v40, v40
    v_exp_f32 v41, v41
    v_exp_f32 v42, v42
    v_exp_f32 v43, v43
    v_exp_f32 v44, v44
    v_exp_f32 v45, v45
    v_exp_f32 v46, v46
    v_exp_f32 v47, v47
    v_exp_f32 v48, v48
    v_exp_f32 v49, v49
    v_exp_f32 v50, v50
    v_exp_f32 v51, v51
    v_exp_f32 v52, v52
    v_exp_f32 v53, v53
    v_exp_f32 v54, v54
    v_exp_f32 v55, v55
    s_nop 1
    v_cvt_pk_bf16_f32 v72, v40, v41
    v_cvt_pk_bf16_f32 v73, v42, v43
    v_cvt_pk_bf16_f32 v74, v44, v45
    v_cvt_pk_bf16_f32 v75, v46, v47
    v_cvt_pk_bf16_f32 v76, v48, v49
    v_cvt_pk_bf16_f32 v77, v50, v51
    v_cvt_pk_bf16_f32 v78, v52, v53
    v_cvt_pk_bf16_f32 v79, v54, v55
    s_nop 1
    v_mfma_f32_32x32x16_bf16 v[200:215], a[124:127], v[72:75], v[200:215]
    v_mfma_f32_32x32x16_bf16 v[200:215], a[128:131], v[76:79], v[200:215]
    s_nop 15
slk_98:
    s_sub_u32 s45, s44, 3
    s_cmp_gt_u32 s45, 8
    s_cbranch_scc1 slk_102
    v_mfma_f32_32x32x16_bf16 v[40:55], a[100:103], v[160:163], 0
    v_mfma_f32_32x32x16_bf16 v[40:55], a[104:107], v[164:167], v[40:55]
    s_nop 15
    s_cmp_eq_u32 s45, 0
    s_cbranch_scc0 sln_104
    v_cmp_lt_i32 vcc, 0, v100
    s_nop 1
    v_cndmask_b32 v40, v101, v40, vcc
    v_cmp_lt_i32 vcc, -1, v100
    s_nop 1
    v_cndmask_b32 v41, v101, v41, vcc
    v_cmp_lt_i32 vcc, -2, v100
    s_nop 1
    v_cndmask_b32 v42, v101, v42, vcc
    v_cmp_lt_i32 vcc, -3, v100
    s_nop 1
    v_cndmask_b32 v43, v101, v43, vcc
    v_cmp_lt_i32 vcc, -8, v100
    s_nop 1
    v_cndmask_b32 v44, v101, v44, vcc
    v_cmp_lt_i32 vcc, -9, v100
    s_nop 1
    v_cndmask_b32 v45, v101, v45, vcc
    v_cmp_lt_i32 vcc, -10, v100
    s_nop 1
    v_cndmask_b32 v46, v101, v46, vcc
    v_cmp_lt_i32 vcc, -11, v100
    s_nop 1
    v_cndmask_b32 v47, v101, v47, vcc
    v_cmp_lt_i32 vcc, -16, v100
    s_nop 1
    v_cndmask_b32 v48, v101, v48, vcc
    v_cmp_lt_i32 vcc, -17, v100
    s_nop 1
    v_cndmask_b32 v49, v101, v49, vcc
    v_cmp_lt_i32 vcc, -18, v100
    s_nop 1
    v_cndmask_b32 v50, v101, v50, vcc
    v_cmp_lt_i32 vcc, -19, v100
    s_nop 1
    v_cndmask_b32 v51, v101, v51, vcc
    v_cmp_lt_i32 vcc, -24, v100
    s_nop 1
    v_cndmask_b32 v52, v101, v52, vcc
    v_cmp_lt_i32 vcc, -25, v100
    s_nop 1
    v_cndmask_b32 v53, v101, v53, vcc
    v_cmp_lt_i32 vcc, -26, v100
    s_nop 1
    v_cndmask_b32 v54, v101, v54, vcc
    v_cmp_lt_i32 vcc, -27, v100
    s_nop 1
    v_cndmask_b32 v55, v101, v55, vcc
sln_104:
    s_cmp_eq_u32 s45, 8
    s_cbranch_scc0 sln_105
    v_cmp_ge_i32 vcc, 0, v100
    s_nop 1
    v_cndmask_b32 v40, v101, v40, vcc
    v_cmp_ge_i32 vcc, -1, v100
    s_nop 1
    v_cndmask_b32 v41, v101, v41, vcc
    v_cmp_ge_i32 vcc, -2, v100
    s_nop 1
    v_cndmask_b32 v42, v101, v42, vcc
    v_cmp_ge_i32 vcc, -3, v100
    s_nop 1
    v_cndmask_b32 v43, v101, v43, vcc
    v_cmp_ge_i32 vcc, -8, v100
    s_nop 1
    v_cndmask_b32 v44, v101, v44, vcc
    v_cmp_ge_i32 vcc, -9, v100
    s_nop 1
    v_cndmask_b32 v45, v101, v45, vcc
    v_cmp_ge_i32 vcc, -10, v100
    s_nop 1
    v_cndmask_b32 v46, v101, v46, vcc
    v_cmp_ge_i32 vcc, -11, v100
    s_nop 1
    v_cndmask_b32 v47, v101, v47, vcc
    v_cmp_ge_i32 vcc, -16, v100
    s_nop 1
    v_cndmask_b32 v48, v101, v48, vcc
    v_cmp_ge_i32 vcc, -17, v100
    s_nop 1
    v_cndmask_b32 v49, v101, v49, vcc
    v_cmp_ge_i32 vcc, -18, v100
    s_nop 1
    v_cndmask_b32 v50, v101, v50, vcc
    v_cmp_ge_i32 vcc, -19, v100
    s_nop 1
    v_cndmask_b32 v51, v101, v51, vcc
    v_cmp_ge_i32 vcc, -24, v100
    s_nop 1
    v_cndmask_b32 v52, v101, v52, vcc
    v_cmp_ge_i32 vcc, -25, v100
    s_nop 1
    v_cndmask_b32 v53, v101, v53, vcc
    v_cmp_ge_i32 vcc, -26, v100
    s_nop 1
    v_cndmask_b32 v54, v101, v54, vcc
    v_cmp_ge_i32 vcc, -27, v100
    s_nop 1
    v_cndmask_b32 v55, v101, v55, vcc
sln_105:
    s_cmp_eq_u32 s43, 0
    s_cbranch_scc0 slf_103
    v_max_f32 v99, v99, v40
    v_max_f32 v99, v99, v41
    v_max_f32 v99, v99, v42
    v_max_f32 v99, v99, v43
    v_max_f32 v99, v99, v44
    v_max_f32 v99, v99, v45
    v_max_f32 v99, v99, v46
    v_max_f32 v99, v99, v47
    v_max_f32 v99, v99, v48
    v_max_f32 v99, v99, v49
    v_max_f32 v99, v99, v50
    v_max_f32 v99, v99, v51
    v_max_f32 v99, v99, v52
    v_max_f32 v99, v99, v53
    v_max_f32 v99, v99, v54
    v_max_f32 v99, v99, v55
    s_branch slk_102
slf_103:
    v_sub_f32 v40, v40, v99
    v_sub_f32 v41, v41, v99
    v_sub_f32 v42, v42, v99
    v_sub_f32 v43, v43, v99
    v_sub_f32 v44, v44, v99
    v_sub_f32 v45, v45, v99
    v_sub_f32 v46, v46, v99
    v_sub_f32 v47, v47, v99
    v_sub_f32 v48, v48, v99
    v_sub_f32 v49, v49, v99
    v_sub_f32 v50, v50, v99
    v_sub_f32 v51, v51, v99
    v_sub_f32 v52, v52, v99
    v_sub_f32 v53, v53, v99
    v_sub_f32 v54, v54, v99
    v_sub_f32 v55, v55, v99
    v_exp_f32 v40, v40
    v_exp_f32 v41, v41
    v_exp_f32 v42, v42
    v_exp_f32 v43, v43
    v_exp_f32 v44, v44
    v_exp_f32 v45, v45
    v_exp_f32 v46, v46
    v_exp_f32 v47, v47
    v_exp_f32 v48, v48
    v_exp_f32 v49, v49
    v_exp_f32 v50, v50
    v_exp_f32 v51, v51
    v_exp_f32 v52, v52
    v_exp_f32 v53, v53
    v_exp_f32 v54, v54
    v_exp_f32 v55, v55
    s_nop 1
    v_cvt_pk_bf16_f32 v72, v40, v41
    v_cvt_pk_bf16_f32 v73, v42, v43
    v_cvt_pk_bf16_f32 v74, v44, v45
    v_cvt_pk_bf16_f32 v75, v46, v47
    v_cvt_pk_bf16_f32 v76, v48, v49
    v_cvt_pk_bf16_f32 v77, v50, v51
    v_cvt_pk_bf16_f32 v78, v52, v53
    v_cvt_pk_bf16_f32 v79, v54, v55
    s_nop 1
    v_mfma_f32_32x32x16_bf16 v[216:231], a[124:127], v[72:75], v[216:231]
    v_mfma_f32_32x32x16_bf16 v[216:231], a[128:131], v[76:79], v[216:231]
    s_nop 15
slk_102:
slt_89:
    s_add_u32 s61, s61, 1
    s_cmp_lt_u32 s61, 3
    s_cbranch_scc1 slb_36
    s_cmp_eq_u32 s43, 1
    s_cbranch_scc1 sld_37
    v_mov_b32 v26, v96
    v_mov_b32 v27, v96
    s_nop 1
    v_permlane32_swap_b32 v26, v27
    s_nop 1
    v_max_f32 v96, v26, v27
    v_mov_b32 v26, v97
    v_mov_b32 v27, v97
    s_nop 1
    v_permlane32_swap_b32 v26, v27
    s_nop 1
    v_max_f32 v97, v26, v27
    v_mov_b32 v26, v98
    v_mov_b32 v27, v98
    s_nop 1
    v_permlane32_swap_b32 v26, v27
    s_nop 1
    v_max_f32 v98, v26, v27
    v_mov_b32 v26, v99
    v_mov_b32 v27, v99
    s_nop 1
    v_permlane32_swap_b32 v26, v27
    s_nop 1
    v_max_f32 v99, v26, v27
    s_mov_b32 s43, 1
    s_branch slm_35
sld_37:
    s_nop 15
    v_mov_b32 v26, v176
    v_mov_b32 v27, v176
    v_mov_b32 v28, v192
    v_mov_b32 v29, v192
    v_mov_b32 v30, v208
    v_mov_b32 v31, v208
    v_mov_b32 v32, v224
    v_mov_b32 v33, v224
    s_nop 1
    v_permlane32_swap_b32 v26, v27
    v_permlane32_swap_b32 v28, v29
    v_permlane32_swap_b32 v30, v31
    v_permlane32_swap_b32 v32, v33
    s_branch L_slow_ret
L_end:
    s_endpgm

.section .rodata,"a"
.p2align 6
.amdhsa_kernel concat_heads__sliding_block__linear_attn_block__prompt_kernel
  .amdhsa_next_free_vgpr 512
  .amdhsa_next_free_sgpr 102
  .amdhsa_accum_offset 256
  .amdhsa_group_segment_fixed_size 0
  .amdhsa_kernarg_size 72
  .amdhsa_user_sgpr_count 2
  .amdhsa_user_sgpr_kernarg_segment_ptr 1
  .amdhsa_system_sgpr_workgroup_id_x 1
.end_amdhsa_kernel
```
